```python
import torch

def _softmax(x, axis=-1):
    return torch.softmax(x, dim=axis)
def _gelu(x):
    return torch.nn.functional.gelu(x, approximate="tanh")
def _silu(x):
    return torch.nn.functional.silu(x)
def _sigmoid(x):
    return torch.sigmoid(x)
def _layernorm(x, axis=-1, eps=1e-5):
    m = x.mean(dim=axis, keepdim=True)
    v = x.var(dim=axis, keepdim=True, unbiased=False)
    return (x - m) / torch.sqrt(v + eps)
def _scatter_add(tgt, idx, src, axis=0):
    return tgt.clone().index_add_(axis, idx, src)
def _segment_sum(src, seg, n):
    out = torch.zeros((n,) + src.shape[1:], dtype=src.dtype)
    return out.index_add_(0, seg, src)
def _pad(x, pw):
    flat = tuple(v for pair in reversed(pw) for v in pair)
    return torch.nn.functional.pad(x, flat)

kernel_name = 'interleave_layers__softmax_full_mha__mixer_s_mlp__prompt'

def setup_inputs():

    _w = (lambda a: (lambda t: t.to(torch.bfloat16) if t.is_floating_point() else t)(torch.as_tensor(a)))
    def _A_setup():
        B, S, D = 1, 2048, 448
        return {
            "x": _w((lambda *s: torch.randn(*s, dtype=torch.bfloat16) * 0.05)(B, S, D)),
            "wqkv": _w((lambda *s: torch.randn(*s, dtype=torch.bfloat16) * 0.05)(D, 3 * D)),
            "wo": _w((lambda *s: torch.randn(*s, dtype=torch.bfloat16) * 0.05)(D, D)),
        }
    _A_in = _A_setup()

    def _B_setup():
        B, S, D, F = 1, 2048, 448, 1792
        return {
            "x":  _w((lambda *s: torch.randn(*s, dtype=torch.bfloat16) * 0.05)(B, S, D)),
            "w1": _w((lambda *s: torch.randn(*s, dtype=torch.bfloat16) * 0.8)(D, D) * (D ** -0.5)),
            "w2": _w((lambda *s: torch.randn(*s, dtype=torch.bfloat16) * 0.8)(D, D) * (D ** -0.5)),
            "w3": _w((lambda *s: torch.randn(*s, dtype=torch.bfloat16) * 0.8)(D, F) * (D ** -0.5)),
            "w4": _w((lambda *s: torch.randn(*s, dtype=torch.bfloat16) * 0.8)(F, D) * (F ** -0.5)),
        }
    _B_in = _B_setup()

    return {
        "A_x": _A_in["x"],
        "A_wqkv": _A_in["wqkv"],
        "A_wo": _A_in["wo"],
        "B_x": _B_in["x"],
        "B_w1": _B_in["w1"],
        "B_w2": _B_in["w2"],
        "B_w3": _B_in["w3"],
        "B_w4": _B_in["w4"],
    }

def reference(A_x, A_wqkv, A_wo, B_x, B_w1, B_w2, B_w3, B_w4):
    def _A_ref(x, wqkv, wo):
        B, S, D = x.shape
        H = 16; Dh = D // H
        qkv = (lambda x, *d: x.permute(*d))((x @ wqkv).reshape(B, S, 3, H, Dh), 2, 0, 3, 1, 4)
        q, k, v = qkv[0], qkv[1], qkv[2]
        scale = Dh ** -0.5
        scores = torch.einsum("bhqd,bhkd->bhqk", q, k) * scale
        p = _softmax(scores, axis=-1)
        o = torch.einsum("bhqk,bhkd->bhqd", p, v)
        return (lambda x, *d: x.permute(*d))(o, 0, 2, 1, 3).reshape(B, S, D) @ wo

    def _B_ref(x, w1, w2, w3, w4):
        B, S, D = x.shape
        h = _gelu(_layernorm(x, axis=-1) @ w1)
        c = D // 4
        g0 = _pad(h[:, :, 0*c:1*c], ((0, 0), (1, 0), (0, 0)))[:, :S, :]
        g1 = _pad(h[:, :, 1*c:2*c], ((0, 0), (0, 1), (0, 0)))[:, 1:, :]
        g2 = _pad(h[:, :, 2*c:3*c], ((0, 0), (2, 0), (0, 0)))[:, :S, :]
        g3 = _pad(h[:, :, 3*c:   ], ((0, 0), (0, 2), (0, 0)))[:, 2:, :]
        hs = torch.concatenate([g0, g1, g2, g3], axis=-1) @ w2
        x1 = x + hs
        h2 = _gelu(_layernorm(x1, axis=-1) @ w3) @ w4
        return x1 + h2

    x = A_x
    x = x + _A_ref(_layernorm(x, axis=-1), A_wqkv, A_wo)
    x = x + _B_ref(_layernorm(x, axis=-1), B_w1, B_w2, B_w3, B_w4)
    x = x + _A_ref(_layernorm(x, axis=-1), A_wqkv, A_wo)
    x = x + _B_ref(_layernorm(x, axis=-1), B_w1, B_w2, B_w3, B_w4)
    return x
```

```asm
; @launch grid=(256,1,1) block=(256,1,1) lds=163840
.amdgcn_target "amdgcn-amd-amdhsa--gfx950"
.text
.globl interleave_layers__softmax_full_mha__mixer_s_mlp__prompt_kernel
.p2align 8
.type interleave_layers__softmax_full_mha__mixer_s_mlp__prompt_kernel,@function
interleave_layers__softmax_full_mha__mixer_s_mlp__prompt_kernel:
    s_cmp_ge_u32 s2, 256
    s_cbranch_scc1 L_done
    s_load_dwordx4 s[16:19], s[0:1], 0
    s_getpc_b64 s[60:61]
L_pc0:
    s_lshr_b32 s40, s2, 3
    v_min_u32 v5, 15, v0
    v_lshl_add_u32 v5, s40, 4, v5
    v_lshlrev_b32 v5, 7, v5
    v_min_u32 v5, L_code_end-L_pc0-4, v5
    global_load_dword v198, v5, s[60:61]
    s_load_dwordx2 s[36:37], s[0:1], 80
    s_load_dwordx4 s[20:23], s[0:1], 16
    s_load_dwordx8 s[24:31], s[0:1], 32
    s_load_dwordx4 s[32:35], s[0:1], 64
    s_and_b32 s39, s2, 7
    v_lshrrev_b32 v5, 6, v0
    s_and_b32 s43, s40, 15
    v_readfirstlane_b32 s41, v5
    s_lshr_b32 s60, s40, 4
    s_lshl_b32 s42, s39, 1
    s_add_u32 s42, s42, s60
    s_lshl_b32 s63, s39, 5
    s_add_u32 s63, s63, s40
    s_mul_i32 s63, s63, 56
    v_and_b32 v0, 63, v0
    v_min_u32 v6, 55, v0
    v_add_lshl_u32 v6, v6, s63, 7
    v_lshrrev_b32 v5, 2, v0
    v_mul_u32_u24 v44, 2688, v5
    v_and_b32 v5, 3, v0
    v_lshl_add_u32 v44, v5, 4, v44
    s_mul_i32 s61, s42, 75264
    s_mul_i32 s62, s43, 56
    s_add_u32 s61, s61, s62
    s_mul_i32 s62, s41, 896
    s_add_u32 s61, s61, s62
    s_cmp_eq_u32 s41, 3
    s_cselect_b32 s61, 0x40000000, s61
    s_add_u32 s62, s61, 43008
    v_mov_b32 v7, 40960
    s_mov_b32 s10, 1204224
    s_mov_b32 s11, 0x20000
    s_waitcnt lgkmcnt(0)
    s_mov_b32 s8, s18
    s_and_b32 s9, s19, 0xffff
    buffer_load_dwordx4 v[36:39], v44, s[8:11], s61 offen
    s_mov_b32 exec_hi, 0xffff
    buffer_load_dwordx4 v[40:43], v44, s[8:11], s62 offen
    s_mov_b32 exec_hi, -1
    global_load_dword v202, v7, s[36:37] sc1
    v_mov_b32 v45, v6
    v_lshlrev_b32 v1, 4, v0
    s_lshl_b32 s86, s42, 2
    s_add_u32 s86, s86, s41
    s_mov_b32 s4, s36
    s_and_b32 s5, s37, 0xffff
    s_mov_b32 s6, 268435456
    s_mov_b32 s7, 0x20000
    s_mov_b32 s38, 0
    s_mov_b32 s12, s16
    s_and_b32 s13, s17, 0xffff
    s_mov_b32 s14, 1835008
    s_mov_b32 s15, 0x20000
    v_lshrrev_b32 v5, 3, v0
    v_mul_u32_u24 v6, 896, v5
    v_lshrrev_b32 v5, 4, v0
    v_xor_b32 v5, v5, v0
    v_and_b32 v5, 7, v5
    v_lshl_add_u32 v52, v5, 4, v6
    v_xor_b32 v5, 4, v5
    v_lshl_add_u32 v53, v5, 4, v6
    v_add_u32 v54, 12288, v52
    v_add_u32 v55, 18432, v53
    v_add_u32 v53, 6144, v53
    s_mul_i32 s93, s86, 28672
    s_lshl_b32 s94, s41, 14
    s_add_u32 s94, s94, 86016
    s_lshl_b32 s92, s41, 10
    s_mul_i32 s91, s43, 90112
    s_add_u32 s91, s91, 13631488
    s_movk_i32 s52, 0x1000
    s_movk_i32 s53, 0x2000
    s_movk_i32 s54, 0x3000
    s_movk_i32 s55, 0x4000
    s_movk_i32 s56, 0x5000
    s_movk_i32 s57, 0x6000
    s_movk_i32 s58, 0x7000
    s_mov_b32 s59, 32768
    v_lshrrev_b32 v5, 5, v0
    v_lshlrev_b32 v201, 4, v5
    v_add_u32 v201, 131072, v201
    v_lshlrev_b32 v2, 8, v5
    v_bfe_u32 v5, v0, 2, 2
    v_lshl_add_u32 v2, v5, 6, v2
    v_bfe_u32 v5, v0, 4, 1
    v_lshl_add_u32 v2, v5, 5, v2
    v_and_b32 v5, 3, v0
    v_lshl_add_u32 v2, v5, 3, v2
    s_mul_i32 s44, s40, 37
    s_lshr_b32 s44, s44, 8
    s_mul_i32 s60, s44, 7
    s_sub_u32 s45, s40, s60
    s_lshr_b32 s46, s44, 1
    s_mul_i32 s60, s46, 14
    s_sub_u32 s47, s40, s60
    s_and_b32 s50, s41, 1
    s_lshr_b32 s51, s41, 1
    s_mul_i32 s99, s50, 14336
    s_lshl_b32 s84, s39, 3
    s_lshl_b32 s60, s44, 1
    s_add_u32 s60, s60, s50
    s_add_u32 s84, s84, s60
    s_cmp_eq_u32 s60, 0
    s_cselect_b32 s98, 3, 0
    s_cmp_eq_u32 s60, 7
    s_cselect_b32 s98, 0xc0000000, s98
    s_lshl_b32 s85, s45, 1
    s_add_u32 s85, s85, s51
    s_mov_b32 s61, 16777216
    s_mul_i32 s49, s39, 1179648
    s_add_u32 s49, s49, s61
    s_mul_i32 s80, s39, 1376256
    s_add_u32 s80, s80, s61
    s_mul_i32 s81, s39, 491520
    s_add_u32 s81, s81, s61
    s_sub_u32 s101, 1048576, s49
    s_mul_i32 s71, s39, 1409024
    s_add_u32 s71, s71, s61
    s_lshl_b32 s61, s40, 2
    s_add_u32 s61, s61, s41
    s_mul_i32 s61, s61, 3840
    s_add_u32 s71, s71, s61
    v_lshlrev_b32 v196, 7, v0
    s_mov_b32 exec_lo, 0xfffffff8
    v_bfrev_b32 v196, 1
    s_mov_b32 exec_lo, -1
    s_mul_i32 s97, s84, 28672
    s_add_u32 s97, s97, s49
    s_lshl_b32 s61, s85, 11
    s_add_u32 s95, s97, s61
    s_mul_i32 s61, s51, 14336
    s_add_u32 s97, s97, s61
    s_lshl_b32 s96, s84, 12
    s_lshr_b32 s61, s85, 2
    s_lshl_b32 s61, s61, 10
    s_add_u32 s96, s96, s61
    s_add_u32 s96, s96, s80
    s_and_b32 s61, s85, 3
    s_lshl_b32 s61, s61, 2
    s_add_u32 s96, s96, s61
    s_lshl_b32 s89, s39, 8
    s_add_u32 s89, s89, 4096
    s_lshl_b32 s61, s40, 2
    s_add_u32 s83, s89, s61
    s_add_u32 s61, s61, s41
    s_lshl_b32 s61, s61, 2
    s_lshl_b32 s60, s39, 9
    s_add_u32 s82, s60, s61
    s_mov_b32 s48, 1
    v_lshl_add_u32 v241, v0, 3, s60
    s_lshl_b32 s61, s50, 2
    v_add_u32 v4, s61, v241
    s_cmp_lg_u32 s41, 3
    s_cbranch_scc1 L_xt_1
    global_load_dword v198, v45, s[16:17]
L_xt_1:
    s_lshl_b32 s61, s43, 11
    s_add_u32 s61, s61, 65536
    s_lshl_b32 s62, s41, 15
    s_add_u32 s61, s61, s62
    s_lshl_b32 s62, s39, 8
    s_add_u32 s62, s62, s61
    v_and_b32 v5, 7, v0
    v_lshl_add_u32 v244, v5, 2, s62
    v_bfe_u32 v5, v0, 3, 1
    v_lshl_add_u32 v244, v5, 7, v244
    s_lshr_b32 s62, s42, 3
    s_lshl_b32 s62, s62, 7
    s_add_u32 s61, s61, s62
    s_and_b32 s23, s42, 7
    s_lshl_b32 s23, s23, 2
    s_add_u32 s23, s23, s61
    s_lshl_b32 s61, s39, 9
    s_lshl_b32 s62, s50, 8
    s_add_u32 s61, s61, s62
    s_lshl_b32 s63, s85, 2
    s_add_u32 s61, s61, s63
    s_add_u32 s90, s61, 8192
    s_lshl_b32 s61, s50, 1
    s_add_u32 s61, s61, s39
    s_sub_u32 s61, s61, 1
    s_cmp_lt_u32 s61, 8
    s_cselect_b32 s64, s98, 0
    s_lshl_b32 s61, s61, 9
    s_xor_b32 s62, s62, 256
    s_add_u32 s61, s61, s62
    s_add_u32 s61, s61, 7744
    s_cmp_lg_u32 s64, 0
    s_cselect_b32 s61, s61, s60
    s_cselect_b32 s64, 0x7f000000, 0
    s_mov_b32 exec_lo, 0
    s_mov_b32 exec_hi, 0xff000000
    v_lshl_add_u32 v241, v0, 3, s61
    s_mov_b64 exec, -1
    s_mul_i32 s61, s44, 14
    s_mov_b32 s72, 0x3fff
    s_mov_b32 s73, 0
    s_lshl_b64 s[72:73], s[72:73], s61
    s_lshr_b64 s[62:63], s[72:73], 14
    s_lshl_b64 s[66:67], s[72:73], 14
    s_cmp_eq_u32 s50, 0
    s_cselect_b64 s[62:63], s[62:63], s[66:67]
    s_or_b64 s[62:63], s[62:63], s[72:73]
    s_and_b32 s63, s63, 0xffffff
    s_or_b32 s63, s63, s64
    s_or_b32 s73, s73, s64
    s_cmp_eq_u32 s50, 0
    s_cselect_b64 s[0:1], s[72:73], s[62:63]
    s_cselect_b64 s[36:37], s[62:63], s[72:73]
    s_lshl_b32 s60, s2, 2
    s_add_u32 s60, s60, s41
    s_mul_i32 s61, s60, 2
    v_min_u32 v5, 1, v0
    v_add_u32 v5, s61, v5
    v_mul_u32_u24 v5, 3, v5
    v_min_u32 v5, 3133, v5
    v_lshlrev_b32 v246, 7, v5
    s_mul_i32 s61, s60, 5
    v_min_u32 v5, 4, v0
    v_add_u32 v5, s61, v5
    v_mul_u32_u24 v5, 3, v5
    v_min_u32 v5, 12541, v5
    v_lshlrev_b32 v247, 7, v5
    v_bfe_u32 v5, v0, 2, 3
    v_mul_u32_u24 v3, 896, v5
    v_lshrrev_b32 v5, 5, v0
    v_lshl_add_u32 v3, v5, 6, v3
    v_and_b32 v5, 3, v0
    v_lshl_add_u32 v3, v5, 4, v3
    v_bfe_u32 v5, v0, 2, 3
    v_mul_u32_u24 v240, 3584, v5
    v_lshrrev_b32 v5, 5, v0
    v_lshl_add_u32 v240, v5, 6, v240
    v_and_b32 v5, 3, v0
    v_lshl_add_u32 v240, v5, 4, v240
    s_lshl_b32 s60, s41, 12
    s_add_u32 s60, s60, 114688
    v_add_u32 v199, s60, v1
    v_xor_b32 v200, 0x2000, v199
    s_add_u32 s60, s41, 1
    s_and_b32 s60, s60, 3
    s_mul_i32 s60, s60, 12288
    s_add_u32 s60, s60, 114688
    v_add_u32 v204, s60, v1
    s_add_u32 s60, s41, 2
    s_and_b32 s60, s60, 3
    s_mul_i32 s60, s60, 12288
    s_add_u32 s60, s60, 118784
    v_add_u32 v205, s60, v1
    s_add_u32 s60, s41, 3
    s_and_b32 s60, s60, 3
    s_mul_i32 s60, s60, 12288
    s_add_u32 s60, s60, 122880
    v_add_u32 v206, s60, v1
    s_mul_i32 s60, s41, 12288
    s_add_u32 s60, s60, 114688
    v_add_u32 v207, s60, v1
    s_mul_i32 s62, s86, 28672
    s_add_u32 s62, s62, s49
    s_mul_i32 s60, s43, 7
    v_lshrrev_b32 v6, 5, v0
    v_add_u32 v6, s60, v6
    v_and_b32 v7, 31, v0
    v_lshl_add_u32 v7, v7, 4, s62
    v_and_b32 v8, 1, v6
    v_lshl_add_u32 v7, v8, 9, v7
    v_add_u32 v8, 0, v6
    v_lshrrev_b32 v9, 2, v8
    v_lshl_add_u32 v192, v9, 10, v7
    v_bfe_u32 v9, v8, 1, 1
    v_lshl_add_u32 v192, v9, 3, v192
    v_add_u32 v8, 2, v6
    v_lshrrev_b32 v9, 2, v8
    v_lshl_add_u32 v193, v9, 10, v7
    v_bfe_u32 v9, v8, 1, 1
    v_lshl_add_u32 v193, v9, 3, v193
    v_add_u32 v8, 4, v6
    v_lshrrev_b32 v9, 2, v8
    v_lshl_add_u32 v194, v9, 10, v7
    v_bfe_u32 v9, v8, 1, 1
    v_lshl_add_u32 v194, v9, 3, v194
    v_add_u32 v8, 6, v6
    v_lshrrev_b32 v9, 2, v8
    v_lshl_add_u32 v195, v9, 10, v7
    v_bfe_u32 v9, v8, 1, 1
    v_lshl_add_u32 v195, v9, 3, v195
    s_mul_i32 s60, s39, 1409024
    s_add_u32 s60, s60, 16777216
    s_lshl_b32 s61, s40, 2
    s_add_u32 s61, s61, s41
    s_mul_i32 s61, s61, 3840
    s_add_u32 s60, s60, s61
    v_min_u32 v8, 29, v0
    v_lshl_add_u32 v197, v8, 7, s60
    s_mul_i32 s63, s51, 14336
    s_add_u32 s63, s63, s49
    s_add_u32 s63, s63, 0
    s_lshl_b32 s62, s84, 5
    s_add_u32 s64, s51, 1
    s_mov_b32 s65, 28672
    v_and_b32 v5, 31, v0
    v_add_u32 v5, s62, v5
    v_subrev_u32 v5, s64, v5
    v_lshrrev_b32 v6, 5, v5
    v_mul_lo_u32 v242, v6, s65
    v_and_b32 v6, 31, v5
    v_lshl_add_u32 v242, v6, 4, v242
    v_and_b32 v6, 512, v1
    v_add3_u32 v242, v242, v6, s63
    v_lshrrev_b32 v6, 8, v5
    v_cmp_ne_u32 vcc, s39, v6
    v_add_u32 v6, s101, v242
    s_nop 0
    v_cndmask_b32 v242, v242, v6, vcc
    v_cmp_lt_u32 vcc, 0x7ff, v5
    v_bfrev_b32 v6, 1
    s_nop 0
    v_cndmask_b32 v242, v242, v6, vcc
    v_and_b32 v5, 31, v0
    v_add_u32 v5, s62, v5
    v_add_u32 v5, s64, v5
    v_lshrrev_b32 v6, 5, v5
    v_mul_lo_u32 v243, v6, s65
    v_and_b32 v6, 31, v5
    v_lshl_add_u32 v243, v6, 4, v243
    v_and_b32 v6, 512, v1
    v_add3_u32 v243, v243, v6, s63
    v_lshrrev_b32 v6, 8, v5
    v_cmp_ne_u32 vcc, s39, v6
    v_add_u32 v6, s101, v243
    s_nop 0
    v_cndmask_b32 v243, v243, v6, vcc
    v_cmp_lt_u32 vcc, 0x7ff, v5
    v_bfrev_b32 v6, 1
    s_nop 0
    v_cndmask_b32 v243, v243, v6, vcc
    s_mul_i32 s61, s41, 28672
    s_mul_i32 s62, s42, 1792
    s_add_u32 s61, s61, s62
    s_add_u32 s61, s61, s91
    s_cmp_eq_u32 s41, 3
    s_cselect_b32 s61, 0x40000000, s61
    s_mov_b32 exec_lo, 0x88888888
    s_mov_b32 exec_hi, 0x88888888
    s_waitcnt vmcnt(1)
    v_mov_b32 v38, 0
    v_mov_b32 v39, 0
    v_mov_b32 v42, 0
    v_mov_b32 v43, 0
    s_mov_b64 exec, -1
    buffer_store_dwordx4 v[36:39], v1, s[4:7], s61 offen sc1
    s_mov_b32 exec_hi, 0xffff
    buffer_store_dwordx4 v[40:43], v1, s[4:7], s61 offen offset:1024 sc1
    s_mov_b32 exec_hi, -1
    s_add_u32 m0, s94, 0
    s_add_u32 s70, s93, 0
    buffer_load_dwordx4 v52, s[12:15], s70 offen offset:0 lds
    buffer_load_dwordx4 v53, s[12:15], s70 offen offset:1024 lds
    buffer_load_dwordx4 v54, s[12:15], s70 offen offset:2048 lds
    buffer_load_dwordx4 v55, s[12:15], s70 offen offset:3072 lds
    s_add_u32 m0, s94, 4096
    s_add_u32 s70, s93, 128
    buffer_load_dwordx4 v52, s[12:15], s70 offen offset:0 lds
    buffer_load_dwordx4 v53, s[12:15], s70 offen offset:1024 lds
    buffer_load_dwordx4 v54, s[12:15], s70 offen offset:2048 lds
    buffer_load_dwordx4 v55, s[12:15], s70 offen offset:3072 lds
    s_add_u32 s91, s91, s92
    v_and_b32 v5, 31, v0
    v_lshrrev_b32 v6, 1, v5
    v_lshrrev_b32 v8, 5, v0
    v_xor_b32 v6, v6, v8
    v_and_b32 v6, 7, v6
    v_lshl_add_u32 v5, v5, 7, s94
    v_xor_b32 v9, 0, v6
    v_lshl_add_u32 v56, v9, 4, v5
    v_xor_b32 v9, 2, v6
    v_lshl_add_u32 v57, v9, 4, v5
    v_xor_b32 v9, 4, v6
    v_lshl_add_u32 v58, v9, 4, v5
    v_xor_b32 v9, 6, v6
    v_lshl_add_u32 v59, v9, 4, v5
    v_lshl_add_u32 v14, v8, 8, v2
    v_add_u32 v15, 28672, v14
    v_add_u32 v11, 57344, v14
    s_mul_i32 s60, s41, 28672
    s_cmp_eq_u32 s41, 3
    s_cselect_b32 s60, 0, s60
    v_lshrrev_b32 v5, 2, v0
    v_lshl_add_u32 v60, v5, 6, s60
    v_and_b32 v5, 3, v0
    v_lshl_add_u32 v60, v5, 3, v60
    s_cselect_b32 s60, 0, 0x3f803f80
    v_accvgpr_write_b32 a176, s60
    v_accvgpr_write_b32 a177, s60
    v_accvgpr_write_b32 a178, s60
    v_accvgpr_write_b32 a179, s60
    v_mov_b32 v36, 0x3f803f80
    v_mov_b32 v32, 0
    v_mov_b32 v33, 0
    v_mov_b32 v34, 0
    v_mov_b32 v35, 0
    s_waitcnt vmcnt(10)
    v_readfirstlane_b32 s3, v202
    s_nop 1
    s_add_u32 s3, s3, 64
    s_sub_u32 s63, s3, 1
    s_cmp_ge_u32 s63, 0xffffff00
    s_cselect_b32 s3, 64, s3
    v_mov_b32 v5, s3
    s_add_u32 s62, s23, 131072
    v_lshlrev_b32 v62, 8, v0
    s_lshl_b32 s63, s41, 15
    s_sub_u32 s63, 131072, s63
    v_add_u32 v61, s63, v244
    s_cmp_eq_u32 s41, 3
    s_cbranch_scc1 L_w3s_2
    s_waitcnt vmcnt(8)
L_w3s_2:
    s_cmp_lg_u32 s41, 0
    s_barrier
    v_bfrev_b32 v37, 1
    s_cbranch_scc1 L_imf_3
    s_mov_b64 exec, 0xff
    buffer_store_dword v5, v62, s[4:7], s62 offen sc1
    s_mov_b64 exec, -1
    s_lshl_b32 s60, s39, 9
    s_lshl_b32 s61, s40, 4
    s_add_u32 s61, s61, s60
    v_lshl_add_u32 v5, v0, 2, s61
    s_lshr_b32 s62, s61, 1
    s_lshl_b32 s63, s40, 2
    s_sub_u32 s62, s62, s63
    s_add_u32 s62, s62, 4096
    v_writelane_b32 v5, s62, 4
    v_writelane_b32 v5, s62, 5
    s_lshl_b32 s63, s40, 3
    s_add_u32 s63, s63, s60
    s_add_u32 s62, s63, 8192
    s_cmp_lt_u32 s40, 7
    s_cselect_b32 s62, s62, s61
    s_add_u32 s63, s63, 8280
    s_sub_u32 s64, s40, 21
    s_cmp_lt_u32 s64, 7
    s_cselect_b32 s62, s63, s62
    v_writelane_b32 v5, s62, 6
    s_add_u32 s62, s62, 4
    v_writelane_b32 v5, s62, 7
    v_mov_b32 v37, v5
    s_getreg_b32 s62, hwreg(HW_REG_XCC_ID, 0, 3)
    s_add_u32 s62, s62, s3
    s_add_u32 s62, s62, 32
    v_mov_b32 v38, 0
    v_writelane_b32 v38, s62, 4
    v_writelane_b32 v38, s62, 5
L_imf_3:
    s_add_u32 m0, s94, 8192
    s_add_u32 s70, s93, 256
    buffer_load_dwordx4 v52, s[12:15], s70 offen offset:0 lds
    buffer_load_dwordx4 v53, s[12:15], s70 offen offset:1024 lds
    buffer_load_dwordx4 v54, s[12:15], s70 offen offset:2048 lds
    buffer_load_dwordx4 v55, s[12:15], s70 offen offset:3072 lds
    s_add_u32 m0, s94, 12288
    s_add_u32 s70, s93, 384
    buffer_load_dwordx4 v52, s[12:15], s70 offen offset:0 lds
    buffer_load_dwordx4 v53, s[12:15], s70 offen offset:1024 lds
    buffer_load_dwordx4 v54, s[12:15], s70 offen offset:2048 lds
    buffer_load_dwordx4 v55, s[12:15], s70 offen offset:3072 lds
    s_mov_b32 s72, 0xffff
    s_mov_b32 s73, 0
    s_waitcnt vmcnt(12)
    ds_read_b128 v[64:67], v56 offset:0
    ds_read_b128 v[68:71], v57 offset:0
    ds_read_b128 v[72:75], v58 offset:0
    ds_read_b128 v[76:79], v59 offset:0
    s_waitcnt lgkmcnt(0)
    s_add_u32 m0, s94, 0
    s_add_u32 s70, s93, 512
    buffer_load_dwordx4 v52, s[12:15], s70 offen offset:0 lds
    buffer_load_dwordx4 v53, s[12:15], s70 offen offset:1024 lds
    buffer_load_dwordx4 v54, s[12:15], s70 offen offset:2048 lds
    buffer_load_dwordx4 v55, s[12:15], s70 offen offset:3072 lds
    s_waitcnt vmcnt(12)
    ds_read_b128 v[80:83], v56 offset:4096
    ds_read_b128 v[84:87], v57 offset:4096
    ds_read_b128 v[88:91], v58 offset:4096
    ds_read_b128 v[92:95], v59 offset:4096
    v_dot2c_f32_bf16 v32, v64, v36
    v_dot2c_f32_bf16 v34, v64, v64
    v_dot2c_f32_bf16 v33, v65, v36
    v_dot2c_f32_bf16 v35, v65, v65
    v_dot2c_f32_bf16 v32, v66, v36
    v_dot2c_f32_bf16 v34, v66, v66
    v_dot2c_f32_bf16 v33, v67, v36
    v_dot2c_f32_bf16 v35, v67, v67
    v_dot2c_f32_bf16 v32, v68, v36
    v_dot2c_f32_bf16 v34, v68, v68
    v_dot2c_f32_bf16 v33, v69, v36
    v_dot2c_f32_bf16 v35, v69, v69
    v_dot2c_f32_bf16 v32, v70, v36
    v_dot2c_f32_bf16 v34, v70, v70
    v_dot2c_f32_bf16 v33, v71, v36
    v_dot2c_f32_bf16 v35, v71, v71
    v_dot2c_f32_bf16 v32, v72, v36
    v_dot2c_f32_bf16 v34, v72, v72
    v_dot2c_f32_bf16 v33, v73, v36
    v_dot2c_f32_bf16 v35, v73, v73
    v_dot2c_f32_bf16 v32, v74, v36
    v_dot2c_f32_bf16 v34, v74, v74
    v_dot2c_f32_bf16 v33, v75, v36
    v_dot2c_f32_bf16 v35, v75, v75
    v_dot2c_f32_bf16 v32, v76, v36
    v_dot2c_f32_bf16 v34, v76, v76
    v_dot2c_f32_bf16 v33, v77, v36
    v_dot2c_f32_bf16 v35, v77, v77
    v_dot2c_f32_bf16 v32, v78, v36
    v_dot2c_f32_bf16 v34, v78, v78
    v_dot2c_f32_bf16 v33, v79, v36
    v_dot2c_f32_bf16 v35, v79, v79
    s_waitcnt lgkmcnt(0)
    s_add_u32 m0, s94, 4096
    s_add_u32 s70, s93, 640
    buffer_load_dwordx4 v52, s[12:15], s70 offen offset:0 lds
    buffer_load_dwordx4 v53, s[12:15], s70 offen offset:1024 lds
    buffer_load_dwordx4 v54, s[12:15], s70 offen offset:2048 lds
    buffer_load_dwordx4 v55, s[12:15], s70 offen offset:3072 lds
    s_waitcnt vmcnt(12)
    ds_read_b128 v[96:99], v56 offset:8192
    ds_read_b128 v[100:103], v57 offset:8192
    ds_read_b128 v[104:107], v58 offset:8192
    ds_read_b128 v[108:111], v59 offset:8192
    v_dot2c_f32_bf16 v32, v80, v36
    v_dot2c_f32_bf16 v34, v80, v80
    v_dot2c_f32_bf16 v33, v81, v36
    v_dot2c_f32_bf16 v35, v81, v81
    v_dot2c_f32_bf16 v32, v82, v36
    v_dot2c_f32_bf16 v34, v82, v82
    v_dot2c_f32_bf16 v33, v83, v36
    v_dot2c_f32_bf16 v35, v83, v83
    v_dot2c_f32_bf16 v32, v84, v36
    v_dot2c_f32_bf16 v34, v84, v84
    v_dot2c_f32_bf16 v33, v85, v36
    v_dot2c_f32_bf16 v35, v85, v85
    v_dot2c_f32_bf16 v32, v86, v36
    v_dot2c_f32_bf16 v34, v86, v86
    v_dot2c_f32_bf16 v33, v87, v36
    v_dot2c_f32_bf16 v35, v87, v87
    v_dot2c_f32_bf16 v32, v88, v36
    v_dot2c_f32_bf16 v34, v88, v88
    v_dot2c_f32_bf16 v33, v89, v36
    v_dot2c_f32_bf16 v35, v89, v89
    v_dot2c_f32_bf16 v32, v90, v36
    v_dot2c_f32_bf16 v34, v90, v90
    v_dot2c_f32_bf16 v33, v91, v36
    v_dot2c_f32_bf16 v35, v91, v91
    v_dot2c_f32_bf16 v32, v92, v36
    v_dot2c_f32_bf16 v34, v92, v92
    v_dot2c_f32_bf16 v33, v93, v36
    v_dot2c_f32_bf16 v35, v93, v93
    v_dot2c_f32_bf16 v32, v94, v36
    v_dot2c_f32_bf16 v34, v94, v94
    v_dot2c_f32_bf16 v33, v95, v36
    v_dot2c_f32_bf16 v35, v95, v95
    s_waitcnt lgkmcnt(0)
    s_add_u32 m0, s94, 8192
    s_add_u32 s70, s93, 768
    buffer_load_dwordx4 v52, s[12:15], s70 offen offset:0 lds
    buffer_load_dwordx4 v53, s[12:15], s70 offen offset:1024 lds
    buffer_load_dwordx4 v54, s[12:15], s70 offen offset:2048 lds
    buffer_load_dwordx4 v55, s[12:15], s70 offen offset:3072 lds
    s_waitcnt vmcnt(12)
    ds_read_b128 v[112:115], v56 offset:12288
    ds_read_b128 v[116:119], v57 offset:12288
    ds_read_b128 v[120:123], v58 offset:12288
    ds_read_b128 v[124:127], v59 offset:12288
    v_dot2c_f32_bf16 v32, v96, v36
    v_dot2c_f32_bf16 v34, v96, v96
    v_dot2c_f32_bf16 v33, v97, v36
    v_dot2c_f32_bf16 v35, v97, v97
    v_dot2c_f32_bf16 v32, v98, v36
    v_dot2c_f32_bf16 v34, v98, v98
    v_dot2c_f32_bf16 v33, v99, v36
    v_dot2c_f32_bf16 v35, v99, v99
    v_dot2c_f32_bf16 v32, v100, v36
    v_dot2c_f32_bf16 v34, v100, v100
    v_dot2c_f32_bf16 v33, v101, v36
    v_dot2c_f32_bf16 v35, v101, v101
    v_dot2c_f32_bf16 v32, v102, v36
    v_dot2c_f32_bf16 v34, v102, v102
    v_dot2c_f32_bf16 v33, v103, v36
    v_dot2c_f32_bf16 v35, v103, v103
    v_dot2c_f32_bf16 v32, v104, v36
    v_dot2c_f32_bf16 v34, v104, v104
    v_dot2c_f32_bf16 v33, v105, v36
    v_dot2c_f32_bf16 v35, v105, v105
    v_dot2c_f32_bf16 v32, v106, v36
    v_dot2c_f32_bf16 v34, v106, v106
    v_dot2c_f32_bf16 v33, v107, v36
    v_dot2c_f32_bf16 v35, v107, v107
    v_dot2c_f32_bf16 v32, v108, v36
    v_dot2c_f32_bf16 v34, v108, v108
    v_dot2c_f32_bf16 v33, v109, v36
    v_dot2c_f32_bf16 v35, v109, v109
    v_dot2c_f32_bf16 v32, v110, v36
    v_dot2c_f32_bf16 v34, v110, v110
    v_dot2c_f32_bf16 v33, v111, v36
    v_dot2c_f32_bf16 v35, v111, v111
    s_waitcnt lgkmcnt(0)
    s_waitcnt vmcnt(8)
    ds_read_b128 v[128:131], v56 offset:0
    ds_read_b128 v[132:135], v57 offset:0
    ds_read_b128 v[136:139], v58 offset:0
    ds_read_b128 v[140:143], v59 offset:0
    v_dot2c_f32_bf16 v32, v112, v36
    v_dot2c_f32_bf16 v34, v112, v112
    v_dot2c_f32_bf16 v33, v113, v36
    v_dot2c_f32_bf16 v35, v113, v113
    v_dot2c_f32_bf16 v32, v114, v36
    v_dot2c_f32_bf16 v34, v114, v114
    v_dot2c_f32_bf16 v33, v115, v36
    v_dot2c_f32_bf16 v35, v115, v115
    v_dot2c_f32_bf16 v32, v116, v36
    v_dot2c_f32_bf16 v34, v116, v116
    v_dot2c_f32_bf16 v33, v117, v36
    v_dot2c_f32_bf16 v35, v117, v117
    v_dot2c_f32_bf16 v32, v118, v36
    v_dot2c_f32_bf16 v34, v118, v118
    v_dot2c_f32_bf16 v33, v119, v36
    v_dot2c_f32_bf16 v35, v119, v119
    v_dot2c_f32_bf16 v32, v120, v36
    v_dot2c_f32_bf16 v34, v120, v120
    v_dot2c_f32_bf16 v33, v121, v36
    v_dot2c_f32_bf16 v35, v121, v121
    v_dot2c_f32_bf16 v32, v122, v36
    v_dot2c_f32_bf16 v34, v122, v122
    v_dot2c_f32_bf16 v33, v123, v36
    v_dot2c_f32_bf16 v35, v123, v123
    v_dot2c_f32_bf16 v32, v124, v36
    v_dot2c_f32_bf16 v34, v124, v124
    v_dot2c_f32_bf16 v33, v125, v36
    v_dot2c_f32_bf16 v35, v125, v125
    v_dot2c_f32_bf16 v32, v126, v36
    v_dot2c_f32_bf16 v34, v126, v126
    v_dot2c_f32_bf16 v33, v127, v36
    v_dot2c_f32_bf16 v35, v127, v127
    s_waitcnt lgkmcnt(0)
    buffer_load_dword v202, v61, s[4:7], 0 offen sc1
    s_waitcnt vmcnt(5)
    ds_read_b128 v[144:147], v56 offset:4096
    ds_read_b128 v[148:151], v57 offset:4096
    ds_read_b128 v[152:155], v58 offset:4096
    ds_read_b128 v[156:159], v59 offset:4096
    v_dot2c_f32_bf16 v32, v128, v36
    v_dot2c_f32_bf16 v34, v128, v128
    v_dot2c_f32_bf16 v33, v129, v36
    v_dot2c_f32_bf16 v35, v129, v129
    v_dot2c_f32_bf16 v32, v130, v36
    v_dot2c_f32_bf16 v34, v130, v130
    v_dot2c_f32_bf16 v33, v131, v36
    v_dot2c_f32_bf16 v35, v131, v131
    v_dot2c_f32_bf16 v32, v132, v36
    v_dot2c_f32_bf16 v34, v132, v132
    v_dot2c_f32_bf16 v33, v133, v36
    v_dot2c_f32_bf16 v35, v133, v133
    v_dot2c_f32_bf16 v32, v134, v36
    v_dot2c_f32_bf16 v34, v134, v134
    v_dot2c_f32_bf16 v33, v135, v36
    v_dot2c_f32_bf16 v35, v135, v135
    v_dot2c_f32_bf16 v32, v136, v36
    v_dot2c_f32_bf16 v34, v136, v136
    v_dot2c_f32_bf16 v33, v137, v36
    v_dot2c_f32_bf16 v35, v137, v137
    v_dot2c_f32_bf16 v32, v138, v36
    v_dot2c_f32_bf16 v34, v138, v138
    v_dot2c_f32_bf16 v33, v139, v36
    v_dot2c_f32_bf16 v35, v139, v139
    v_dot2c_f32_bf16 v32, v140, v36
    v_dot2c_f32_bf16 v34, v140, v140
    v_dot2c_f32_bf16 v33, v141, v36
    v_dot2c_f32_bf16 v35, v141, v141
    v_dot2c_f32_bf16 v32, v142, v36
    v_dot2c_f32_bf16 v34, v142, v142
    v_dot2c_f32_bf16 v33, v143, v36
    v_dot2c_f32_bf16 v35, v143, v143
    s_waitcnt lgkmcnt(0)
    s_waitcnt vmcnt(1)
    ds_read_b128 v[160:163], v56 offset:8192
    ds_read_b128 v[164:167], v57 offset:8192
    ds_read_b128 v[168:171], v58 offset:8192
    ds_read_b128 v[172:175], v59 offset:8192
    v_dot2c_f32_bf16 v32, v144, v36
    v_dot2c_f32_bf16 v34, v144, v144
    v_dot2c_f32_bf16 v33, v145, v36
    v_dot2c_f32_bf16 v35, v145, v145
    v_dot2c_f32_bf16 v32, v146, v36
    v_dot2c_f32_bf16 v34, v146, v146
    v_dot2c_f32_bf16 v33, v147, v36
    v_dot2c_f32_bf16 v35, v147, v147
    v_dot2c_f32_bf16 v32, v148, v36
    v_dot2c_f32_bf16 v34, v148, v148
    v_dot2c_f32_bf16 v33, v149, v36
    v_dot2c_f32_bf16 v35, v149, v149
    v_dot2c_f32_bf16 v32, v150, v36
    v_dot2c_f32_bf16 v34, v150, v150
    v_dot2c_f32_bf16 v33, v151, v36
    v_dot2c_f32_bf16 v35, v151, v151
    v_dot2c_f32_bf16 v32, v152, v36
    v_dot2c_f32_bf16 v34, v152, v152
    v_dot2c_f32_bf16 v33, v153, v36
    v_dot2c_f32_bf16 v35, v153, v153
    v_dot2c_f32_bf16 v32, v154, v36
    v_dot2c_f32_bf16 v34, v154, v154
    v_dot2c_f32_bf16 v33, v155, v36
    v_dot2c_f32_bf16 v35, v155, v155
    v_dot2c_f32_bf16 v32, v156, v36
    v_dot2c_f32_bf16 v34, v156, v156
    v_dot2c_f32_bf16 v33, v157, v36
    v_dot2c_f32_bf16 v35, v157, v157
    v_dot2c_f32_bf16 v32, v158, v36
    v_dot2c_f32_bf16 v34, v158, v158
    v_dot2c_f32_bf16 v33, v159, v36
    v_dot2c_f32_bf16 v35, v159, v159
    s_waitcnt lgkmcnt(0)
    s_add_u32 s22, s3, 0
    s_mov_b32 s74, 0
L_poll_5:
    s_waitcnt vmcnt(0)
    v_subrev_u32 v202, s22, v202
    v_cmp_lt_u32 vcc, 31, v202
    s_and_b64 s[60:61], vcc, s[72:73]
    s_cbranch_scc0 L_poll_done_4
    buffer_load_dword v202, v61, s[4:7], 0 offen sc1
    s_add_u32 s74, s74, 1
    s_cmp_lt_u32 s74, 200000
    s_cbranch_scc1 L_poll_5
    s_waitcnt vmcnt(0)
L_poll_done_4:
    s_add_u32 m0, s92, 0
    s_add_u32 s70, s91, 0
    buffer_load_dwordx4 v1, s[4:7], s70 offen sc1 lds
    s_add_u32 m0, s92, 28672
    s_add_u32 s70, s91, 28672
    buffer_load_dwordx4 v1, s[4:7], s70 offen sc1 lds
    s_add_u32 m0, s92, 57344
    s_add_u32 s70, s91, 57344
    buffer_load_dwordx4 v1, s[4:7], s70 offen sc1 lds
    s_add_u32 m0, s92, 4096
    s_add_u32 s70, s91, 4096
    buffer_load_dwordx4 v1, s[4:7], s70 offen sc1 lds
    s_add_u32 m0, s92, 32768
    s_add_u32 s70, s91, 32768
    buffer_load_dwordx4 v1, s[4:7], s70 offen sc1 lds
    s_add_u32 m0, s92, 61440
    s_add_u32 s70, s91, 61440
    buffer_load_dwordx4 v1, s[4:7], s70 offen sc1 lds
    s_add_u32 m0, s92, 8192
    s_add_u32 s70, s91, 8192
    buffer_load_dwordx4 v1, s[4:7], s70 offen sc1 lds
    s_add_u32 m0, s92, 36864
    s_add_u32 s70, s91, 36864
    buffer_load_dwordx4 v1, s[4:7], s70 offen sc1 lds
    s_add_u32 m0, s92, 65536
    s_add_u32 s70, s91, 65536
    buffer_load_dwordx4 v1, s[4:7], s70 offen sc1 lds
    v_dot2c_f32_bf16 v32, v160, v36
    v_dot2c_f32_bf16 v34, v160, v160
    v_dot2c_f32_bf16 v33, v161, v36
    v_dot2c_f32_bf16 v35, v161, v161
    v_dot2c_f32_bf16 v32, v162, v36
    v_dot2c_f32_bf16 v34, v162, v162
    v_dot2c_f32_bf16 v33, v163, v36
    v_dot2c_f32_bf16 v35, v163, v163
    v_dot2c_f32_bf16 v32, v164, v36
    v_dot2c_f32_bf16 v34, v164, v164
    v_dot2c_f32_bf16 v33, v165, v36
    v_dot2c_f32_bf16 v35, v165, v165
    v_dot2c_f32_bf16 v32, v166, v36
    v_dot2c_f32_bf16 v34, v166, v166
    v_dot2c_f32_bf16 v33, v167, v36
    v_dot2c_f32_bf16 v35, v167, v167
    v_dot2c_f32_bf16 v32, v168, v36
    v_dot2c_f32_bf16 v34, v168, v168
    v_dot2c_f32_bf16 v33, v169, v36
    v_dot2c_f32_bf16 v35, v169, v169
    v_dot2c_f32_bf16 v32, v170, v36
    v_dot2c_f32_bf16 v34, v170, v170
    v_dot2c_f32_bf16 v33, v171, v36
    v_dot2c_f32_bf16 v35, v171, v171
    v_dot2c_f32_bf16 v32, v172, v36
    v_dot2c_f32_bf16 v34, v172, v172
    v_dot2c_f32_bf16 v33, v173, v36
    v_dot2c_f32_bf16 v35, v173, v173
    v_dot2c_f32_bf16 v32, v174, v36
    v_dot2c_f32_bf16 v34, v174, v174
    v_dot2c_f32_bf16 v33, v175, v36
    v_dot2c_f32_bf16 v35, v175, v175
    s_nop 1
    s_lshl_b32 s60, s41, 8
    s_add_u32 s60, s60, 131584
    v_lshl_add_u32 v9, v0, 2, s60
    s_sub_u32 s60, s60, 131072
    v_add_u32 v10, s60, v201
    v_and_b32 v8, 31, v0
    v_lshlrev_b32 v8, 2, v8
    v_add_u32 v8, 131328, v8
    v_add_f32 v32, v32, v33
    v_add_f32 v33, v34, v35
    s_nop 1
    v_permlane32_swap_b32 v32, v33
    v_add_f32 v32, v32, v33
    v_mov_b32 v33, v32
    s_nop 1
    v_permlane32_swap_b32 v33, v32
    v_mul_f32 v12, 0x3b124925, v33
    v_mul_f32 v32, 0x3b124925, v32
    v_fma_f32 v33, -v12, v12, v32
    v_max_f32 v33, 0, v33
    v_add_f32 v33, 0x3727c5ac, v33
    v_rsq_f32 v46, v33
    v_sub_f32 v47, 0, v12
    v_cmp_gt_u32 vcc, 32, v0
    v_mul_f32 v48, 0x3e8b97f6, v46
    v_mul_f32 v49, v47, v46
    v_cndmask_b32 v49, v49, v46, vcc
    s_waitcnt vmcnt(6)
    s_barrier
    ds_write_b32 v9, v49
    ds_read_b64_tr_b16 a[128:129], v14 offset:0
    ds_read_b64_tr_b16 a[130:131], v14 offset:256
    ds_read_b64_tr_b16 a[132:133], v15 offset:0
    ds_read_b64_tr_b16 a[134:135], v15 offset:256
    ds_read_b64_tr_b16 a[136:137], v11 offset:0
    ds_read_b64_tr_b16 a[138:139], v11 offset:256
    ds_read_b64_tr_b16 a[140:141], v60 offset:0
    ds_read_b64_tr_b16 a[142:143], v60 offset:1024
    ds_read_b64_tr_b16 a[144:145], v14 offset:1024
    ds_read_b64_tr_b16 a[146:147], v14 offset:1280
    ds_read_b64_tr_b16 a[148:149], v15 offset:1024
    ds_read_b64_tr_b16 a[150:151], v15 offset:1280
    ds_read_b64_tr_b16 a[152:153], v11 offset:1024
    ds_read_b64_tr_b16 a[154:155], v11 offset:1280
    s_waitcnt lgkmcnt(10)
    ds_read_b64_tr_b16 a[156:157], v60 offset:32
    ds_read_b64_tr_b16 a[158:159], v60 offset:1056
    s_waitcnt lgkmcnt(8)
    v_mfma_f32_32x32x16_bf16 v[176:191], a[128:131], v[64:67], 0
    ds_read_b64_tr_b16 a[160:161], v14 offset:2048
    ds_read_b64_tr_b16 a[162:163], v14 offset:2304
    v_mfma_f32_32x32x16_bf16 v[208:223], a[132:135], v[64:67], 0
    ds_read_b64_tr_b16 a[164:165], v15 offset:2048
    ds_read_b64_tr_b16 a[166:167], v15 offset:2304
    s_add_u32 m0, s92, 12288
    s_add_u32 s70, s91, 12288
    buffer_load_dwordx4 v1, s[4:7], s70 offen sc1 lds
    v_mfma_f32_32x32x16_bf16 v[224:239], v[64:67], a[136:139], 0
    ds_read_b64_tr_b16 a[168:169], v11 offset:2048
    ds_read_b64_tr_b16 a[170:171], v11 offset:2304
    v_mfma_f32_16x16x32_bf16 a[180:183], a[140:143], a[176:179], 0
    ds_read_b64_tr_b16 a[172:173], v60 offset:2048
    s_waitcnt lgkmcnt(10)
    ds_read_b64_tr_b16 a[174:175], v60 offset:3072
    s_waitcnt lgkmcnt(8)
    v_mfma_f32_32x32x16_bf16 v[176:191], a[144:147], v[68:71], v[176:191]
    ds_read_b64_tr_b16 a[128:129], v14 offset:3072
    ds_read_b64_tr_b16 a[130:131], v14 offset:3328
    v_mfma_f32_32x32x16_bf16 v[208:223], a[148:151], v[68:71], v[208:223]
    ds_read_b64_tr_b16 a[132:133], v15 offset:3072
    ds_read_b64_tr_b16 a[134:135], v15 offset:3328
    s_add_u32 m0, s92, 40960
    s_add_u32 s70, s91, 40960
    buffer_load_dwordx4 v1, s[4:7], s70 offen sc1 lds
    v_mfma_f32_32x32x16_bf16 v[224:239], v[68:71], a[152:155], v[224:239]
    ds_read_b64_tr_b16 a[136:137], v11 offset:3072
    ds_read_b64_tr_b16 a[138:139], v11 offset:3328
    v_mfma_f32_16x16x32_bf16 a[184:187], a[156:159], a[176:179], 0
    ds_read_b64_tr_b16 a[140:141], v60 offset:2080
    s_waitcnt lgkmcnt(10)
    ds_read_b64_tr_b16 a[142:143], v60 offset:3104
    s_waitcnt vmcnt(5)
    s_barrier
    s_waitcnt lgkmcnt(8)
    v_mfma_f32_32x32x16_bf16 v[176:191], a[160:163], v[72:75], v[176:191]
    ds_read_b64_tr_b16 a[144:145], v14 offset:4096
    ds_read_b64_tr_b16 a[146:147], v14 offset:4352
    v_mfma_f32_32x32x16_bf16 v[208:223], a[164:167], v[72:75], v[208:223]
    ds_read_b64_tr_b16 a[148:149], v15 offset:4096
    ds_read_b64_tr_b16 a[150:151], v15 offset:4352
    s_add_u32 m0, s92, 69632
    s_add_u32 s70, s91, 69632
    buffer_load_dwordx4 v1, s[4:7], s70 offen sc1 lds
    v_mfma_f32_32x32x16_bf16 v[224:239], v[72:75], a[168:171], v[224:239]
    ds_read_b64_tr_b16 a[152:153], v11 offset:4096
    ds_read_b64_tr_b16 a[154:155], v11 offset:4352
    v_mfma_f32_16x16x32_bf16 a[180:183], a[172:175], a[176:179], a[180:183]
    ds_read_b64_tr_b16 a[156:157], v60 offset:4096
    s_waitcnt lgkmcnt(10)
    ds_read_b64_tr_b16 a[158:159], v60 offset:5120
    s_waitcnt lgkmcnt(8)
    v_mfma_f32_32x32x16_bf16 v[176:191], a[128:131], v[76:79], v[176:191]
    ds_read_b64_tr_b16 a[160:161], v14 offset:5120
    ds_read_b64_tr_b16 a[162:163], v14 offset:5376
    v_mfma_f32_32x32x16_bf16 v[208:223], a[132:135], v[76:79], v[208:223]
    ds_read_b64_tr_b16 a[164:165], v15 offset:5120
    ds_read_b64_tr_b16 a[166:167], v15 offset:5376
    v_mfma_f32_32x32x16_bf16 v[224:239], v[76:79], a[136:139], v[224:239]
    ds_read_b64_tr_b16 a[168:169], v11 offset:5120
    ds_read_b64_tr_b16 a[170:171], v11 offset:5376
    v_mfma_f32_16x16x32_bf16 a[184:187], a[140:143], a[176:179], a[184:187]
    ds_read_b64_tr_b16 a[172:173], v60 offset:4128
    s_waitcnt lgkmcnt(10)
    ds_read_b64_tr_b16 a[174:175], v60 offset:5152
    s_waitcnt lgkmcnt(8)
    v_mfma_f32_32x32x16_bf16 v[176:191], a[144:147], v[80:83], v[176:191]
    ds_read_b64_tr_b16 a[128:129], v14 offset:6144
    ds_read_b64_tr_b16 a[130:131], v14 offset:6400
    v_mfma_f32_32x32x16_bf16 v[208:223], a[148:151], v[80:83], v[208:223]
    ds_read_b64_tr_b16 a[132:133], v15 offset:6144
    ds_read_b64_tr_b16 a[134:135], v15 offset:6400
    s_add_u32 m0, s92, 16384
    s_add_u32 s70, s91, 16384
    buffer_load_dwordx4 v1, s[4:7], s70 offen sc1 lds
    v_mfma_f32_32x32x16_bf16 v[224:239], v[80:83], a[152:155], v[224:239]
    ds_read_b64_tr_b16 a[136:137], v11 offset:6144
    ds_read_b64_tr_b16 a[138:139], v11 offset:6400
    v_mfma_f32_16x16x32_bf16 a[180:183], a[156:159], a[176:179], a[180:183]
    ds_read_b64_tr_b16 a[140:141], v60 offset:6144
    s_waitcnt lgkmcnt(10)
    ds_read_b64_tr_b16 a[142:143], v60 offset:7168
    s_waitcnt lgkmcnt(8)
    v_mfma_f32_32x32x16_bf16 v[176:191], a[160:163], v[84:87], v[176:191]
    ds_read_b64_tr_b16 a[144:145], v14 offset:7168
    ds_read_b64_tr_b16 a[146:147], v14 offset:7424
    v_mfma_f32_32x32x16_bf16 v[208:223], a[164:167], v[84:87], v[208:223]
    ds_read_b64_tr_b16 a[148:149], v15 offset:7168
    ds_read_b64_tr_b16 a[150:151], v15 offset:7424
    s_add_u32 m0, s92, 45056
    s_add_u32 s70, s91, 45056
    buffer_load_dwordx4 v1, s[4:7], s70 offen sc1 lds
    v_mfma_f32_32x32x16_bf16 v[224:239], v[84:87], a[168:171], v[224:239]
    ds_read_b64_tr_b16 a[152:153], v11 offset:7168
    ds_read_b64_tr_b16 a[154:155], v11 offset:7424
    v_mfma_f32_16x16x32_bf16 a[184:187], a[172:175], a[176:179], a[184:187]
    ds_read_b64_tr_b16 a[156:157], v60 offset:6176
    s_waitcnt lgkmcnt(10)
    ds_read_b64_tr_b16 a[158:159], v60 offset:7200
    s_waitcnt vmcnt(5)
    s_barrier
    s_waitcnt lgkmcnt(8)
    v_mfma_f32_32x32x16_bf16 v[176:191], a[128:131], v[88:91], v[176:191]
    ds_read_b64_tr_b16 a[160:161], v14 offset:8192
    ds_read_b64_tr_b16 a[162:163], v14 offset:8448
    v_mfma_f32_32x32x16_bf16 v[208:223], a[132:135], v[88:91], v[208:223]
    ds_read_b64_tr_b16 a[164:165], v15 offset:8192
    ds_read_b64_tr_b16 a[166:167], v15 offset:8448
    s_add_u32 m0, s92, 73728
    s_add_u32 s70, s91, 73728
    buffer_load_dwordx4 v1, s[4:7], s70 offen sc1 lds
    v_mfma_f32_32x32x16_bf16 v[224:239], v[88:91], a[136:139], v[224:239]
    ds_read_b64_tr_b16 a[168:169], v11 offset:8192
    ds_read_b64_tr_b16 a[170:171], v11 offset:8448
    v_mfma_f32_16x16x32_bf16 a[180:183], a[140:143], a[176:179], a[180:183]
    ds_read_b64_tr_b16 a[172:173], v60 offset:8192
    s_waitcnt lgkmcnt(10)
    ds_read_b64_tr_b16 a[174:175], v60 offset:9216
    s_waitcnt lgkmcnt(8)
    v_mfma_f32_32x32x16_bf16 v[176:191], a[144:147], v[92:95], v[176:191]
    ds_read_b64_tr_b16 a[128:129], v14 offset:9216
    ds_read_b64_tr_b16 a[130:131], v14 offset:9472
    v_mfma_f32_32x32x16_bf16 v[208:223], a[148:151], v[92:95], v[208:223]
    ds_read_b64_tr_b16 a[132:133], v15 offset:9216
    ds_read_b64_tr_b16 a[134:135], v15 offset:9472
    v_mfma_f32_32x32x16_bf16 v[224:239], v[92:95], a[152:155], v[224:239]
    ds_read_b64_tr_b16 a[136:137], v11 offset:9216
    ds_read_b64_tr_b16 a[138:139], v11 offset:9472
    v_mfma_f32_16x16x32_bf16 a[184:187], a[156:159], a[176:179], a[184:187]
    ds_read_b64_tr_b16 a[140:141], v60 offset:8224
    s_waitcnt lgkmcnt(10)
    ds_read_b64_tr_b16 a[142:143], v60 offset:9248
    s_waitcnt lgkmcnt(8)
    v_mfma_f32_32x32x16_bf16 v[176:191], a[160:163], v[96:99], v[176:191]
    ds_read_b64_tr_b16 a[144:145], v14 offset:10240
    ds_read_b64_tr_b16 a[146:147], v14 offset:10496
    v_mfma_f32_32x32x16_bf16 v[208:223], a[164:167], v[96:99], v[208:223]
    ds_read_b64_tr_b16 a[148:149], v15 offset:10240
    ds_read_b64_tr_b16 a[150:151], v15 offset:10496
    s_add_u32 m0, s92, 20480
    s_add_u32 s70, s91, 20480
    buffer_load_dwordx4 v1, s[4:7], s70 offen sc1 lds
    v_mfma_f32_32x32x16_bf16 v[224:239], v[96:99], a[168:171], v[224:239]
    ds_read_b64_tr_b16 a[152:153], v11 offset:10240
    ds_read_b64_tr_b16 a[154:155], v11 offset:10496
    v_mfma_f32_16x16x32_bf16 a[180:183], a[172:175], a[176:179], a[180:183]
    ds_read_b64_tr_b16 a[156:157], v60 offset:10240
    s_waitcnt lgkmcnt(10)
    ds_read_b64_tr_b16 a[158:159], v60 offset:11264
    s_waitcnt lgkmcnt(8)
    v_mfma_f32_32x32x16_bf16 v[176:191], a[128:131], v[100:103], v[176:191]
    ds_read_b64_tr_b16 a[160:161], v14 offset:11264
    ds_read_b64_tr_b16 a[162:163], v14 offset:11520
    v_mfma_f32_32x32x16_bf16 v[208:223], a[132:135], v[100:103], v[208:223]
    ds_read_b64_tr_b16 a[164:165], v15 offset:11264
    ds_read_b64_tr_b16 a[166:167], v15 offset:11520
    s_add_u32 m0, s92, 49152
    s_add_u32 s70, s91, 49152
    buffer_load_dwordx4 v1, s[4:7], s70 offen sc1 lds
    v_mfma_f32_32x32x16_bf16 v[224:239], v[100:103], a[136:139], v[224:239]
    ds_read_b64_tr_b16 a[168:169], v11 offset:11264
    ds_read_b64_tr_b16 a[170:171], v11 offset:11520
    v_mfma_f32_16x16x32_bf16 a[184:187], a[140:143], a[176:179], a[184:187]
    ds_read_b64_tr_b16 a[172:173], v60 offset:10272
    s_waitcnt lgkmcnt(10)
    ds_read_b64_tr_b16 a[174:175], v60 offset:11296
    s_waitcnt vmcnt(5)
    s_barrier
    s_waitcnt lgkmcnt(8)
    v_mfma_f32_32x32x16_bf16 v[176:191], a[144:147], v[104:107], v[176:191]
    ds_read_b64_tr_b16 a[128:129], v14 offset:12288
    ds_read_b64_tr_b16 a[130:131], v14 offset:12544
    v_mfma_f32_32x32x16_bf16 v[208:223], a[148:151], v[104:107], v[208:223]
    ds_read_b64_tr_b16 a[132:133], v15 offset:12288
    ds_read_b64_tr_b16 a[134:135], v15 offset:12544
    s_add_u32 m0, s92, 77824
    s_add_u32 s70, s91, 77824
    buffer_load_dwordx4 v1, s[4:7], s70 offen sc1 lds
    v_mfma_f32_32x32x16_bf16 v[224:239], v[104:107], a[152:155], v[224:239]
    ds_read_b64_tr_b16 a[136:137], v11 offset:12288
    ds_read_b64_tr_b16 a[138:139], v11 offset:12544
    v_mfma_f32_16x16x32_bf16 a[180:183], a[156:159], a[176:179], a[180:183]
    ds_read_b64_tr_b16 a[140:141], v60 offset:12288
    s_waitcnt lgkmcnt(10)
    ds_read_b64_tr_b16 a[142:143], v60 offset:13312
    s_waitcnt lgkmcnt(8)
    v_mfma_f32_32x32x16_bf16 v[176:191], a[160:163], v[108:111], v[176:191]
    ds_read_b64_tr_b16 a[144:145], v14 offset:13312
    ds_read_b64_tr_b16 a[146:147], v14 offset:13568
    v_mfma_f32_32x32x16_bf16 v[208:223], a[164:167], v[108:111], v[208:223]
    ds_read_b64_tr_b16 a[148:149], v15 offset:13312
    ds_read_b64_tr_b16 a[150:151], v15 offset:13568
    v_mfma_f32_32x32x16_bf16 v[224:239], v[108:111], a[168:171], v[224:239]
    ds_read_b64_tr_b16 a[152:153], v11 offset:13312
    ds_read_b64_tr_b16 a[154:155], v11 offset:13568
    v_mfma_f32_16x16x32_bf16 a[184:187], a[172:175], a[176:179], a[184:187]
    ds_read_b64_tr_b16 a[156:157], v60 offset:12320
    s_waitcnt lgkmcnt(10)
    ds_read_b64_tr_b16 a[158:159], v60 offset:13344
    s_waitcnt lgkmcnt(8)
    v_mfma_f32_32x32x16_bf16 v[176:191], a[128:131], v[112:115], v[176:191]
    ds_read_b64_tr_b16 a[160:161], v14 offset:14336
    ds_read_b64_tr_b16 a[162:163], v14 offset:14592
    v_mfma_f32_32x32x16_bf16 v[208:223], a[132:135], v[112:115], v[208:223]
    ds_read_b64_tr_b16 a[164:165], v15 offset:14336
    ds_read_b64_tr_b16 a[166:167], v15 offset:14592
    s_add_u32 m0, s92, 24576
    s_add_u32 s70, s91, 24576
    buffer_load_dwordx4 v1, s[4:7], s70 offen sc1 lds
    v_mfma_f32_32x32x16_bf16 v[224:239], v[112:115], a[136:139], v[224:239]
    ds_read_b64_tr_b16 a[168:169], v11 offset:14336
    ds_read_b64_tr_b16 a[170:171], v11 offset:14592
    v_mfma_f32_16x16x32_bf16 a[180:183], a[140:143], a[176:179], a[180:183]
    ds_read_b64_tr_b16 a[172:173], v60 offset:14336
    s_waitcnt lgkmcnt(10)
    ds_read_b64_tr_b16 a[174:175], v60 offset:15360
    s_waitcnt lgkmcnt(8)
    v_mfma_f32_32x32x16_bf16 v[176:191], a[144:147], v[116:119], v[176:191]
    ds_read_b64_tr_b16 a[128:129], v14 offset:15360
    ds_read_b64_tr_b16 a[130:131], v14 offset:15616
    v_mfma_f32_32x32x16_bf16 v[208:223], a[148:151], v[116:119], v[208:223]
    ds_read_b64_tr_b16 a[132:133], v15 offset:15360
    ds_read_b64_tr_b16 a[134:135], v15 offset:15616
    s_add_u32 m0, s92, 53248
    s_add_u32 s70, s91, 53248
    buffer_load_dwordx4 v1, s[4:7], s70 offen sc1 lds
    v_mfma_f32_32x32x16_bf16 v[224:239], v[116:119], a[152:155], v[224:239]
    ds_read_b64_tr_b16 a[136:137], v11 offset:15360
    ds_read_b64_tr_b16 a[138:139], v11 offset:15616
    v_mfma_f32_16x16x32_bf16 a[184:187], a[156:159], a[176:179], a[184:187]
    ds_read_b64_tr_b16 a[140:141], v60 offset:14368
    s_waitcnt lgkmcnt(10)
    ds_read_b64_tr_b16 a[142:143], v60 offset:15392
    s_waitcnt vmcnt(5)
    s_barrier
    s_waitcnt lgkmcnt(8)
    v_mfma_f32_32x32x16_bf16 v[176:191], a[160:163], v[120:123], v[176:191]
    ds_read_b64_tr_b16 a[144:145], v14 offset:16384
    ds_read_b64_tr_b16 a[146:147], v14 offset:16640
    v_mfma_f32_32x32x16_bf16 v[208:223], a[164:167], v[120:123], v[208:223]
    ds_read_b64_tr_b16 a[148:149], v15 offset:16384
    ds_read_b64_tr_b16 a[150:151], v15 offset:16640
    s_add_u32 m0, s92, 81920
    s_add_u32 s70, s91, 81920
    buffer_load_dwordx4 v1, s[4:7], s70 offen sc1 lds
    v_mfma_f32_32x32x16_bf16 v[224:239], v[120:123], a[168:171], v[224:239]
    ds_read_b64_tr_b16 a[152:153], v11 offset:16384
    ds_read_b64_tr_b16 a[154:155], v11 offset:16640
    v_mfma_f32_16x16x32_bf16 a[180:183], a[172:175], a[176:179], a[180:183]
    ds_read_b64_tr_b16 a[156:157], v60 offset:16384
    s_waitcnt lgkmcnt(10)
    ds_read_b64_tr_b16 a[158:159], v60 offset:17408
    s_waitcnt lgkmcnt(8)
    v_mfma_f32_32x32x16_bf16 v[176:191], a[128:131], v[124:127], v[176:191]
    ds_read_b64_tr_b16 a[160:161], v14 offset:17408
    ds_read_b64_tr_b16 a[162:163], v14 offset:17664
    v_mfma_f32_32x32x16_bf16 v[208:223], a[132:135], v[124:127], v[208:223]
    ds_read_b64_tr_b16 a[164:165], v15 offset:17408
    ds_read_b64_tr_b16 a[166:167], v15 offset:17664
    v_mfma_f32_32x32x16_bf16 v[224:239], v[124:127], a[136:139], v[224:239]
    ds_read_b64_tr_b16 a[168:169], v11 offset:17408
    ds_read_b64_tr_b16 a[170:171], v11 offset:17664
    v_mfma_f32_16x16x32_bf16 a[184:187], a[140:143], a[176:179], a[184:187]
    ds_read_b64_tr_b16 a[172:173], v60 offset:16416
    s_waitcnt lgkmcnt(10)
    ds_read_b64_tr_b16 a[174:175], v60 offset:17440
    s_waitcnt lgkmcnt(8)
    v_mfma_f32_32x32x16_bf16 v[176:191], a[144:147], v[128:131], v[176:191]
    ds_read_b64_tr_b16 a[128:129], v14 offset:18432
    ds_read_b64_tr_b16 a[130:131], v14 offset:18688
    v_mfma_f32_32x32x16_bf16 v[208:223], a[148:151], v[128:131], v[208:223]
    ds_read_b64_tr_b16 a[132:133], v15 offset:18432
    ds_read_b64_tr_b16 a[134:135], v15 offset:18688
    v_mov_b32 v63, 0
    s_mov_b64 exec, 0xff
    buffer_store_dword v63, v62, s[4:7], s23 offen sc1
    buffer_store_dword v38, v37, s[4:7], 0 offen sc1
    s_mov_b64 exec, -1
    v_mfma_f32_32x32x16_bf16 v[224:239], v[128:131], a[152:155], v[224:239]
    ds_read_b64_tr_b16 a[136:137], v11 offset:18432
    ds_read_b64_tr_b16 a[138:139], v11 offset:18688
    v_mfma_f32_16x16x32_bf16 a[180:183], a[156:159], a[176:179], a[180:183]
    ds_read_b64_tr_b16 a[140:141], v60 offset:18432
    s_waitcnt lgkmcnt(10)
    ds_read_b64_tr_b16 a[142:143], v60 offset:19456
    s_waitcnt lgkmcnt(8)
    v_mfma_f32_32x32x16_bf16 v[176:191], a[160:163], v[132:135], v[176:191]
    ds_read_b64_tr_b16 a[144:145], v14 offset:19456
    ds_read_b64_tr_b16 a[146:147], v14 offset:19712
    v_mfma_f32_32x32x16_bf16 v[208:223], a[164:167], v[132:135], v[208:223]
    ds_read_b64_tr_b16 a[148:149], v15 offset:19456
    ds_read_b64_tr_b16 a[150:151], v15 offset:19712
    v_mfma_f32_32x32x16_bf16 v[224:239], v[132:135], a[168:171], v[224:239]
    ds_read_b64_tr_b16 a[152:153], v11 offset:19456
    ds_read_b64_tr_b16 a[154:155], v11 offset:19712
    v_mfma_f32_16x16x32_bf16 a[184:187], a[172:175], a[176:179], a[184:187]
    ds_read_b64_tr_b16 a[156:157], v60 offset:18464
    s_waitcnt lgkmcnt(10)
    ds_read_b64_tr_b16 a[158:159], v60 offset:19488
    s_waitcnt vmcnt(5)
    s_barrier
    s_waitcnt lgkmcnt(8)
    v_mfma_f32_32x32x16_bf16 v[176:191], a[128:131], v[136:139], v[176:191]
    ds_read_b64_tr_b16 a[160:161], v14 offset:20480
    ds_read_b64_tr_b16 a[162:163], v14 offset:20736
    v_mfma_f32_32x32x16_bf16 v[208:223], a[132:135], v[136:139], v[208:223]
    ds_read_b64_tr_b16 a[164:165], v15 offset:20480
    ds_read_b64_tr_b16 a[166:167], v15 offset:20736
    v_mfma_f32_32x32x16_bf16 v[224:239], v[136:139], a[136:139], v[224:239]
    ds_read_b64_tr_b16 a[168:169], v11 offset:20480
    ds_read_b64_tr_b16 a[170:171], v11 offset:20736
    v_mfma_f32_16x16x32_bf16 a[180:183], a[140:143], a[176:179], a[180:183]
    ds_read_b64_tr_b16 a[172:173], v60 offset:20480
    s_waitcnt lgkmcnt(10)
    ds_read_b64_tr_b16 a[174:175], v60 offset:21504
    s_waitcnt lgkmcnt(8)
    v_mfma_f32_32x32x16_bf16 v[176:191], a[144:147], v[140:143], v[176:191]
    ds_read_b64_tr_b16 a[128:129], v14 offset:21504
    ds_read_b64_tr_b16 a[130:131], v14 offset:21760
    v_mfma_f32_32x32x16_bf16 v[208:223], a[148:151], v[140:143], v[208:223]
    ds_read_b64_tr_b16 a[132:133], v15 offset:21504
    ds_read_b64_tr_b16 a[134:135], v15 offset:21760
    v_mfma_f32_32x32x16_bf16 v[224:239], v[140:143], a[152:155], v[224:239]
    ds_read_b64_tr_b16 a[136:137], v11 offset:21504
    ds_read_b64_tr_b16 a[138:139], v11 offset:21760
    v_mfma_f32_16x16x32_bf16 a[184:187], a[156:159], a[176:179], a[184:187]
    ds_read_b64_tr_b16 a[140:141], v60 offset:20512
    s_waitcnt lgkmcnt(10)
    ds_read_b64_tr_b16 a[142:143], v60 offset:21536
    s_waitcnt lgkmcnt(8)
    v_mfma_f32_32x32x16_bf16 v[176:191], a[160:163], v[144:147], v[176:191]
    ds_read_b64_tr_b16 a[144:145], v14 offset:22528
    ds_read_b64_tr_b16 a[146:147], v14 offset:22784
    v_mfma_f32_32x32x16_bf16 v[208:223], a[164:167], v[144:147], v[208:223]
    ds_read_b64_tr_b16 a[148:149], v15 offset:22528
    ds_read_b64_tr_b16 a[150:151], v15 offset:22784
    v_mfma_f32_32x32x16_bf16 v[224:239], v[144:147], a[168:171], v[224:239]
    ds_read_b64_tr_b16 a[152:153], v11 offset:22528
    ds_read_b64_tr_b16 a[154:155], v11 offset:22784
    v_mfma_f32_16x16x32_bf16 a[180:183], a[172:175], a[176:179], a[180:183]
    ds_read_b64_tr_b16 a[156:157], v60 offset:22528
    s_waitcnt lgkmcnt(10)
    ds_read_b64_tr_b16 a[158:159], v60 offset:23552
    ds_read_b128 v[96:99], v10 offset:0
    s_waitcnt lgkmcnt(9)
    v_mfma_f32_32x32x16_bf16 v[176:191], a[128:131], v[148:151], v[176:191]
    ds_read_b64_tr_b16 a[160:161], v14 offset:23552
    ds_read_b64_tr_b16 a[162:163], v14 offset:23808
    v_mfma_f32_32x32x16_bf16 v[208:223], a[132:135], v[148:151], v[208:223]
    ds_read_b64_tr_b16 a[164:165], v15 offset:23552
    ds_read_b64_tr_b16 a[166:167], v15 offset:23808
    v_mfma_f32_32x32x16_bf16 v[224:239], v[148:151], a[136:139], v[224:239]
    ds_read_b64_tr_b16 a[168:169], v11 offset:23552
    ds_read_b64_tr_b16 a[170:171], v11 offset:23808
    v_mfma_f32_16x16x32_bf16 a[184:187], a[140:143], a[176:179], a[184:187]
    s_waitcnt lgkmcnt(10)
    ds_read_b64_tr_b16 a[172:173], v60 offset:22560
    ds_read_b64_tr_b16 a[174:175], v60 offset:23584
    ds_read_b128 v[100:103], v10 offset:32
    s_waitcnt vmcnt(2)
    s_barrier
    s_waitcnt lgkmcnt(10)
    v_mfma_f32_32x32x16_bf16 v[176:191], a[144:147], v[152:155], v[176:191]
    ds_read_b64_tr_b16 a[128:129], v14 offset:24576
    ds_read_b64_tr_b16 a[130:131], v14 offset:24832
    v_mfma_f32_32x32x16_bf16 v[208:223], a[148:151], v[152:155], v[208:223]
    ds_read_b64_tr_b16 a[132:133], v15 offset:24576
    ds_read_b64_tr_b16 a[134:135], v15 offset:24832
    v_mfma_f32_32x32x16_bf16 v[224:239], v[152:155], a[152:155], v[224:239]
    ds_read_b64_tr_b16 a[136:137], v11 offset:24576
    s_waitcnt lgkmcnt(10)
    ds_read_b64_tr_b16 a[138:139], v11 offset:24832
    v_mfma_f32_16x16x32_bf16 a[180:183], a[156:159], a[176:179], a[180:183]
    ds_read_b64_tr_b16 a[140:141], v60 offset:24576
    ds_read_b64_tr_b16 a[142:143], v60 offset:25600
    ds_read_b128 v[104:107], v10 offset:64
    s_waitcnt lgkmcnt(10)
    v_mfma_f32_32x32x16_bf16 v[176:191], a[160:163], v[156:159], v[176:191]
    ds_read_b64_tr_b16 a[144:145], v14 offset:25600
    ds_read_b64_tr_b16 a[146:147], v14 offset:25856
    v_mfma_f32_32x32x16_bf16 v[208:223], a[164:167], v[156:159], v[208:223]
    ds_read_b64_tr_b16 a[148:149], v15 offset:25600
    ds_read_b64_tr_b16 a[150:151], v15 offset:25856
    v_mfma_f32_32x32x16_bf16 v[224:239], v[156:159], a[168:171], v[224:239]
    ds_read_b64_tr_b16 a[152:153], v11 offset:25600
    s_waitcnt lgkmcnt(10)
    ds_read_b64_tr_b16 a[154:155], v11 offset:25856
    v_mfma_f32_16x16x32_bf16 a[184:187], a[172:175], a[176:179], a[184:187]
    ds_read_b64_tr_b16 a[156:157], v60 offset:24608
    ds_read_b64_tr_b16 a[158:159], v60 offset:25632
    ds_read_b128 v[108:111], v10 offset:96
    s_waitcnt lgkmcnt(10)
    v_mfma_f32_32x32x16_bf16 v[176:191], a[128:131], v[160:163], v[176:191]
    ds_read_b64_tr_b16 a[160:161], v14 offset:26624
    ds_read_b64_tr_b16 a[162:163], v14 offset:26880
    v_mfma_f32_32x32x16_bf16 v[208:223], a[132:135], v[160:163], v[208:223]
    ds_read_b64_tr_b16 a[164:165], v15 offset:26624
    ds_read_b64_tr_b16 a[166:167], v15 offset:26880
    v_mfma_f32_32x32x16_bf16 v[224:239], v[160:163], a[136:139], v[224:239]
    ds_read_b64_tr_b16 a[168:169], v11 offset:26624
    s_waitcnt lgkmcnt(10)
    ds_read_b64_tr_b16 a[170:171], v11 offset:26880
    v_mfma_f32_16x16x32_bf16 a[180:183], a[140:143], a[176:179], a[180:183]
    ds_read_b64_tr_b16 a[172:173], v60 offset:26624
    ds_read_b64_tr_b16 a[174:175], v60 offset:27648
    ds_read_b128 v[112:115], v10 offset:128
    s_waitcnt lgkmcnt(10)
    v_mfma_f32_32x32x16_bf16 v[176:191], a[144:147], v[164:167], v[176:191]
    ds_read_b64_tr_b16 a[128:129], v14 offset:27648
    ds_read_b64_tr_b16 a[130:131], v14 offset:27904
    v_mfma_f32_32x32x16_bf16 v[208:223], a[148:151], v[164:167], v[208:223]
    ds_read_b64_tr_b16 a[132:133], v15 offset:27648
    ds_read_b64_tr_b16 a[134:135], v15 offset:27904
    v_mfma_f32_32x32x16_bf16 v[224:239], v[164:167], a[152:155], v[224:239]
    ds_read_b64_tr_b16 a[136:137], v11 offset:27648
    s_waitcnt lgkmcnt(10)
    ds_read_b64_tr_b16 a[138:139], v11 offset:27904
    v_mfma_f32_16x16x32_bf16 a[184:187], a[156:159], a[176:179], a[184:187]
    ds_read_b64_tr_b16 a[140:141], v60 offset:26656
    ds_read_b64_tr_b16 a[142:143], v60 offset:27680
    ds_read_b128 v[116:119], v10 offset:160
    s_waitcnt lgkmcnt(10)
    v_mfma_f32_32x32x16_bf16 v[176:191], a[160:163], v[168:171], v[176:191]
    v_mfma_f32_32x32x16_bf16 v[208:223], a[164:167], v[168:171], v[208:223]
    v_mfma_f32_32x32x16_bf16 v[224:239], v[168:171], a[168:171], v[224:239]
    v_mfma_f32_16x16x32_bf16 a[180:183], a[172:175], a[176:179], a[180:183]
    ds_read_b128 v[120:123], v10 offset:192
    s_waitcnt lgkmcnt(2)
    v_mfma_f32_32x32x16_bf16 v[176:191], a[128:131], v[172:175], v[176:191]
    v_mfma_f32_32x32x16_bf16 v[208:223], a[132:135], v[172:175], v[208:223]
    v_mfma_f32_32x32x16_bf16 v[224:239], v[172:175], a[136:139], v[224:239]
    v_mfma_f32_16x16x32_bf16 a[184:187], a[140:143], a[176:179], a[184:187]
    ds_read_b128 v[124:127], v10 offset:224
    s_lshl_b32 s60, s41, 7
    s_add_u32 s60, s60, 131072
    v_add_u32 v5, s60, v0
    s_mov_b32 exec_lo, 0x10001
    s_mov_b32 exec_hi, 0x10001
    s_nop 2
    ds_write_b128 v5, a[180:183] offset:0
    ds_write_b128 v5, a[184:187] offset:64
    s_mov_b64 exec, -1
    s_waitcnt lgkmcnt(0)
    s_barrier
    ds_read_b128 v[80:83], v201 offset:128
    ds_read_b128 v[84:87], v201 offset:160
    ds_read_b128 v[88:91], v201 offset:192
    ds_read_b128 v[92:95], v201 offset:224
    ds_read_b32 v50, v8
    ds_read_b128 v[64:67], v201 offset:0
    ds_read_b128 v[68:71], v201 offset:32
    ds_read_b128 v[72:75], v201 offset:64
    ds_read_b128 v[76:79], v201 offset:96
    s_waitcnt lgkmcnt(0)
L_kv:
    s_lshl_b32 s78, s43, 18
    s_mul_i32 s61, s38, 4194304
    s_add_u32 s78, s78, s61
    s_add_u32 s78, s78, 5242880
    s_lshl_b32 s88, s86, 12
    s_add_u32 s88, s88, s78
    v_mov_b32 v5, 0
    s_mov_b32 exec_lo, 0x10000000
    s_mov_b32 exec_hi, 0x10000000
    v_mov_b32 v5, 0x3f803f80
    s_mov_b64 exec, -1
    s_mov_b32 vcc_lo, 0xf0000000
    s_mov_b32 vcc_hi, 0xf0000000
    v_pk_fma_f32 v[208:209], v[46:47], v[80:81], v[208:209] op_sel:[1,0,0]
    v_pk_fma_f32 v[210:211], v[46:47], v[82:83], v[210:211] op_sel:[1,0,0]
    v_pk_fma_f32 v[212:213], v[46:47], v[84:85], v[212:213] op_sel:[1,0,0]
    v_pk_fma_f32 v[214:215], v[46:47], v[86:87], v[214:215] op_sel:[1,0,0]
    v_pk_fma_f32 v[216:217], v[46:47], v[88:89], v[216:217] op_sel:[1,0,0]
    v_pk_fma_f32 v[218:219], v[46:47], v[90:91], v[218:219] op_sel:[1,0,0]
    v_pk_fma_f32 v[220:221], v[46:47], v[92:93], v[220:221] op_sel:[1,0,0]
    v_pk_fma_f32 v[222:223], v[46:47], v[94:95], v[222:223] op_sel:[1,0,0]
    v_pk_mul_f32 v[208:209], v[208:209], v[46:47] op_sel_hi:[1,0]
    v_pk_mul_f32 v[210:211], v[210:211], v[46:47] op_sel_hi:[1,0]
    v_pk_mul_f32 v[212:213], v[212:213], v[46:47] op_sel_hi:[1,0]
    v_pk_mul_f32 v[214:215], v[214:215], v[46:47] op_sel_hi:[1,0]
    v_pk_mul_f32 v[216:217], v[216:217], v[46:47] op_sel_hi:[1,0]
    v_pk_mul_f32 v[218:219], v[218:219], v[46:47] op_sel_hi:[1,0]
    v_pk_mul_f32 v[220:221], v[220:221], v[46:47] op_sel_hi:[1,0]
    v_pk_mul_f32 v[222:223], v[222:223], v[46:47] op_sel_hi:[1,0]
    v_cvt_pk_bf16_f32 v136, v208, v209
    v_cvt_pk_bf16_f32 v137, v210, v211
    v_cvt_pk_bf16_f32 v138, v212, v213
    v_cvt_pk_bf16_f32 v139, v214, v215
    v_cvt_pk_bf16_f32 v140, v216, v217
    v_cvt_pk_bf16_f32 v141, v218, v219
    v_cvt_pk_bf16_f32 v142, v220, v221
    v_cvt_pk_bf16_f32 v143, v222, v223
    s_mov_b32 exec_lo, 0
    v_mov_b32 v142, 0x3f803f80
    v_mov_b32 v143, 0
    s_mov_b32 exec_lo, -1
    buffer_store_dwordx4 v[136:139], v1, s[4:7], s88 offen offset:0 sc1
    buffer_store_dwordx4 v[140:143], v1, s[4:7], s88 offen offset:1024 sc1
    v_pk_mul_f32 v[224:225], v[224:225], v[96:97]
    v_pk_mul_f32 v[226:227], v[226:227], v[98:99]
    v_pk_mul_f32 v[228:229], v[228:229], v[100:101]
    v_pk_mul_f32 v[230:231], v[230:231], v[102:103]
    v_pk_mul_f32 v[232:233], v[232:233], v[104:105]
    v_pk_mul_f32 v[234:235], v[234:235], v[106:107]
    v_pk_mul_f32 v[236:237], v[236:237], v[108:109]
    v_pk_mul_f32 v[238:239], v[238:239], v[110:111]
    v_pk_fma_f32 v[224:225], v[112:113], v[50:51], v[224:225] op_sel_hi:[1,0,1]
    v_pk_fma_f32 v[226:227], v[114:115], v[50:51], v[226:227] op_sel_hi:[1,0,1]
    v_pk_fma_f32 v[228:229], v[116:117], v[50:51], v[228:229] op_sel_hi:[1,0,1]
    v_pk_fma_f32 v[230:231], v[118:119], v[50:51], v[230:231] op_sel_hi:[1,0,1]
    v_pk_fma_f32 v[232:233], v[120:121], v[50:51], v[232:233] op_sel_hi:[1,0,1]
    v_pk_fma_f32 v[234:235], v[122:123], v[50:51], v[234:235] op_sel_hi:[1,0,1]
    v_pk_fma_f32 v[236:237], v[124:125], v[50:51], v[236:237] op_sel_hi:[1,0,1]
    v_pk_fma_f32 v[238:239], v[126:127], v[50:51], v[238:239] op_sel_hi:[1,0,1]
    v_cvt_pk_bf16_f32 v144, v224, v225
    v_cvt_pk_bf16_f32 v145, v226, v227
    v_cvt_pk_bf16_f32 v146, v228, v229
    v_cvt_pk_bf16_f32 v147, v230, v231
    v_cvt_pk_bf16_f32 v148, v232, v233
    v_cvt_pk_bf16_f32 v149, v234, v235
    v_cvt_pk_bf16_f32 v150, v236, v237
    v_cvt_pk_bf16_f32 v151, v238, v239
    v_cndmask_b32 v144, v144, v5, vcc
    v_cndmask_b32 v145, v145, v5, vcc
    v_cndmask_b32 v146, v146, v5, vcc
    v_cndmask_b32 v147, v147, v5, vcc
    v_cndmask_b32 v148, v148, v5, vcc
    v_cndmask_b32 v149, v149, v5, vcc
    v_cndmask_b32 v150, v150, v5, vcc
    v_cndmask_b32 v151, v151, v5, vcc
    buffer_store_dwordx4 v[144:147], v1, s[4:7], s88 offen offset:2048 sc1
    buffer_store_dwordx4 v[148:151], v1, s[4:7], s88 offen offset:3072 sc1
    s_cmp_lg_u32 s38, 0
    s_cbranch_scc1 L_noimg_6
    v_add_u32 v7, 131072, v1
    ds_read_b128 v[52:55], v7
    s_mul_i32 s61, s43, 90112
    s_add_u32 s61, s61, 13717504
    s_mov_b64 exec, 0xffffff
    s_waitcnt lgkmcnt(0)
    buffer_store_dwordx4 v[52:55], v1, s[4:7], s61 offen sc1
    s_mov_b64 exec, -1
L_noimg_6:
    v_pk_fma_f32 v[176:177], v[46:47], v[64:65], v[176:177] op_sel:[1,0,0]
    v_pk_fma_f32 v[178:179], v[46:47], v[66:67], v[178:179] op_sel:[1,0,0]
    v_pk_fma_f32 v[180:181], v[46:47], v[68:69], v[180:181] op_sel:[1,0,0]
    v_pk_fma_f32 v[182:183], v[46:47], v[70:71], v[182:183] op_sel:[1,0,0]
    v_pk_fma_f32 v[184:185], v[46:47], v[72:73], v[184:185] op_sel:[1,0,0]
    v_pk_fma_f32 v[186:187], v[46:47], v[74:75], v[186:187] op_sel:[1,0,0]
    v_pk_fma_f32 v[188:189], v[46:47], v[76:77], v[188:189] op_sel:[1,0,0]
    v_pk_fma_f32 v[190:191], v[46:47], v[78:79], v[190:191] op_sel:[1,0,0]
    v_pk_mul_f32 v[176:177], v[176:177], v[48:49] op_sel_hi:[1,0]
    v_pk_mul_f32 v[178:179], v[178:179], v[48:49] op_sel_hi:[1,0]
    v_pk_mul_f32 v[180:181], v[180:181], v[48:49] op_sel_hi:[1,0]
    v_pk_mul_f32 v[182:183], v[182:183], v[48:49] op_sel_hi:[1,0]
    v_pk_mul_f32 v[184:185], v[184:185], v[48:49] op_sel_hi:[1,0]
    v_pk_mul_f32 v[186:187], v[186:187], v[48:49] op_sel_hi:[1,0]
    v_pk_mul_f32 v[188:189], v[188:189], v[48:49] op_sel_hi:[1,0]
    v_pk_mul_f32 v[190:191], v[190:191], v[48:49] op_sel_hi:[1,0]
    v_cvt_pk_bf16_f32 v128, v176, v177
    v_cvt_pk_bf16_f32 v129, v178, v179
    v_cvt_pk_bf16_f32 v130, v180, v181
    v_cvt_pk_bf16_f32 v131, v182, v183
    v_cvt_pk_bf16_f32 v132, v184, v185
    v_cvt_pk_bf16_f32 v133, v186, v187
    v_cvt_pk_bf16_f32 v134, v188, v189
    v_cvt_pk_bf16_f32 v135, v190, v191
    s_mov_b32 exec_lo, 0
    v_mov_b32 v134, 0
    v_mov_b32 v135, 0
    s_mov_b32 exec_lo, -1
    s_lshl_b32 s60, s41, 11
    s_add_u32 s60, s60, 114688
    v_add_u32 v6, s60, v1
    ds_write_b128 v6, v[128:131] offset:0
    ds_write_b128 v6, v[132:135] offset:1024
    s_lshl_b32 s61, s41, 12
    s_add_u32 s78, s78, s61
    s_mov_b32 s75, 1
    v_mov_b32 v160, 0
    v_mov_b32 v161, 0
    v_mov_b32 v162, 0
    v_mov_b32 v163, 0
    v_mov_b32 v164, 0
    v_mov_b32 v165, 0
    v_mov_b32 v166, 0
    v_mov_b32 v167, 0
    v_mov_b32 v168, 0
    v_mov_b32 v169, 0
    v_mov_b32 v170, 0
    v_mov_b32 v171, 0
    v_mov_b32 v172, 0
    v_mov_b32 v173, 0
    v_mov_b32 v174, 0
    v_mov_b32 v175, 0
    v_accvgpr_write_b32 a16, 0
    v_accvgpr_write_b32 a17, 0
    v_accvgpr_write_b32 a18, 0
    v_accvgpr_write_b32 a19, 0
    v_accvgpr_write_b32 a20, 0
    v_accvgpr_write_b32 a21, 0
    v_accvgpr_write_b32 a22, 0
    v_accvgpr_write_b32 a23, 0
    v_accvgpr_write_b32 a24, 0
    v_accvgpr_write_b32 a25, 0
    v_accvgpr_write_b32 a26, 0
    v_accvgpr_write_b32 a27, 0
    v_accvgpr_write_b32 a28, 0
    v_accvgpr_write_b32 a29, 0
    v_accvgpr_write_b32 a30, 0
    v_accvgpr_write_b32 a31, 0
    v_accvgpr_write_b32 a32, 0
    v_accvgpr_write_b32 a33, 0
    v_accvgpr_write_b32 a34, 0
    v_accvgpr_write_b32 a35, 0
    v_accvgpr_write_b32 a36, 0
    v_accvgpr_write_b32 a37, 0
    v_accvgpr_write_b32 a38, 0
    v_accvgpr_write_b32 a39, 0
    v_accvgpr_write_b32 a40, 0
    v_accvgpr_write_b32 a41, 0
    v_accvgpr_write_b32 a42, 0
    v_accvgpr_write_b32 a43, 0
    v_accvgpr_write_b32 a44, 0
    v_accvgpr_write_b32 a45, 0
    v_accvgpr_write_b32 a46, 0
    v_accvgpr_write_b32 a47, 0
    v_accvgpr_write_b32 a48, 0
    v_accvgpr_write_b32 a49, 0
    v_accvgpr_write_b32 a50, 0
    v_accvgpr_write_b32 a51, 0
    v_accvgpr_write_b32 a52, 0
    v_accvgpr_write_b32 a53, 0
    v_accvgpr_write_b32 a54, 0
    v_accvgpr_write_b32 a55, 0
    v_accvgpr_write_b32 a56, 0
    v_accvgpr_write_b32 a57, 0
    v_accvgpr_write_b32 a58, 0
    v_accvgpr_write_b32 a59, 0
    v_accvgpr_write_b32 a60, 0
    v_accvgpr_write_b32 a61, 0
    v_accvgpr_write_b32 a62, 0
    v_accvgpr_write_b32 a63, 0
    v_accvgpr_write_b32 a124, 0
    v_accvgpr_write_b32 a125, 0
    v_accvgpr_write_b32 a126, 0
    v_accvgpr_write_b32 a127, 0
    v_mov_b32 v88, 0
    v_mov_b32 v89, 0
    v_mov_b32 v90, 0
    v_mov_b32 v91, 0
    v_mov_b32 v92, 0
    v_mov_b32 v93, 0
    v_mov_b32 v94, 0
    v_mov_b32 v95, 0
    v_mov_b32 v80, 0
    v_mov_b32 v81, 0
    v_mov_b32 v82, 0
    v_mov_b32 v83, 0
    v_mov_b32 v84, 0
    v_mov_b32 v85, 0
    v_mov_b32 v86, 0
    v_mov_b32 v87, 0
    v_mov_b32 v96, 0xff800000
    v_mov_b32 v97, 0xff800000
    v_mov_b32 v98, 0xff800000
    v_mov_b32 v99, 0xff800000
    s_mov_b32 s76, 0
    v_accvgpr_write_b32 a64, v136
    v_accvgpr_write_b32 a72, v144
    v_accvgpr_write_b32 a65, v137
    v_accvgpr_write_b32 a73, v145
    v_accvgpr_write_b32 a66, v138
    v_accvgpr_write_b32 a74, v146
    v_accvgpr_write_b32 a67, v139
    v_accvgpr_write_b32 a75, v147
    v_accvgpr_write_b32 a68, v140
    v_accvgpr_write_b32 a76, v148
    v_accvgpr_write_b32 a69, v141
    v_accvgpr_write_b32 a77, v149
    v_accvgpr_write_b32 a70, v142
    v_accvgpr_write_b32 a78, v150
    v_accvgpr_write_b32 a71, v143
    v_accvgpr_write_b32 a79, v151
    v_and_b32 v111, 31, v0
    v_mul_u32_u24 v110, 896, v111
    v_lshrrev_b32 v111, 5, v0
    v_lshl_add_u32 v110, v111, 4, v110
    s_lshl_b32 s60, s38, 31
    v_or_b32 v110, s60, v110
    s_mul_i32 s60, s84, 28672
    s_lshl_b32 s61, s85, 6
    s_add_u32 s60, s60, s61
    buffer_load_dwordx4 v[248:251], v110, s[12:15], s60 offen offset:0
    buffer_load_dwordx4 v[252:255], v110, s[12:15], s60 offen offset:32
    s_lshl_b32 s60, s40, 2
    s_add_u32 s60, s60, s41
    s_mul_i32 s60, s60, 49
    v_min_u32 v101, 48, v0
    v_add_lshl_u32 v101, v101, s60, 8
    v_add_u32 v102, 6272, v101
    s_sub_u32 s60, s38, 1
    v_and_b32 v101, s60, v101
    v_and_b32 v102, s60, v102
    s_add_u32 s60, s95, s101
    s_mul_i32 s61, s50, 384
    s_add_u32 s60, s60, s61
    s_cmp_eq_u32 s98, 0
    s_cselect_b32 s61, 1, s38
    s_lshl_b32 s61, s61, 31
    s_or_b32 s60, s60, s61
    v_and_b32 v109, 3, v0
    v_lshl_add_u32 v109, v109, 9, s60
    v_mov_b32 v104, v3
    v_add_u32 v105, 6144, v3
    v_add_u32 v106, 12288, v3
    v_add_u32 v107, 18432, v3
    s_lshl_b32 s60, s40, 2
    s_add_u32 s60, s60, s41
    s_mul_i32 s60, s60, 25
    v_min_u32 v103, 24, v0
    v_add_u32 v103, s60, v103
    v_min_u32 v103, 3135, v103
    v_lshlrev_b32 v103, 7, v103
    s_add_u32 s60, s41, 0
    s_and_b32 s60, s60, 3
    s_lshl_b32 s60, s60, 11
    s_add_u32 s60, s60, 114688
    v_add_u32 v6, s60, v1
    s_add_u32 s60, s41, 1
    s_and_b32 s60, s60, 3
    s_lshl_b32 s60, s60, 11
    s_add_u32 s60, s60, 114688
    v_add_u32 v7, s60, v1
    s_add_u32 s60, s41, 2
    s_and_b32 s60, s60, 3
    s_lshl_b32 s60, s60, 11
    s_add_u32 s60, s60, 114688
    v_add_u32 v8, s60, v1
    s_add_u32 s60, s41, 3
    s_and_b32 s60, s60, 3
    s_lshl_b32 s60, s60, 11
    s_add_u32 s60, s60, 114688
    v_add_u32 v9, s60, v1
    v_mov_b32 v5, s3
    s_mov_b32 s72, 0xffff
    s_mov_b32 s73, 0
    v_lshlrev_b32 v111, 8, v0
    s_mov_b64 exec, 0xff
    s_waitcnt vmcnt(2)
    buffer_store_dword v5, v111, s[4:7], s23 offen sc1
    s_mov_b64 exec, -1
    s_waitcnt lgkmcnt(0)
    s_barrier
    ds_read_b128 v[16:19], v6 offset:0
    ds_read_b128 v[20:23], v6 offset:1024
    ds_read_b128 v[24:27], v7 offset:0
    ds_read_b128 v[28:31], v7 offset:1024
    ds_read_b128 v[32:35], v8 offset:0
    ds_read_b128 v[36:39], v8 offset:1024
    ds_read_b128 v[40:43], v9 offset:0
    ds_read_b128 v[44:47], v9 offset:1024
    v_and_b32 v10, 31, v0
    v_lshlrev_b32 v10, 2, v10
    s_waitcnt lgkmcnt(0)
L_attn_pp:
    v_mfma_f32_32x32x16_bf16 v[48:63], v[136:139], v[16:19], 0
    v_mfma_f32_32x32x16_bf16 v[48:63], v[140:143], v[20:23], v[48:63]
    v_mfma_f32_32x32x16_bf16 v[64:79], v[136:139], v[24:27], 0
    v_mfma_f32_32x32x16_bf16 v[64:79], v[140:143], v[28:31], v[64:79]
    s_nop 9
    v_max3_f32 v96, v48, v49, v96
    v_max3_f32 v96, v50, v51, v96
    v_max3_f32 v96, v52, v53, v96
    v_max3_f32 v96, v54, v55, v96
    v_max3_f32 v96, v56, v57, v96
    v_max3_f32 v96, v58, v59, v96
    v_max3_f32 v96, v60, v61, v96
    v_max3_f32 v96, v62, v63, v96
    v_mfma_f32_32x32x16_bf16 v[48:63], v[136:139], v[32:35], 0
    v_mfma_f32_32x32x16_bf16 v[48:63], v[140:143], v[36:39], v[48:63]
    s_nop 1
    v_max3_f32 v97, v64, v65, v97
    v_max3_f32 v97, v66, v67, v97
    v_max3_f32 v97, v68, v69, v97
    v_max3_f32 v97, v70, v71, v97
    v_max3_f32 v97, v72, v73, v97
    v_max3_f32 v97, v74, v75, v97
    v_max3_f32 v97, v76, v77, v97
    v_max3_f32 v97, v78, v79, v97
    v_mfma_f32_32x32x16_bf16 v[64:79], v[136:139], v[40:43], 0
    v_mfma_f32_32x32x16_bf16 v[64:79], v[140:143], v[44:47], v[64:79]
    s_nop 1
    v_max3_f32 v98, v48, v49, v98
    v_max3_f32 v98, v50, v51, v98
    v_max3_f32 v98, v52, v53, v98
    v_max3_f32 v98, v54, v55, v98
    v_max3_f32 v98, v56, v57, v98
    v_max3_f32 v98, v58, v59, v98
    v_max3_f32 v98, v60, v61, v98
    v_max3_f32 v98, v62, v63, v98
    s_nop 3
    v_max3_f32 v99, v64, v65, v99
    v_max3_f32 v99, v66, v67, v99
    v_max3_f32 v99, v68, v69, v99
    v_max3_f32 v99, v70, v71, v99
    v_max3_f32 v99, v72, v73, v99
    v_max3_f32 v99, v74, v75, v99
    v_max3_f32 v99, v76, v77, v99
    v_max3_f32 v99, v78, v79, v99
    s_add_u32 s76, s76, 1
    s_cmp_ge_u32 s76, s75
    s_cbranch_scc0 L_attn_next
L_attn_ppd:
    v_mov_b32 v5, v96
    v_mov_b32 v6, v97
    v_mov_b32 v7, v98
    v_mov_b32 v8, v99
    s_nop 0
    v_permlane32_swap_b32 v5, v96
    v_permlane32_swap_b32 v6, v97
    v_permlane32_swap_b32 v7, v98
    v_permlane32_swap_b32 v8, v99
    v_max_f32 v96, v96, v5
    v_max_f32 v97, v97, v6
    v_max_f32 v98, v98, v7
    v_max_f32 v99, v99, v8
    v_and_b32 v9, 31, v0
    v_lshlrev_b32 v9, 4, v9
    s_lshl_b32 s61, s41, 2
    s_add_u32 s60, s41, 0
    s_and_b32 s60, s60, 3
    s_lshl_b32 s60, s60, 9
    s_add_u32 s60, s60, 122880
    v_add_u32 v5, s60, v9
    v_add_u32 v108, s61, v5
    ds_write_b32 v108, v96
    s_add_u32 s60, s41, 1
    s_and_b32 s60, s60, 3
    s_lshl_b32 s60, s60, 9
    s_add_u32 s60, s60, 122880
    v_add_u32 v6, s60, v9
    v_add_u32 v108, s61, v6
    ds_write_b32 v108, v97
    s_add_u32 s60, s41, 2
    s_and_b32 s60, s60, 3
    s_lshl_b32 s60, s60, 9
    s_add_u32 s60, s60, 122880
    v_add_u32 v7, s60, v9
    v_add_u32 v108, s61, v7
    ds_write_b32 v108, v98
    s_add_u32 s60, s41, 3
    s_and_b32 s60, s60, 3
    s_lshl_b32 s60, s60, 9
    s_add_u32 s60, s60, 122880
    v_add_u32 v8, s60, v9
    v_add_u32 v108, s61, v8
    ds_write_b32 v108, v99
    s_waitcnt lgkmcnt(0)
    s_barrier
    buffer_load_dword v202, v244, s[4:7], 0 offen sc1
    ds_read_b128 v[112:115], v5
    ds_read_b128 v[116:119], v6
    ds_read_b128 v[120:123], v7
    ds_read_b128 v[124:127], v8
    s_waitcnt lgkmcnt(3)
    v_max3_f32 v96, v112, v113, v114
    v_max_f32 v96, v96, v115
    s_waitcnt lgkmcnt(2)
    v_max3_f32 v97, v116, v117, v118
    v_max_f32 v97, v97, v119
    s_waitcnt lgkmcnt(1)
    v_max3_f32 v98, v120, v121, v122
    v_max_f32 v98, v98, v123
    s_waitcnt lgkmcnt(0)
    v_max3_f32 v99, v124, v125, v126
    v_max_f32 v99, v99, v127
    s_barrier
    v_cvt_pk_bf16_f32 v5, -v96, 0
    v_cvt_pk_bf16_f32 v6, -v97, 0
    v_cvt_pk_bf16_f32 v7, -v98, 0
    v_cvt_pk_bf16_f32 v8, -v99, 0
    v_lshlrev_b32 v5, 16, v5
    v_lshlrev_b32 v6, 16, v6
    v_lshlrev_b32 v7, 16, v7
    v_lshlrev_b32 v8, 16, v8
    v_add_f32 v5, v96, v5
    v_add_f32 v6, v97, v6
    v_add_f32 v7, v98, v7
    v_add_f32 v8, v99, v8
    v_cvt_pk_bf16_f32 v5, -v96, -v5
    v_cvt_pk_bf16_f32 v6, -v97, -v6
    v_cvt_pk_bf16_f32 v7, -v98, -v7
    v_cvt_pk_bf16_f32 v8, -v99, -v8
    s_mov_b32 exec_lo, 0
    v_mov_b32 v22, v5
    v_mov_b32 v30, v6
    v_mov_b32 v38, v7
    v_mov_b32 v46, v8
    s_mov_b32 exec_lo, -1
    s_lshl_b32 s77, s42, 14
    s_add_u32 s77, s77, 0x4000
    s_and_b32 s77, s77, 0x3ffff
    s_add_u32 s66, s77, s78
    s_mov_b32 s79, 0
    v_mfma_f32_32x32x16_bf16 v[48:63], a[64:67], v[16:19], 0
    v_mfma_f32_32x32x16_bf16 v[48:63], a[68:71], v[20:23], v[48:63]
    s_add_u32 s22, s3, 0
    s_mov_b32 s74, 0
L_poll_8:
    s_waitcnt vmcnt(0)
    v_subrev_u32 v202, s22, v202
    v_cmp_lt_u32 vcc, 31, v202
    s_and_b64 s[60:61], vcc, s[72:73]
    s_cbranch_scc0 L_poll_done_7
    buffer_load_dword v202, v244, s[4:7], 0 offen sc1
    s_add_u32 s74, s74, 1
    s_cmp_lt_u32 s74, 200000
    s_cbranch_scc1 L_poll_8
    s_waitcnt vmcnt(0)
L_poll_done_7:
    buffer_load_dwordx4 a[80:83], v1, s[4:7], s66 offen offset:0 sc1
    buffer_load_dwordx4 a[84:87], v1, s[4:7], s66 offen offset:1024 sc1
    buffer_load_dwordx4 a[88:91], v1, s[4:7], s66 offen offset:2048 sc1
    buffer_load_dwordx4 a[92:95], v1, s[4:7], s66 offen offset:3072 sc1
    s_add_u32 s77, s77, 0x4000
    s_and_b32 s77, s77, 0x3ffff
    s_add_u32 s66, s77, s78
    buffer_load_dwordx4 a[96:99], v1, s[4:7], s66 offen offset:0 sc1
    buffer_load_dwordx4 a[100:103], v1, s[4:7], s66 offen offset:1024 sc1
    buffer_load_dwordx4 a[104:107], v1, s[4:7], s66 offen offset:2048 sc1
    buffer_load_dwordx4 a[108:111], v1, s[4:7], s66 offen offset:3072 sc1
    s_add_u32 s77, s77, 0x4000
    s_and_b32 s77, s77, 0x3ffff
    s_add_u32 s66, s77, s78
    buffer_load_dword v198, v109, s[4:7], 0 offen sc1
    s_lshl_b32 s60, s38, 1
    s_add_u32 s60, s60, s75
    s_cmp_eq_u32 s60, 1
    s_cbranch_scc1 L_attn_loop0
L_attn_loop1:
    v_mfma_f32_32x32x16_bf16 v[64:79], a[64:67], v[24:27], 0
    buffer_load_dwordx4 a[112:115], v1, s[4:7], s66 offen offset:0 sc1
    v_cvt_pk_bf16_f32 v94, v84, v85
    v_cvt_pk_bf16_f32 v95, v86, v87
    v_exp_f32 v80, v48
    v_exp_f32 v81, v49
    v_exp_f32 v82, v50
    v_exp_f32 v83, v51
    v_mfma_f32_32x32x16_bf16 v[64:79], a[68:71], v[28:31], v[64:79]
    buffer_load_dwordx4 a[116:119], v1, s[4:7], s66 offen offset:1024 sc1
    v_cvt_pk_bf16_f32 v88, v80, v81
    v_cvt_pk_bf16_f32 v89, v82, v83
    v_exp_f32 v84, v52
    v_exp_f32 v85, v53
    v_exp_f32 v86, v54
    v_exp_f32 v87, v55
    v_mfma_f32_32x32x16_bf16 a[48:63], a[124:127], v[92:95], a[48:63]
    buffer_load_dwordx4 a[120:123], v1, s[4:7], s66 offen offset:2048 sc1
    v_cvt_pk_bf16_f32 v90, v84, v85
    v_cvt_pk_bf16_f32 v91, v86, v87
    v_exp_f32 v80, v56
    v_exp_f32 v81, v57
    v_exp_f32 v82, v58
    v_exp_f32 v83, v59
    v_mfma_f32_32x32x16_bf16 v[160:175], a[72:75], v[88:91], v[160:175]
    buffer_load_dwordx4 a[124:127], v1, s[4:7], s66 offen offset:3072 sc1
    v_cvt_pk_bf16_f32 v92, v80, v81
    v_cvt_pk_bf16_f32 v93, v82, v83
    v_exp_f32 v84, v60
    v_exp_f32 v85, v61
    v_exp_f32 v86, v62
    v_exp_f32 v87, v63
    v_mfma_f32_32x32x16_bf16 v[48:63], a[64:67], v[32:35], 0
    s_add_u32 s77, s77, 0x4000
    v_cvt_pk_bf16_f32 v94, v84, v85
    v_cvt_pk_bf16_f32 v95, v86, v87
    v_exp_f32 v80, v64
    v_exp_f32 v81, v65
    v_exp_f32 v82, v66
    v_exp_f32 v83, v67
    v_mfma_f32_32x32x16_bf16 v[48:63], a[68:71], v[36:39], v[48:63]
    s_and_b32 s77, s77, 0x3ffff
    v_cvt_pk_bf16_f32 v88, v80, v81
    v_cvt_pk_bf16_f32 v89, v82, v83
    v_exp_f32 v84, v68
    v_exp_f32 v85, v69
    v_exp_f32 v86, v70
    v_exp_f32 v87, v71
    v_mfma_f32_32x32x16_bf16 v[160:175], a[76:79], v[92:95], v[160:175]
    s_add_u32 s66, s77, s78
    v_cvt_pk_bf16_f32 v90, v84, v85
    v_cvt_pk_bf16_f32 v91, v86, v87
    v_exp_f32 v80, v72
    v_exp_f32 v81, v73
    v_exp_f32 v82, v74
    v_exp_f32 v83, v75
    v_mfma_f32_32x32x16_bf16 a[16:31], a[72:75], v[88:91], a[16:31]
    v_cvt_pk_bf16_f32 v92, v80, v81
    v_cvt_pk_bf16_f32 v93, v82, v83
    v_exp_f32 v84, v76
    v_exp_f32 v85, v77
    v_exp_f32 v86, v78
    v_exp_f32 v87, v79
    v_mfma_f32_32x32x16_bf16 v[64:79], a[64:67], v[40:43], 0
    v_cvt_pk_bf16_f32 v94, v84, v85
    v_cvt_pk_bf16_f32 v95, v86, v87
    v_exp_f32 v80, v48
    v_exp_f32 v81, v49
    v_exp_f32 v82, v50
    v_exp_f32 v83, v51
    v_mfma_f32_32x32x16_bf16 v[64:79], a[68:71], v[44:47], v[64:79]
    v_cvt_pk_bf16_f32 v88, v80, v81
    v_cvt_pk_bf16_f32 v89, v82, v83
    v_exp_f32 v84, v52
    v_exp_f32 v85, v53
    v_exp_f32 v86, v54
    v_exp_f32 v87, v55
    v_mfma_f32_32x32x16_bf16 a[16:31], a[76:79], v[92:95], a[16:31]
    v_cvt_pk_bf16_f32 v90, v84, v85
    v_cvt_pk_bf16_f32 v91, v86, v87
    v_exp_f32 v80, v56
    v_exp_f32 v81, v57
    v_exp_f32 v82, v58
    v_exp_f32 v83, v59
    v_mfma_f32_32x32x16_bf16 a[32:47], a[72:75], v[88:91], a[32:47]
    s_waitcnt vmcnt(8)
    v_cvt_pk_bf16_f32 v92, v80, v81
    v_cvt_pk_bf16_f32 v93, v82, v83
    v_exp_f32 v84, v60
    v_exp_f32 v85, v61
    v_exp_f32 v86, v62
    v_exp_f32 v87, v63
    v_mfma_f32_32x32x16_bf16 v[48:63], a[80:83], v[16:19], 0
    v_cvt_pk_bf16_f32 v94, v84, v85
    v_cvt_pk_bf16_f32 v95, v86, v87
    v_exp_f32 v80, v64
    v_exp_f32 v81, v65
    v_exp_f32 v82, v66
    v_exp_f32 v83, v67
    v_mfma_f32_32x32x16_bf16 v[48:63], a[84:87], v[20:23], v[48:63]
    v_cvt_pk_bf16_f32 v88, v80, v81
    v_cvt_pk_bf16_f32 v89, v82, v83
    v_exp_f32 v84, v68
    v_exp_f32 v85, v69
    v_exp_f32 v86, v70
    v_exp_f32 v87, v71
    v_mfma_f32_32x32x16_bf16 a[32:47], a[76:79], v[92:95], a[32:47]
    v_cvt_pk_bf16_f32 v90, v84, v85
    v_cvt_pk_bf16_f32 v91, v86, v87
    v_exp_f32 v80, v72
    v_exp_f32 v81, v73
    v_exp_f32 v82, v74
    v_exp_f32 v83, v75
    v_mfma_f32_32x32x16_bf16 a[48:63], a[72:75], v[88:91], a[48:63]
    v_cvt_pk_bf16_f32 v92, v80, v81
    v_cvt_pk_bf16_f32 v93, v82, v83
    v_exp_f32 v84, v76
    v_exp_f32 v85, v77
    v_exp_f32 v86, v78
    v_exp_f32 v87, v79
    v_mfma_f32_32x32x16_bf16 v[64:79], a[80:83], v[24:27], 0
    buffer_load_dwordx4 a[64:67], v1, s[4:7], s66 offen offset:0 sc1
    v_cvt_pk_bf16_f32 v94, v84, v85
    v_cvt_pk_bf16_f32 v95, v86, v87
    v_exp_f32 v80, v48
    v_exp_f32 v81, v49
    v_exp_f32 v82, v50
    v_exp_f32 v83, v51
    v_mfma_f32_32x32x16_bf16 v[64:79], a[84:87], v[28:31], v[64:79]
    buffer_load_dwordx4 a[68:71], v1, s[4:7], s66 offen offset:1024 sc1
    v_cvt_pk_bf16_f32 v88, v80, v81
    v_cvt_pk_bf16_f32 v89, v82, v83
    v_exp_f32 v84, v52
    v_exp_f32 v85, v53
    v_exp_f32 v86, v54
    v_exp_f32 v87, v55
    v_mfma_f32_32x32x16_bf16 a[48:63], a[76:79], v[92:95], a[48:63]
    buffer_load_dwordx4 a[72:75], v1, s[4:7], s66 offen offset:2048 sc1
    v_cvt_pk_bf16_f32 v90, v84, v85
    v_cvt_pk_bf16_f32 v91, v86, v87
    v_exp_f32 v80, v56
    v_exp_f32 v81, v57
    v_exp_f32 v82, v58
    v_exp_f32 v83, v59
    v_mfma_f32_32x32x16_bf16 v[160:175], a[88:91], v[88:91], v[160:175]
    buffer_load_dwordx4 a[76:79], v1, s[4:7], s66 offen offset:3072 sc1
    v_cvt_pk_bf16_f32 v92, v80, v81
    v_cvt_pk_bf16_f32 v93, v82, v83
    v_exp_f32 v84, v60
    v_exp_f32 v85, v61
    v_exp_f32 v86, v62
    v_exp_f32 v87, v63
    v_mfma_f32_32x32x16_bf16 v[48:63], a[80:83], v[32:35], 0
    s_add_u32 s77, s77, 0x4000
    v_cvt_pk_bf16_f32 v94, v84, v85
    v_cvt_pk_bf16_f32 v95, v86, v87
    v_exp_f32 v80, v64
    v_exp_f32 v81, v65
    v_exp_f32 v82, v66
    v_exp_f32 v83, v67
    v_mfma_f32_32x32x16_bf16 v[48:63], a[84:87], v[36:39], v[48:63]
    s_and_b32 s77, s77, 0x3ffff
    v_cvt_pk_bf16_f32 v88, v80, v81
    v_cvt_pk_bf16_f32 v89, v82, v83
    v_exp_f32 v84, v68
    v_exp_f32 v85, v69
    v_exp_f32 v86, v70
    v_exp_f32 v87, v71
    v_mfma_f32_32x32x16_bf16 v[160:175], a[92:95], v[92:95], v[160:175]
    s_add_u32 s66, s77, s78
    v_cvt_pk_bf16_f32 v90, v84, v85
    v_cvt_pk_bf16_f32 v91, v86, v87
    v_exp_f32 v80, v72
    v_exp_f32 v81, v73
    v_exp_f32 v82, v74
    v_exp_f32 v83, v75
    v_mfma_f32_32x32x16_bf16 a[16:31], a[88:91], v[88:91], a[16:31]
    v_cvt_pk_bf16_f32 v92, v80, v81
    v_cvt_pk_bf16_f32 v93, v82, v83
    v_exp_f32 v84, v76
    v_exp_f32 v85, v77
    v_exp_f32 v86, v78
    v_exp_f32 v87, v79
    v_mfma_f32_32x32x16_bf16 v[64:79], a[80:83], v[40:43], 0
    v_cvt_pk_bf16_f32 v94, v84, v85
    v_cvt_pk_bf16_f32 v95, v86, v87
    v_exp_f32 v80, v48
    v_exp_f32 v81, v49
    v_exp_f32 v82, v50
    v_exp_f32 v83, v51
    v_mfma_f32_32x32x16_bf16 v[64:79], a[84:87], v[44:47], v[64:79]
    v_cvt_pk_bf16_f32 v88, v80, v81
    v_cvt_pk_bf16_f32 v89, v82, v83
    v_exp_f32 v84, v52
    v_exp_f32 v85, v53
    v_exp_f32 v86, v54
    v_exp_f32 v87, v55
    v_mfma_f32_32x32x16_bf16 a[16:31], a[92:95], v[92:95], a[16:31]
    v_cvt_pk_bf16_f32 v90, v84, v85
    v_cvt_pk_bf16_f32 v91, v86, v87
    v_exp_f32 v80, v56
    v_exp_f32 v81, v57
    v_exp_f32 v82, v58
    v_exp_f32 v83, v59
    v_mfma_f32_32x32x16_bf16 a[32:47], a[88:91], v[88:91], a[32:47]
    s_waitcnt vmcnt(8)
    v_cvt_pk_bf16_f32 v92, v80, v81
    v_cvt_pk_bf16_f32 v93, v82, v83
    v_exp_f32 v84, v60
    v_exp_f32 v85, v61
    v_exp_f32 v86, v62
    v_exp_f32 v87, v63
    v_mfma_f32_32x32x16_bf16 v[48:63], a[96:99], v[16:19], 0
    v_cvt_pk_bf16_f32 v94, v84, v85
    v_cvt_pk_bf16_f32 v95, v86, v87
    v_exp_f32 v80, v64
    v_exp_f32 v81, v65
    v_exp_f32 v82, v66
    v_exp_f32 v83, v67
    v_mfma_f32_32x32x16_bf16 v[48:63], a[100:103], v[20:23], v[48:63]
    v_cvt_pk_bf16_f32 v88, v80, v81
    v_cvt_pk_bf16_f32 v89, v82, v83
    v_exp_f32 v84, v68
    v_exp_f32 v85, v69
    v_exp_f32 v86, v70
    v_exp_f32 v87, v71
    v_mfma_f32_32x32x16_bf16 a[32:47], a[92:95], v[92:95], a[32:47]
    v_cvt_pk_bf16_f32 v90, v84, v85
    v_cvt_pk_bf16_f32 v91, v86, v87
    v_exp_f32 v80, v72
    v_exp_f32 v81, v73
    v_exp_f32 v82, v74
    v_exp_f32 v83, v75
    v_mfma_f32_32x32x16_bf16 a[48:63], a[88:91], v[88:91], a[48:63]
    v_cvt_pk_bf16_f32 v92, v80, v81
    v_cvt_pk_bf16_f32 v93, v82, v83
    v_exp_f32 v84, v76
    v_exp_f32 v85, v77
    v_exp_f32 v86, v78
    v_exp_f32 v87, v79
    v_mfma_f32_32x32x16_bf16 v[64:79], a[96:99], v[24:27], 0
    buffer_load_dwordx4 a[80:83], v1, s[4:7], s66 offen offset:0 sc1
    v_cvt_pk_bf16_f32 v94, v84, v85
    v_cvt_pk_bf16_f32 v95, v86, v87
    v_exp_f32 v80, v48
    v_exp_f32 v81, v49
    v_exp_f32 v82, v50
    v_exp_f32 v83, v51
    v_mfma_f32_32x32x16_bf16 v[64:79], a[100:103], v[28:31], v[64:79]
    buffer_load_dwordx4 a[84:87], v1, s[4:7], s66 offen offset:1024 sc1
    v_cvt_pk_bf16_f32 v88, v80, v81
    v_cvt_pk_bf16_f32 v89, v82, v83
    v_exp_f32 v84, v52
    v_exp_f32 v85, v53
    v_exp_f32 v86, v54
    v_exp_f32 v87, v55
    v_mfma_f32_32x32x16_bf16 a[48:63], a[92:95], v[92:95], a[48:63]
    buffer_load_dwordx4 a[88:91], v1, s[4:7], s66 offen offset:2048 sc1
    v_cvt_pk_bf16_f32 v90, v84, v85
    v_cvt_pk_bf16_f32 v91, v86, v87
    v_exp_f32 v80, v56
    v_exp_f32 v81, v57
    v_exp_f32 v82, v58
    v_exp_f32 v83, v59
    v_mfma_f32_32x32x16_bf16 v[160:175], a[104:107], v[88:91], v[160:175]
    buffer_load_dwordx4 a[92:95], v1, s[4:7], s66 offen offset:3072 sc1
    v_cvt_pk_bf16_f32 v92, v80, v81
    v_cvt_pk_bf16_f32 v93, v82, v83
    v_exp_f32 v84, v60
    v_exp_f32 v85, v61
    v_exp_f32 v86, v62
    v_exp_f32 v87, v63
    v_mfma_f32_32x32x16_bf16 v[48:63], a[96:99], v[32:35], 0
    s_add_u32 s77, s77, 0x4000
    v_cvt_pk_bf16_f32 v94, v84, v85
    v_cvt_pk_bf16_f32 v95, v86, v87
    v_exp_f32 v80, v64
    v_exp_f32 v81, v65
    v_exp_f32 v82, v66
    v_exp_f32 v83, v67
    v_mfma_f32_32x32x16_bf16 v[48:63], a[100:103], v[36:39], v[48:63]
    s_and_b32 s77, s77, 0x3ffff
    v_cvt_pk_bf16_f32 v88, v80, v81
    v_cvt_pk_bf16_f32 v89, v82, v83
    v_exp_f32 v84, v68
    v_exp_f32 v85, v69
    v_exp_f32 v86, v70
    v_exp_f32 v87, v71
    v_mfma_f32_32x32x16_bf16 v[160:175], a[108:111], v[92:95], v[160:175]
    s_add_u32 s66, s77, s78
    v_cvt_pk_bf16_f32 v90, v84, v85
    v_cvt_pk_bf16_f32 v91, v86, v87
    v_exp_f32 v80, v72
    v_exp_f32 v81, v73
    v_exp_f32 v82, v74
    v_exp_f32 v83, v75
    v_mfma_f32_32x32x16_bf16 a[16:31], a[104:107], v[88:91], a[16:31]
    v_cvt_pk_bf16_f32 v92, v80, v81
    v_cvt_pk_bf16_f32 v93, v82, v83
    v_exp_f32 v84, v76
    v_exp_f32 v85, v77
    v_exp_f32 v86, v78
    v_exp_f32 v87, v79
    v_mfma_f32_32x32x16_bf16 v[64:79], a[96:99], v[40:43], 0
    v_cvt_pk_bf16_f32 v94, v84, v85
    v_cvt_pk_bf16_f32 v95, v86, v87
    v_exp_f32 v80, v48
    v_exp_f32 v81, v49
    v_exp_f32 v82, v50
    v_exp_f32 v83, v51
    v_mfma_f32_32x32x16_bf16 v[64:79], a[100:103], v[44:47], v[64:79]
    v_cvt_pk_bf16_f32 v88, v80, v81
    v_cvt_pk_bf16_f32 v89, v82, v83
    v_exp_f32 v84, v52
    v_exp_f32 v85, v53
    v_exp_f32 v86, v54
    v_exp_f32 v87, v55
    v_mfma_f32_32x32x16_bf16 a[16:31], a[108:111], v[92:95], a[16:31]
    v_cvt_pk_bf16_f32 v90, v84, v85
    v_cvt_pk_bf16_f32 v91, v86, v87
    v_exp_f32 v80, v56
    v_exp_f32 v81, v57
    v_exp_f32 v82, v58
    v_exp_f32 v83, v59
    v_mfma_f32_32x32x16_bf16 a[32:47], a[104:107], v[88:91], a[32:47]
    s_waitcnt vmcnt(8)
    v_cvt_pk_bf16_f32 v92, v80, v81
    v_cvt_pk_bf16_f32 v93, v82, v83
    v_exp_f32 v84, v60
    v_exp_f32 v85, v61
    v_exp_f32 v86, v62
    v_exp_f32 v87, v63
    v_mfma_f32_32x32x16_bf16 v[48:63], a[112:115], v[16:19], 0
    v_cvt_pk_bf16_f32 v94, v84, v85
    v_cvt_pk_bf16_f32 v95, v86, v87
    v_exp_f32 v80, v64
    v_exp_f32 v81, v65
    v_exp_f32 v82, v66
    v_exp_f32 v83, v67
    v_mfma_f32_32x32x16_bf16 v[48:63], a[116:119], v[20:23], v[48:63]
    v_cvt_pk_bf16_f32 v88, v80, v81
    v_cvt_pk_bf16_f32 v89, v82, v83
    v_exp_f32 v84, v68
    v_exp_f32 v85, v69
    v_exp_f32 v86, v70
    v_exp_f32 v87, v71
    v_mfma_f32_32x32x16_bf16 a[32:47], a[108:111], v[92:95], a[32:47]
    v_cvt_pk_bf16_f32 v90, v84, v85
    v_cvt_pk_bf16_f32 v91, v86, v87
    v_exp_f32 v80, v72
    v_exp_f32 v81, v73
    v_exp_f32 v82, v74
    v_exp_f32 v83, v75
    v_mfma_f32_32x32x16_bf16 a[48:63], a[104:107], v[88:91], a[48:63]
    v_cvt_pk_bf16_f32 v92, v80, v81
    v_cvt_pk_bf16_f32 v93, v82, v83
    v_exp_f32 v84, v76
    v_exp_f32 v85, v77
    v_exp_f32 v86, v78
    v_exp_f32 v87, v79
    v_mfma_f32_32x32x16_bf16 v[64:79], a[112:115], v[24:27], 0
    buffer_load_dwordx4 a[96:99], v1, s[4:7], s66 offen offset:0 sc1
    v_cvt_pk_bf16_f32 v94, v84, v85
    v_cvt_pk_bf16_f32 v95, v86, v87
    v_exp_f32 v80, v48
    v_exp_f32 v81, v49
    v_exp_f32 v82, v50
    v_exp_f32 v83, v51
    v_mfma_f32_32x32x16_bf16 v[64:79], a[116:119], v[28:31], v[64:79]
    buffer_load_dwordx4 a[100:103], v1, s[4:7], s66 offen offset:1024 sc1
    v_cvt_pk_bf16_f32 v88, v80, v81
    v_cvt_pk_bf16_f32 v89, v82, v83
    v_exp_f32 v84, v52
    v_exp_f32 v85, v53
    v_exp_f32 v86, v54
    v_exp_f32 v87, v55
    v_mfma_f32_32x32x16_bf16 a[48:63], a[108:111], v[92:95], a[48:63]
    buffer_load_dwordx4 a[104:107], v1, s[4:7], s66 offen offset:2048 sc1
    v_cvt_pk_bf16_f32 v90, v84, v85
    v_cvt_pk_bf16_f32 v91, v86, v87
    v_exp_f32 v80, v56
    v_exp_f32 v81, v57
    v_exp_f32 v82, v58
    v_exp_f32 v83, v59
    v_mfma_f32_32x32x16_bf16 v[160:175], a[120:123], v[88:91], v[160:175]
    buffer_load_dwordx4 a[108:111], v1, s[4:7], s66 offen offset:3072 sc1
    v_cvt_pk_bf16_f32 v92, v80, v81
    v_cvt_pk_bf16_f32 v93, v82, v83
    v_exp_f32 v84, v60
    v_exp_f32 v85, v61
    v_exp_f32 v86, v62
    v_exp_f32 v87, v63
    v_mfma_f32_32x32x16_bf16 v[48:63], a[112:115], v[32:35], 0
    s_add_u32 s77, s77, 0x4000
    v_cvt_pk_bf16_f32 v94, v84, v85
    v_cvt_pk_bf16_f32 v95, v86, v87
    v_exp_f32 v80, v64
    v_exp_f32 v81, v65
    v_exp_f32 v82, v66
    v_exp_f32 v83, v67
    v_mfma_f32_32x32x16_bf16 v[48:63], a[116:119], v[36:39], v[48:63]
    s_and_b32 s77, s77, 0x3ffff
    v_cvt_pk_bf16_f32 v88, v80, v81
    v_cvt_pk_bf16_f32 v89, v82, v83
    v_exp_f32 v84, v68
    v_exp_f32 v85, v69
    v_exp_f32 v86, v70
    v_exp_f32 v87, v71
    v_mfma_f32_32x32x16_bf16 v[160:175], a[124:127], v[92:95], v[160:175]
    s_add_u32 s66, s77, s78
    v_cvt_pk_bf16_f32 v90, v84, v85
    v_cvt_pk_bf16_f32 v91, v86, v87
    v_exp_f32 v80, v72
    v_exp_f32 v81, v73
    v_exp_f32 v82, v74
    v_exp_f32 v83, v75
    v_mfma_f32_32x32x16_bf16 a[16:31], a[120:123], v[88:91], a[16:31]
    v_cvt_pk_bf16_f32 v92, v80, v81
    v_cvt_pk_bf16_f32 v93, v82, v83
    v_exp_f32 v84, v76
    v_exp_f32 v85, v77
    v_exp_f32 v86, v78
    v_exp_f32 v87, v79
    v_mfma_f32_32x32x16_bf16 v[64:79], a[112:115], v[40:43], 0
    v_cvt_pk_bf16_f32 v94, v84, v85
    v_cvt_pk_bf16_f32 v95, v86, v87
    v_exp_f32 v80, v48
    v_exp_f32 v81, v49
    v_exp_f32 v82, v50
    v_exp_f32 v83, v51
    v_mfma_f32_32x32x16_bf16 v[64:79], a[116:119], v[44:47], v[64:79]
    v_cvt_pk_bf16_f32 v88, v80, v81
    v_cvt_pk_bf16_f32 v89, v82, v83
    v_exp_f32 v84, v52
    v_exp_f32 v85, v53
    v_exp_f32 v86, v54
    v_exp_f32 v87, v55
    v_mfma_f32_32x32x16_bf16 a[16:31], a[124:127], v[92:95], a[16:31]
    v_cvt_pk_bf16_f32 v90, v84, v85
    v_cvt_pk_bf16_f32 v91, v86, v87
    v_exp_f32 v80, v56
    v_exp_f32 v81, v57
    v_exp_f32 v82, v58
    v_exp_f32 v83, v59
    v_mfma_f32_32x32x16_bf16 a[32:47], a[120:123], v[88:91], a[32:47]
    s_waitcnt vmcnt(8)
    v_cvt_pk_bf16_f32 v92, v80, v81
    v_cvt_pk_bf16_f32 v93, v82, v83
    v_exp_f32 v84, v60
    v_exp_f32 v85, v61
    v_exp_f32 v86, v62
    v_exp_f32 v87, v63
    v_mfma_f32_32x32x16_bf16 v[48:63], a[64:67], v[16:19], 0
    v_cvt_pk_bf16_f32 v94, v84, v85
    v_cvt_pk_bf16_f32 v95, v86, v87
    v_exp_f32 v80, v64
    v_exp_f32 v81, v65
    v_exp_f32 v82, v66
    v_exp_f32 v83, v67
    v_mfma_f32_32x32x16_bf16 v[48:63], a[68:71], v[20:23], v[48:63]
    v_cvt_pk_bf16_f32 v88, v80, v81
    v_cvt_pk_bf16_f32 v89, v82, v83
    v_exp_f32 v84, v68
    v_exp_f32 v85, v69
    v_exp_f32 v86, v70
    v_exp_f32 v87, v71
    v_mfma_f32_32x32x16_bf16 a[32:47], a[124:127], v[92:95], a[32:47]
    s_add_u32 s79, s79, 1
    v_cvt_pk_bf16_f32 v90, v84, v85
    v_cvt_pk_bf16_f32 v91, v86, v87
    v_exp_f32 v80, v72
    v_exp_f32 v81, v73
    v_exp_f32 v82, v74
    v_exp_f32 v83, v75
    v_mfma_f32_32x32x16_bf16 a[48:63], a[120:123], v[88:91], a[48:63]
    s_cmp_lt_u32 s79, 3
    v_cvt_pk_bf16_f32 v92, v80, v81
    v_cvt_pk_bf16_f32 v93, v82, v83
    v_exp_f32 v84, v76
    v_exp_f32 v85, v77
    v_exp_f32 v86, v78
    v_exp_f32 v87, v79
    s_cbranch_scc1 L_attn_loop1
L_attn_tail:
    v_mfma_f32_32x32x16_bf16 v[64:79], a[64:67], v[24:27], 0
    buffer_load_dwordx4 a[112:115], v1, s[4:7], s66 offen offset:0 sc1
    v_cvt_pk_bf16_f32 v94, v84, v85
    v_cvt_pk_bf16_f32 v95, v86, v87
    v_exp_f32 v80, v48
    v_exp_f32 v81, v49
    v_exp_f32 v82, v50
    v_exp_f32 v83, v51
    v_mfma_f32_32x32x16_bf16 v[64:79], a[68:71], v[28:31], v[64:79]
    buffer_load_dwordx4 a[116:119], v1, s[4:7], s66 offen offset:1024 sc1
    v_cvt_pk_bf16_f32 v88, v80, v81
    v_cvt_pk_bf16_f32 v89, v82, v83
    v_exp_f32 v84, v52
    v_exp_f32 v85, v53
    v_exp_f32 v86, v54
    v_exp_f32 v87, v55
    v_mfma_f32_32x32x16_bf16 a[48:63], a[124:127], v[92:95], a[48:63]
    buffer_load_dwordx4 a[120:123], v1, s[4:7], s66 offen offset:2048 sc1
    v_cvt_pk_bf16_f32 v90, v84, v85
    v_cvt_pk_bf16_f32 v91, v86, v87
    v_exp_f32 v80, v56
    v_exp_f32 v81, v57
    v_exp_f32 v82, v58
    v_exp_f32 v83, v59
    v_mfma_f32_32x32x16_bf16 v[160:175], a[72:75], v[88:91], v[160:175]
    buffer_load_dwordx4 a[124:127], v1, s[4:7], s66 offen offset:3072 sc1
    v_cvt_pk_bf16_f32 v92, v80, v81
    v_cvt_pk_bf16_f32 v93, v82, v83
    v_exp_f32 v84, v60
    v_exp_f32 v85, v61
    v_exp_f32 v86, v62
    v_exp_f32 v87, v63
    v_mfma_f32_32x32x16_bf16 v[48:63], a[64:67], v[32:35], 0
    buffer_load_dword v202, v10, s[4:7], s89 offen sc1
    buffer_load_dword v198, v197, s[4:7], 0 offen sc1
    v_cvt_pk_bf16_f32 v94, v84, v85
    v_cvt_pk_bf16_f32 v95, v86, v87
    v_exp_f32 v80, v64
    v_exp_f32 v81, v65
    v_exp_f32 v82, v66
    v_exp_f32 v83, v67
    v_mfma_f32_32x32x16_bf16 v[48:63], a[68:71], v[36:39], v[48:63]
    s_mov_b32 s8, s20
    s_and_b32 s9, s21, 0xffff
    v_cvt_pk_bf16_f32 v88, v80, v81
    v_cvt_pk_bf16_f32 v89, v82, v83
    v_exp_f32 v84, v68
    v_exp_f32 v85, v69
    v_exp_f32 v86, v70
    v_exp_f32 v87, v71
    v_mfma_f32_32x32x16_bf16 v[160:175], a[76:79], v[92:95], v[160:175]
    s_mov_b32 s10, 401408
    s_mov_b32 s11, 0x20000
    v_cvt_pk_bf16_f32 v90, v84, v85
    v_cvt_pk_bf16_f32 v91, v86, v87
    v_exp_f32 v80, v72
    v_exp_f32 v81, v73
    v_exp_f32 v82, v74
    v_exp_f32 v83, v75
    v_mfma_f32_32x32x16_bf16 a[16:31], a[72:75], v[88:91], a[16:31]
    s_mul_i32 s70, s51, 28672
    s_add_u32 s70, s70, s99
    v_cvt_pk_bf16_f32 v92, v80, v81
    v_cvt_pk_bf16_f32 v93, v82, v83
    v_exp_f32 v84, v76
    v_exp_f32 v85, v77
    v_exp_f32 v86, v78
    v_exp_f32 v87, v79
    v_mfma_f32_32x32x16_bf16 v[64:79], a[64:67], v[40:43], 0
    s_add_u32 m0, s70, 0
    s_mul_i32 s70, s41, 100352
    v_cvt_pk_bf16_f32 v94, v84, v85
    v_cvt_pk_bf16_f32 v95, v86, v87
    v_exp_f32 v80, v48
    v_exp_f32 v81, v49
    v_exp_f32 v82, v50
    v_exp_f32 v83, v51
    v_mfma_f32_32x32x16_bf16 v[64:79], a[68:71], v[44:47], v[64:79]
    s_mul_i32 s67, s45, 128
    v_cvt_pk_bf16_f32 v88, v80, v81
    v_cvt_pk_bf16_f32 v89, v82, v83
    v_exp_f32 v84, v52
    v_exp_f32 v85, v53
    v_exp_f32 v86, v54
    v_exp_f32 v87, v55
    v_mfma_f32_32x32x16_bf16 a[16:31], a[76:79], v[92:95], a[16:31]
    s_add_u32 s70, s70, s67
    v_cvt_pk_bf16_f32 v90, v84, v85
    v_cvt_pk_bf16_f32 v91, v86, v87
    v_exp_f32 v80, v56
    v_exp_f32 v81, v57
    v_exp_f32 v82, v58
    v_exp_f32 v83, v59
    v_mfma_f32_32x32x16_bf16 a[32:47], a[72:75], v[88:91], a[32:47]
    s_waitcnt vmcnt(10)
    v_cvt_pk_bf16_f32 v92, v80, v81
    v_cvt_pk_bf16_f32 v93, v82, v83
    v_exp_f32 v84, v60
    v_exp_f32 v85, v61
    v_exp_f32 v86, v62
    v_exp_f32 v87, v63
    v_mfma_f32_32x32x16_bf16 v[48:63], a[80:83], v[16:19], 0
    buffer_load_dwordx4 v104, s[8:11], s70 offen offset:0 lds
    buffer_load_dwordx4 v105, s[8:11], s70 offen offset:1024 lds
    v_cvt_pk_bf16_f32 v94, v84, v85
    v_cvt_pk_bf16_f32 v95, v86, v87
    v_exp_f32 v80, v64
    v_exp_f32 v81, v65
    v_exp_f32 v82, v66
    v_exp_f32 v83, v67
    v_mfma_f32_32x32x16_bf16 v[48:63], a[84:87], v[20:23], v[48:63]
    buffer_load_dwordx4 v106, s[8:11], s70 offen offset:2048 lds
    v_cvt_pk_bf16_f32 v88, v80, v81
    v_cvt_pk_bf16_f32 v89, v82, v83
    v_exp_f32 v84, v68
    v_exp_f32 v85, v69
    v_exp_f32 v86, v70
    v_exp_f32 v87, v71
    v_mfma_f32_32x32x16_bf16 a[32:47], a[76:79], v[92:95], a[32:47]
    buffer_load_dwordx4 v107, s[8:11], s70 offen offset:3072 lds
    v_cvt_pk_bf16_f32 v90, v84, v85
    v_cvt_pk_bf16_f32 v91, v86, v87
    v_exp_f32 v80, v72
    v_exp_f32 v81, v73
    v_exp_f32 v82, v74
    v_exp_f32 v83, v75
    v_mfma_f32_32x32x16_bf16 a[48:63], a[72:75], v[88:91], a[48:63]
    s_add_u32 m0, m0, 4096
    v_cvt_pk_bf16_f32 v92, v80, v81
    v_cvt_pk_bf16_f32 v93, v82, v83
    v_exp_f32 v84, v76
    v_exp_f32 v85, v77
    v_exp_f32 v86, v78
    v_exp_f32 v87, v79
    v_mfma_f32_32x32x16_bf16 v[64:79], a[80:83], v[24:27], 0
    s_add_u32 s70, s70, 28672
    v_cvt_pk_bf16_f32 v94, v84, v85
    v_cvt_pk_bf16_f32 v95, v86, v87
    v_exp_f32 v80, v48
    v_exp_f32 v81, v49
    v_exp_f32 v82, v50
    v_exp_f32 v83, v51
    v_mfma_f32_32x32x16_bf16 v[64:79], a[84:87], v[28:31], v[64:79]
    buffer_load_dwordx4 v104, s[8:11], s70 offen offset:0 lds
    v_cvt_pk_bf16_f32 v88, v80, v81
    v_cvt_pk_bf16_f32 v89, v82, v83
    v_exp_f32 v84, v52
    v_exp_f32 v85, v53
    v_exp_f32 v86, v54
    v_exp_f32 v87, v55
    v_mfma_f32_32x32x16_bf16 a[48:63], a[76:79], v[92:95], a[48:63]
    buffer_load_dwordx4 v105, s[8:11], s70 offen offset:1024 lds
    v_cvt_pk_bf16_f32 v90, v84, v85
    v_cvt_pk_bf16_f32 v91, v86, v87
    v_exp_f32 v80, v56
    v_exp_f32 v81, v57
    v_exp_f32 v82, v58
    v_exp_f32 v83, v59
    v_mfma_f32_32x32x16_bf16 v[160:175], a[88:91], v[88:91], v[160:175]
    buffer_load_dwordx4 v106, s[8:11], s70 offen offset:2048 lds
    v_cvt_pk_bf16_f32 v92, v80, v81
    v_cvt_pk_bf16_f32 v93, v82, v83
    v_exp_f32 v84, v60
    v_exp_f32 v85, v61
    v_exp_f32 v86, v62
    v_exp_f32 v87, v63
    v_mfma_f32_32x32x16_bf16 v[48:63], a[80:83], v[32:35], 0
    buffer_load_dwordx4 v107, s[8:11], s70 offen offset:3072 lds
    v_cvt_pk_bf16_f32 v94, v84, v85
    v_cvt_pk_bf16_f32 v95, v86, v87
    v_exp_f32 v80, v64
    v_exp_f32 v81, v65
    v_exp_f32 v82, v66
    v_exp_f32 v83, v67
    v_mfma_f32_32x32x16_bf16 v[48:63], a[84:87], v[36:39], v[48:63]
    s_add_u32 m0, m0, 4096
    v_cvt_pk_bf16_f32 v88, v80, v81
    v_cvt_pk_bf16_f32 v89, v82, v83
    v_exp_f32 v84, v68
    v_exp_f32 v85, v69
    v_exp_f32 v86, v70
    v_exp_f32 v87, v71
    v_mfma_f32_32x32x16_bf16 v[160:175], a[92:95], v[92:95], v[160:175]
    s_add_u32 s70, s70, 28672
    v_cvt_pk_bf16_f32 v90, v84, v85
    v_cvt_pk_bf16_f32 v91, v86, v87
    v_exp_f32 v80, v72
    v_exp_f32 v81, v73
    v_exp_f32 v82, v74
    v_exp_f32 v83, v75
    v_mfma_f32_32x32x16_bf16 a[16:31], a[88:91], v[88:91], a[16:31]
    buffer_load_dwordx4 v104, s[8:11], s70 offen offset:0 lds
    v_cvt_pk_bf16_f32 v92, v80, v81
    v_cvt_pk_bf16_f32 v93, v82, v83
    v_exp_f32 v84, v76
    v_exp_f32 v85, v77
    v_exp_f32 v86, v78
    v_exp_f32 v87, v79
    v_mfma_f32_32x32x16_bf16 v[64:79], a[80:83], v[40:43], 0
    buffer_load_dwordx4 v105, s[8:11], s70 offen offset:1024 lds
    v_cvt_pk_bf16_f32 v94, v84, v85
    v_cvt_pk_bf16_f32 v95, v86, v87
    v_exp_f32 v80, v48
    v_exp_f32 v81, v49
    v_exp_f32 v82, v50
    v_exp_f32 v83, v51
    v_mfma_f32_32x32x16_bf16 v[64:79], a[84:87], v[44:47], v[64:79]
    buffer_load_dwordx4 v106, s[8:11], s70 offen offset:2048 lds
    v_cvt_pk_bf16_f32 v88, v80, v81
    v_cvt_pk_bf16_f32 v89, v82, v83
    v_exp_f32 v84, v52
    v_exp_f32 v85, v53
    v_exp_f32 v86, v54
    v_exp_f32 v87, v55
    v_mfma_f32_32x32x16_bf16 a[16:31], a[92:95], v[92:95], a[16:31]
    buffer_load_dwordx4 v107, s[8:11], s70 offen offset:3072 lds
    v_cvt_pk_bf16_f32 v90, v84, v85
    v_cvt_pk_bf16_f32 v91, v86, v87
    v_exp_f32 v80, v56
    v_exp_f32 v81, v57
    v_exp_f32 v82, v58
    v_exp_f32 v83, v59
    v_mfma_f32_32x32x16_bf16 a[32:47], a[88:91], v[88:91], a[32:47]
    s_waitcnt vmcnt(18)
    v_cvt_pk_bf16_f32 v92, v80, v81
    v_cvt_pk_bf16_f32 v93, v82, v83
    v_exp_f32 v84, v60
    v_exp_f32 v85, v61
    v_exp_f32 v86, v62
    v_exp_f32 v87, v63
    v_mfma_f32_32x32x16_bf16 v[48:63], a[96:99], v[16:19], 0
    s_add_u32 m0, m0, 4096
    s_add_u32 s70, s70, 28672
    v_cvt_pk_bf16_f32 v94, v84, v85
    v_cvt_pk_bf16_f32 v95, v86, v87
    v_exp_f32 v80, v64
    v_exp_f32 v81, v65
    v_exp_f32 v82, v66
    v_exp_f32 v83, v67
    v_mfma_f32_32x32x16_bf16 v[48:63], a[100:103], v[20:23], v[48:63]
    buffer_load_dwordx4 v104, s[8:11], s70 offen offset:0 lds
    v_cvt_pk_bf16_f32 v88, v80, v81
    v_cvt_pk_bf16_f32 v89, v82, v83
    v_exp_f32 v84, v68
    v_exp_f32 v85, v69
    v_exp_f32 v86, v70
    v_exp_f32 v87, v71
    v_mfma_f32_32x32x16_bf16 a[32:47], a[92:95], v[92:95], a[32:47]
    buffer_load_dwordx4 v105, s[8:11], s70 offen offset:1024 lds
    v_cvt_pk_bf16_f32 v90, v84, v85
    v_cvt_pk_bf16_f32 v91, v86, v87
    v_exp_f32 v80, v72
    v_exp_f32 v81, v73
    v_exp_f32 v82, v74
    v_exp_f32 v83, v75
    v_mfma_f32_32x32x16_bf16 a[48:63], a[88:91], v[88:91], a[48:63]
    s_mov_b32 s8, s24
    v_cvt_pk_bf16_f32 v92, v80, v81
    v_cvt_pk_bf16_f32 v93, v82, v83
    v_exp_f32 v84, v76
    v_exp_f32 v85, v77
    v_exp_f32 v86, v78
    v_exp_f32 v87, v79
    v_mfma_f32_32x32x16_bf16 v[64:79], a[96:99], v[24:27], 0
    s_and_b32 s9, s25, 0xffff
    v_cvt_pk_bf16_f32 v94, v84, v85
    v_cvt_pk_bf16_f32 v95, v86, v87
    v_exp_f32 v80, v48
    v_exp_f32 v81, v49
    v_exp_f32 v82, v50
    v_exp_f32 v83, v51
    v_mfma_f32_32x32x16_bf16 v[64:79], a[100:103], v[28:31], v[64:79]
    s_mov_b32 s10, 401408
    v_cvt_pk_bf16_f32 v88, v80, v81
    v_cvt_pk_bf16_f32 v89, v82, v83
    v_exp_f32 v84, v52
    v_exp_f32 v85, v53
    v_exp_f32 v86, v54
    v_exp_f32 v87, v55
    v_mfma_f32_32x32x16_bf16 a[48:63], a[92:95], v[92:95], a[48:63]
    s_mov_b32 s11, 0x20000
    v_cvt_pk_bf16_f32 v90, v84, v85
    v_cvt_pk_bf16_f32 v91, v86, v87
    v_exp_f32 v80, v56
    v_exp_f32 v81, v57
    v_exp_f32 v82, v58
    v_exp_f32 v83, v59
    v_mfma_f32_32x32x16_bf16 v[160:175], a[104:107], v[88:91], v[160:175]
    s_mul_i32 s70, s51, 28672
    v_cvt_pk_bf16_f32 v92, v80, v81
    v_cvt_pk_bf16_f32 v93, v82, v83
    v_exp_f32 v84, v60
    v_exp_f32 v85, v61
    v_exp_f32 v86, v62
    v_exp_f32 v87, v63
    v_mfma_f32_32x32x16_bf16 v[48:63], a[96:99], v[32:35], 0
    s_add_u32 s70, s70, s99
    v_cvt_pk_bf16_f32 v94, v84, v85
    v_cvt_pk_bf16_f32 v95, v86, v87
    v_exp_f32 v80, v64
    v_exp_f32 v81, v65
    v_exp_f32 v82, v66
    v_exp_f32 v83, v67
    v_mfma_f32_32x32x16_bf16 v[48:63], a[100:103], v[36:39], v[48:63]
    s_add_u32 m0, s70, 57344
    v_cvt_pk_bf16_f32 v88, v80, v81
    v_cvt_pk_bf16_f32 v89, v82, v83
    v_exp_f32 v84, v68
    v_exp_f32 v85, v69
    v_exp_f32 v86, v70
    v_exp_f32 v87, v71
    v_mfma_f32_32x32x16_bf16 v[160:175], a[108:111], v[92:95], v[160:175]
    s_mul_i32 s70, s41, 100352
    v_cvt_pk_bf16_f32 v90, v84, v85
    v_cvt_pk_bf16_f32 v91, v86, v87
    v_exp_f32 v80, v72
    v_exp_f32 v81, v73
    v_exp_f32 v82, v74
    v_exp_f32 v83, v75
    v_mfma_f32_32x32x16_bf16 a[16:31], a[104:107], v[88:91], a[16:31]
    s_mul_i32 s67, s45, 128
    v_cvt_pk_bf16_f32 v92, v80, v81
    v_cvt_pk_bf16_f32 v93, v82, v83
    v_exp_f32 v84, v76
    v_exp_f32 v85, v77
    v_exp_f32 v86, v78
    v_exp_f32 v87, v79
    v_mfma_f32_32x32x16_bf16 v[64:79], a[96:99], v[40:43], 0
    s_add_u32 s70, s70, s67
    v_cvt_pk_bf16_f32 v94, v84, v85
    v_cvt_pk_bf16_f32 v95, v86, v87
    v_exp_f32 v80, v48
    v_exp_f32 v81, v49
    v_exp_f32 v82, v50
    v_exp_f32 v83, v51
    v_mfma_f32_32x32x16_bf16 v[64:79], a[100:103], v[44:47], v[64:79]
    buffer_load_dwordx4 v104, s[8:11], s70 offen offset:0 lds
    v_cvt_pk_bf16_f32 v88, v80, v81
    v_cvt_pk_bf16_f32 v89, v82, v83
    v_exp_f32 v84, v52
    v_exp_f32 v85, v53
    v_exp_f32 v86, v54
    v_exp_f32 v87, v55
    v_mfma_f32_32x32x16_bf16 a[16:31], a[108:111], v[92:95], a[16:31]
    buffer_load_dwordx4 v105, s[8:11], s70 offen offset:1024 lds
    v_cvt_pk_bf16_f32 v90, v84, v85
    v_cvt_pk_bf16_f32 v91, v86, v87
    v_exp_f32 v80, v56
    v_exp_f32 v81, v57
    v_exp_f32 v82, v58
    v_exp_f32 v83, v59
    v_mfma_f32_32x32x16_bf16 a[32:47], a[104:107], v[88:91], a[32:47]
    s_waitcnt vmcnt(18)
    v_cvt_pk_bf16_f32 v92, v80, v81
    v_cvt_pk_bf16_f32 v93, v82, v83
    v_exp_f32 v84, v60
    v_exp_f32 v85, v61
    v_exp_f32 v86, v62
    v_exp_f32 v87, v63
    v_mfma_f32_32x32x16_bf16 v[48:63], a[112:115], v[16:19], 0
    buffer_load_dwordx4 v106, s[8:11], s70 offen offset:2048 lds
    buffer_load_dwordx4 v107, s[8:11], s70 offen offset:3072 lds
    v_cvt_pk_bf16_f32 v94, v84, v85
    v_cvt_pk_bf16_f32 v95, v86, v87
    v_exp_f32 v80, v64
    v_exp_f32 v81, v65
    v_exp_f32 v82, v66
    v_exp_f32 v83, v67
    v_mfma_f32_32x32x16_bf16 v[48:63], a[116:119], v[20:23], v[48:63]
    s_add_u32 m0, m0, 4096
    v_cvt_pk_bf16_f32 v88, v80, v81
    v_cvt_pk_bf16_f32 v89, v82, v83
    v_exp_f32 v84, v68
    v_exp_f32 v85, v69
    v_exp_f32 v86, v70
    v_exp_f32 v87, v71
    v_mfma_f32_32x32x16_bf16 a[32:47], a[108:111], v[92:95], a[32:47]
    s_add_u32 s70, s70, 28672
    v_cvt_pk_bf16_f32 v90, v84, v85
    v_cvt_pk_bf16_f32 v91, v86, v87
    v_exp_f32 v80, v72
    v_exp_f32 v81, v73
    v_exp_f32 v82, v74
    v_exp_f32 v83, v75
    v_mfma_f32_32x32x16_bf16 a[48:63], a[104:107], v[88:91], a[48:63]
    buffer_load_dwordx4 v104, s[8:11], s70 offen offset:0 lds
    v_cvt_pk_bf16_f32 v92, v80, v81
    v_cvt_pk_bf16_f32 v93, v82, v83
    v_exp_f32 v84, v76
    v_exp_f32 v85, v77
    v_exp_f32 v86, v78
    v_exp_f32 v87, v79
    v_mfma_f32_32x32x16_bf16 v[64:79], a[112:115], v[24:27], 0
    buffer_load_dwordx4 v105, s[8:11], s70 offen offset:1024 lds
    v_cvt_pk_bf16_f32 v94, v84, v85
    v_cvt_pk_bf16_f32 v95, v86, v87
    v_exp_f32 v80, v48
    v_exp_f32 v81, v49
    v_exp_f32 v82, v50
    v_exp_f32 v83, v51
    v_mfma_f32_32x32x16_bf16 v[64:79], a[116:119], v[28:31], v[64:79]
    buffer_load_dwordx4 v106, s[8:11], s70 offen offset:2048 lds
    v_cvt_pk_bf16_f32 v88, v80, v81
    v_cvt_pk_bf16_f32 v89, v82, v83
    v_exp_f32 v84, v52
    v_exp_f32 v85, v53
    v_exp_f32 v86, v54
    v_exp_f32 v87, v55
    v_mfma_f32_32x32x16_bf16 a[48:63], a[108:111], v[92:95], a[48:63]
    buffer_load_dwordx4 v107, s[8:11], s70 offen offset:3072 lds
    v_cvt_pk_bf16_f32 v90, v84, v85
    v_cvt_pk_bf16_f32 v91, v86, v87
    v_exp_f32 v80, v56
    v_exp_f32 v81, v57
    v_exp_f32 v82, v58
    v_exp_f32 v83, v59
    v_mfma_f32_32x32x16_bf16 v[160:175], a[120:123], v[88:91], v[160:175]
    s_add_u32 m0, m0, 4096
    v_cvt_pk_bf16_f32 v92, v80, v81
    v_cvt_pk_bf16_f32 v93, v82, v83
    v_exp_f32 v84, v60
    v_exp_f32 v85, v61
    v_exp_f32 v86, v62
    v_exp_f32 v87, v63
    v_mfma_f32_32x32x16_bf16 v[48:63], a[112:115], v[32:35], 0
    s_add_u32 s70, s70, 28672
    v_cvt_pk_bf16_f32 v94, v84, v85
    v_cvt_pk_bf16_f32 v95, v86, v87
    v_exp_f32 v80, v64
    v_exp_f32 v81, v65
    v_exp_f32 v82, v66
    v_exp_f32 v83, v67
    v_mfma_f32_32x32x16_bf16 v[48:63], a[116:119], v[36:39], v[48:63]
    buffer_load_dwordx4 v104, s[8:11], s70 offen offset:0 lds
    v_cvt_pk_bf16_f32 v88, v80, v81
    v_cvt_pk_bf16_f32 v89, v82, v83
    v_exp_f32 v84, v68
    v_exp_f32 v85, v69
    v_exp_f32 v86, v70
    v_exp_f32 v87, v71
    v_mfma_f32_32x32x16_bf16 v[160:175], a[124:127], v[92:95], v[160:175]
    buffer_load_dwordx4 v105, s[8:11], s70 offen offset:1024 lds
    v_cvt_pk_bf16_f32 v90, v84, v85
    v_cvt_pk_bf16_f32 v91, v86, v87
    v_exp_f32 v80, v72
    v_exp_f32 v81, v73
    v_exp_f32 v82, v74
    v_exp_f32 v83, v75
    v_mfma_f32_32x32x16_bf16 a[16:31], a[120:123], v[88:91], a[16:31]
    buffer_load_dwordx4 v106, s[8:11], s70 offen offset:2048 lds
    v_cvt_pk_bf16_f32 v92, v80, v81
    v_cvt_pk_bf16_f32 v93, v82, v83
    v_exp_f32 v84, v76
    v_exp_f32 v85, v77
    v_exp_f32 v86, v78
    v_exp_f32 v87, v79
    v_mfma_f32_32x32x16_bf16 v[64:79], a[112:115], v[40:43], 0
    buffer_load_dwordx4 v107, s[8:11], s70 offen offset:3072 lds
    v_cvt_pk_bf16_f32 v94, v84, v85
    v_cvt_pk_bf16_f32 v95, v86, v87
    v_exp_f32 v80, v48
    v_exp_f32 v81, v49
    v_exp_f32 v82, v50
    v_exp_f32 v83, v51
    v_mfma_f32_32x32x16_bf16 v[64:79], a[116:119], v[44:47], v[64:79]
    s_add_u32 m0, m0, 4096
    v_cvt_pk_bf16_f32 v88, v80, v81
    v_cvt_pk_bf16_f32 v89, v82, v83
    v_exp_f32 v84, v52
    v_exp_f32 v85, v53
    v_exp_f32 v86, v54
    v_exp_f32 v87, v55
    v_mfma_f32_32x32x16_bf16 a[16:31], a[124:127], v[92:95], a[16:31]
    s_add_u32 s70, s70, 28672
    v_cvt_pk_bf16_f32 v90, v84, v85
    v_cvt_pk_bf16_f32 v91, v86, v87
    v_exp_f32 v80, v56
    v_exp_f32 v81, v57
    v_exp_f32 v82, v58
    v_exp_f32 v83, v59
    v_mfma_f32_32x32x16_bf16 a[32:47], a[120:123], v[88:91], a[32:47]
    buffer_load_dwordx4 v104, s[8:11], s70 offen offset:0 lds
    v_cvt_pk_bf16_f32 v92, v80, v81
    v_cvt_pk_bf16_f32 v93, v82, v83
    v_exp_f32 v84, v60
    v_exp_f32 v85, v61
    v_exp_f32 v86, v62
    v_exp_f32 v87, v63
    buffer_load_dwordx4 v105, s[8:11], s70 offen offset:1024 lds
    s_nop 0
    v_cvt_pk_bf16_f32 v94, v84, v85
    v_cvt_pk_bf16_f32 v95, v86, v87
    v_exp_f32 v80, v64
    v_exp_f32 v81, v65
    v_exp_f32 v82, v66
    v_exp_f32 v83, v67
    global_load_dword v198, v103, s[26:27]
    s_nop 0
    v_cvt_pk_bf16_f32 v88, v80, v81
    v_cvt_pk_bf16_f32 v89, v82, v83
    v_exp_f32 v84, v68
    v_exp_f32 v85, v69
    v_exp_f32 v86, v70
    v_exp_f32 v87, v71
    v_mfma_f32_32x32x16_bf16 a[32:47], a[124:127], v[92:95], a[32:47]
    global_load_dword v198, v101, s[28:29]
    v_cvt_pk_bf16_f32 v90, v84, v85
    v_cvt_pk_bf16_f32 v91, v86, v87
    v_exp_f32 v80, v72
    v_exp_f32 v81, v73
    v_exp_f32 v82, v74
    v_exp_f32 v83, v75
    v_mfma_f32_32x32x16_bf16 a[48:63], a[120:123], v[88:91], a[48:63]
    v_cvt_pk_bf16_f32 v92, v80, v81
    v_cvt_pk_bf16_f32 v93, v82, v83
    v_exp_f32 v84, v76
    v_exp_f32 v85, v77
    v_exp_f32 v86, v78
    v_exp_f32 v87, v79
    s_nop 0
    v_cvt_pk_bf16_f32 v94, v84, v85
    v_cvt_pk_bf16_f32 v95, v86, v87
    s_mov_b32 s60, 0
    v_mov_b32 v9, 0x4e800000
    v_mfma_f32_32x32x16_bf16 a[48:63], a[124:127], v[92:95], a[48:63]
    v_cmp_nlt_f32 vcc, v172, v9
    v_accvgpr_read_b32 v6, a28
    s_or_b32 s60, s60, vcc_hi
    v_cmp_nlt_f32 vcc, v6, v9
    v_accvgpr_read_b32 v7, a44
    s_or_b32 s60, s60, vcc_hi
    v_cmp_nlt_f32 vcc, v7, v9
    ds_write_b128 v204, a[16:19] offset:0
    ds_write_b128 v204, a[20:23] offset:1024
    ds_write_b128 v204, a[24:27] offset:2048
    s_or_b32 s60, s60, vcc_hi
    ds_write_b128 v205, a[32:35] offset:0
    ds_write_b128 v205, a[36:39] offset:1024
    ds_write_b128 v205, a[40:43] offset:2048
    v_accvgpr_read_b32 v8, a60
    ds_write_b128 v206, a[48:51] offset:0
    ds_write_b128 v206, a[52:55] offset:1024
    ds_write_b128 v206, a[56:59] offset:2048
    v_cmp_nlt_f32 vcc, v8, v9
    s_mov_b32 exec_lo, 0
    s_or_b32 s60, s60, vcc_hi
    v_accvgpr_write_b32 a29, s60
    v_accvgpr_write_b32 a45, s60
    v_accvgpr_write_b32 a61, s60
    s_mov_b32 exec_lo, -1
    ds_write_b128 v204, a[28:31] offset:3072
    ds_write_b128 v205, a[44:47] offset:3072
    ds_write_b128 v206, a[60:63] offset:3072
    s_cmp_eq_u32 s38, 0
    s_cbranch_scc1 L_mode_loop
L_mode_ok:
    s_waitcnt vmcnt(16) lgkmcnt(0)
    s_barrier
    ds_read_b128 v[124:127], v207 offset:3072
    ds_read_b128 v[140:143], v207 offset:7168
    ds_read_b128 v[156:159], v207 offset:11264
    ds_read_b128 v[112:115], v207 offset:0
    ds_read_b128 v[128:131], v207 offset:4096
    ds_read_b128 v[144:147], v207 offset:8192
    ds_read_b128 v[116:119], v207 offset:1024
    ds_read_b128 v[132:135], v207 offset:5120
    ds_read_b128 v[148:151], v207 offset:9216
    ds_read_b128 v[120:123], v207 offset:2048
    ds_read_b128 v[136:139], v207 offset:6144
    ds_read_b128 v[152:155], v207 offset:10240
    s_waitcnt lgkmcnt(9)
    v_or3_b32 v6, v125, v141, v157
    v_pk_add_f32 v[172:173], v[172:173], v[124:125]
    v_pk_add_f32 v[140:141], v[140:141], v[156:157]
    v_pk_add_f32 v[174:175], v[174:175], v[126:127]
    v_pk_add_f32 v[142:143], v[142:143], v[158:159]
    v_readlane_b32 s61, v6, 32
    v_pk_add_f32 v[172:173], v[172:173], v[140:141]
    v_pk_add_f32 v[174:175], v[174:175], v[142:143]
    v_mov_b32 v5, v172
    v_mov_b32 v6, v172
    s_or_b32 s60, s60, s61
    s_cbranch_scc1 L_attn_ovf
L_attn_ok:
    v_permlane32_swap_b32 v6, v5
    v_rcp_f32 v6, v5
    s_waitcnt lgkmcnt(6)
    v_pk_add_f32 v[160:161], v[160:161], v[112:113]
    v_pk_add_f32 v[128:129], v[128:129], v[144:145]
    v_pk_add_f32 v[162:163], v[162:163], v[114:115]
    v_pk_add_f32 v[130:131], v[130:131], v[146:147]
    v_pk_add_f32 v[160:161], v[160:161], v[128:129]
    v_pk_add_f32 v[162:163], v[162:163], v[130:131]
    s_waitcnt lgkmcnt(3)
    v_pk_add_f32 v[164:165], v[164:165], v[116:117]
    v_pk_add_f32 v[132:133], v[132:133], v[148:149]
    v_pk_add_f32 v[166:167], v[166:167], v[118:119]
    v_pk_add_f32 v[134:135], v[134:135], v[150:151]
    v_pk_add_f32 v[164:165], v[164:165], v[132:133]
    v_pk_add_f32 v[166:167], v[166:167], v[134:135]
    s_waitcnt lgkmcnt(0)
    v_pk_add_f32 v[168:169], v[168:169], v[120:121]
    v_pk_add_f32 v[136:137], v[136:137], v[152:153]
    v_pk_add_f32 v[170:171], v[170:171], v[122:123]
    v_pk_add_f32 v[138:139], v[138:139], v[154:155]
    v_pk_add_f32 v[168:169], v[168:169], v[136:137]
    v_pk_add_f32 v[170:171], v[170:171], v[138:139]
    v_pk_mul_f32 v[160:161], v[160:161], v[6:7] op_sel_hi:[1,0]
    v_pk_mul_f32 v[162:163], v[162:163], v[6:7] op_sel_hi:[1,0]
    v_pk_mul_f32 v[164:165], v[164:165], v[6:7] op_sel_hi:[1,0]
    v_pk_mul_f32 v[166:167], v[166:167], v[6:7] op_sel_hi:[1,0]
    v_pk_mul_f32 v[168:169], v[168:169], v[6:7] op_sel_hi:[1,0]
    v_pk_mul_f32 v[170:171], v[170:171], v[6:7] op_sel_hi:[1,0]
    v_pk_mul_f32 v[172:173], v[172:173], v[6:7] op_sel_hi:[1,0]
    v_pk_mul_f32 v[174:175], v[174:175], v[6:7] op_sel_hi:[1,0]
    v_cvt_pk_bf16_f32 v112, v160, v161
    v_cvt_pk_bf16_f32 v113, v162, v163
    v_cvt_pk_bf16_f32 v114, v164, v165
    v_cvt_pk_bf16_f32 v115, v166, v167
    v_cvt_pk_bf16_f32 v116, v168, v169
    v_cvt_pk_bf16_f32 v117, v170, v171
    v_cvt_pk_bf16_f32 v118, v172, v173
    v_cvt_pk_bf16_f32 v119, v174, v175
    s_cmp_lg_u32 s48, 0
    s_cbranch_scc1 L_slow_9
    buffer_store_dwordx2 v[112:113], v192, s[4:7], 0 offen
    buffer_store_dwordx2 v[114:115], v193, s[4:7], 0 offen
    buffer_store_dwordx2 v[116:117], v194, s[4:7], 0 offen
    s_mov_b32 exec_hi, 0
    buffer_store_dwordx2 v[118:119], v195, s[4:7], 0 offen
    s_mov_b32 exec_hi, -1
L_join_10:
    s_mul_i32 s60, s51, 29184
    v_add_u32 v14, s60, v2
    v_xor_b32 v15, 512, v14
    ds_read_b64_tr_b16 a[0:1], v14 offset:0
    s_add_u32 s62, s97, 0
    ds_read_b64_tr_b16 a[2:3], v14 offset:1024
    v_add_u32 v8, s62, v1
    ds_read_b64_tr_b16 a[4:5], v15 offset:0
    s_add_u32 s87, s95, 262144
    ds_read_b64_tr_b16 a[6:7], v15 offset:1024
    s_add_u32 s88, s96, 229376
    ds_read_b64_tr_b16 a[8:9], v14 offset:2048
    s_lshl_b32 s61, s46, 5
    ds_read_b64_tr_b16 a[10:11], v14 offset:3072
    s_and_b32 s60, s44, 1
    ds_read_b64_tr_b16 a[12:13], v15 offset:2048
    s_add_u32 s61, s61, s60
    ds_read_b64_tr_b16 a[14:15], v15 offset:3072
    s_mov_b32 s72, 0x55555555
    ds_read_b64_tr_b16 a[16:17], v14 offset:4096
    s_mov_b32 s73, 0
    ds_read_b64_tr_b16 a[18:19], v14 offset:5120
    s_lshl_b64 s[72:73], s[72:73], s61
    ds_read_b64_tr_b16 a[20:21], v15 offset:4096
    v_mov_b32 v176, v3
    ds_read_b64_tr_b16 a[22:23], v15 offset:5120
    v_add_u32 v177, 6144, v3
    ds_read_b64_tr_b16 a[24:25], v14 offset:6144
    v_add_u32 v178, 12288, v3
    ds_read_b64_tr_b16 a[26:27], v14 offset:7168
    v_add_u32 v179, 18432, v3
    ds_read_b64_tr_b16 a[28:29], v15 offset:6144
    s_mov_b32 s8, s26
    s_waitcnt lgkmcnt(10)
    ds_read_b64_tr_b16 a[30:31], v15 offset:7168
    s_and_b32 s9, s27, 0xffff
    ds_read_b64_tr_b16 a[32:33], v14 offset:8192
    s_mov_b32 s10, 401408
    ds_read_b64_tr_b16 a[34:35], v14 offset:9216
    s_mov_b32 s11, 0x20000
    ds_read_b64_tr_b16 a[36:37], v15 offset:8192
    s_mul_i32 s70, s51, 28672
    ds_read_b64_tr_b16 a[38:39], v15 offset:9216
    s_add_u32 s70, s70, s99
    s_waitcnt lgkmcnt(10)
    ds_read_b64_tr_b16 a[40:41], v14 offset:10240
    s_add_u32 m0, s70, 0
    ds_read_b64_tr_b16 a[42:43], v14 offset:11264
    s_mul_i32 s70, s41, 100352
    ds_read_b64_tr_b16 a[44:45], v15 offset:10240
    s_mul_i32 s67, s45, 128
    ds_read_b64_tr_b16 a[46:47], v15 offset:11264
    s_add_u32 s70, s70, s67
    ds_read_b64_tr_b16 a[48:49], v14 offset:12288
    s_waitcnt lgkmcnt(10)
    ds_read_b64_tr_b16 a[50:51], v14 offset:13312
    ds_read_b64_tr_b16 a[52:53], v15 offset:12288
    ds_read_b64_tr_b16 a[54:55], v15 offset:13312
    ds_read_b64_tr_b16 a[56:57], v14 offset:14336
    ds_read_b64_tr_b16 a[58:59], v14 offset:15360
    s_waitcnt lgkmcnt(10)
    ds_read_b64_tr_b16 a[60:61], v15 offset:14336
    ds_read_b64_tr_b16 a[62:63], v15 offset:15360
    ds_read_b64_tr_b16 a[64:65], v14 offset:16384
    ds_read_b64_tr_b16 a[66:67], v14 offset:17408
    ds_read_b64_tr_b16 a[68:69], v15 offset:16384
    s_waitcnt lgkmcnt(10)
    ds_read_b64_tr_b16 a[70:71], v15 offset:17408
    ds_read_b64_tr_b16 a[72:73], v14 offset:18432
    ds_read_b64_tr_b16 a[74:75], v14 offset:19456
    ds_read_b64_tr_b16 a[76:77], v15 offset:18432
    ds_read_b64_tr_b16 a[78:79], v15 offset:19456
    s_waitcnt lgkmcnt(10)
    ds_read_b64_tr_b16 a[80:81], v14 offset:20480
    ds_read_b64_tr_b16 a[82:83], v14 offset:21504
    ds_read_b64_tr_b16 a[84:85], v15 offset:20480
    ds_read_b64_tr_b16 a[86:87], v15 offset:21504
    ds_read_b64_tr_b16 a[88:89], v14 offset:22528
    s_waitcnt lgkmcnt(10)
    ds_read_b64_tr_b16 a[90:91], v14 offset:23552
    ds_read_b64_tr_b16 a[92:93], v15 offset:22528
    ds_read_b64_tr_b16 a[94:95], v15 offset:23552
    ds_read_b64_tr_b16 a[96:97], v14 offset:24576
    ds_read_b64_tr_b16 a[98:99], v14 offset:25600
    s_waitcnt lgkmcnt(10)
    ds_read_b64_tr_b16 a[100:101], v15 offset:24576
    ds_read_b64_tr_b16 a[102:103], v15 offset:25600
    ds_read_b64_tr_b16 a[104:105], v14 offset:26624
    ds_read_b64_tr_b16 a[106:107], v14 offset:27648
    ds_read_b64_tr_b16 a[108:109], v15 offset:26624
    s_waitcnt lgkmcnt(10)
    ds_read_b64_tr_b16 a[110:111], v15 offset:27648
    s_add_u32 s22, s3, 1
    v_mov_b32 v5, s22
    s_mov_b64 exec, 1
    s_waitcnt vmcnt(0)
    s_cmp_lg_u32 s48, 0
    s_cbranch_scc1 L_slow_11
    buffer_store_dword v5, off, s[4:7], s82
L_join_12:
    s_mov_b64 exec, -1
    s_waitcnt lgkmcnt(0)
    s_barrier
    s_cmp_ge_u32 s40, 28
    s_cbranch_scc1 L_idle
    s_mul_i32 s60, s51, 29184
    s_add_u32 s60, s60, 57344
    v_add_u32 v14, s60, v2
    v_xor_b32 v15, 512, v14
    s_cmp_eq_u32 s38, 0
    s_cbranch_scc1 L_xr0_13
    buffer_load_dwordx4 v176, s[8:11], s70 offen offset:0 lds
    buffer_load_dwordx4 v177, s[8:11], s70 offen offset:1024 lds
    buffer_load_dwordx4 v178, s[8:11], s70 offen offset:2048 lds
    buffer_load_dwordx4 v179, s[8:11], s70 offen offset:3072 lds
    s_add_u32 m0, m0, 4096
    s_add_u32 s70, s70, 28672
    buffer_load_dwordx4 v176, s[8:11], s70 offen offset:0 lds
    buffer_load_dwordx4 v177, s[8:11], s70 offen offset:1024 lds
    buffer_load_dwordx4 v178, s[8:11], s70 offen offset:2048 lds
    buffer_load_dwordx4 v179, s[8:11], s70 offen offset:3072 lds
    s_add_u32 m0, m0, 4096
    s_add_u32 s70, s70, 28672
    buffer_load_dwordx4 v176, s[8:11], s70 offen offset:0 lds
    buffer_load_dwordx4 v177, s[8:11], s70 offen offset:1024 lds
    v_accvgpr_read_b32 v16, a200
    v_accvgpr_read_b32 v17, a201
    v_accvgpr_read_b32 v18, a202
    v_accvgpr_read_b32 v19, a203
    v_accvgpr_read_b32 v20, a204
    v_accvgpr_read_b32 v21, a205
    v_accvgpr_read_b32 v22, a206
    v_accvgpr_read_b32 v23, a207
    v_accvgpr_read_b32 v24, a208
    v_accvgpr_read_b32 v25, a209
    v_accvgpr_read_b32 v26, a210
    v_accvgpr_read_b32 v27, a211
    v_accvgpr_read_b32 v28, a212
    v_accvgpr_read_b32 v29, a213
    v_accvgpr_read_b32 v30, a214
    v_accvgpr_read_b32 v31, a215
L_xr2_14:
    buffer_load_dword v202, v4, s[4:7], 0 offen sc1
    s_add_u32 s22, s3, 1
    s_mov_b32 s74, 0
L_poll_16:
    s_waitcnt vmcnt(0)
    v_subrev_u32 v202, s22, v202
    v_cmp_lt_u32 vcc, 31, v202
    s_and_b64 s[60:61], vcc, s[72:73]
    s_cbranch_scc0 L_poll_done_15
    buffer_load_dword v202, v4, s[4:7], 0 offen sc1
    s_add_u32 s74, s74, 1
    s_cmp_lt_u32 s74, 200000
    s_cbranch_scc1 L_poll_16
    s_waitcnt vmcnt(0)
L_poll_done_15:
    buffer_load_dwordx4 a[112:115], v8, s[4:7], 0 offen offset:0 sc1
    buffer_load_dwordx4 a[116:119], v8, s[4:7], 0 offen offset:1024 sc1
    buffer_load_dwordx4 a[120:123], v8, s[4:7], 0 offen offset:2048 sc1
    s_barrier
    buffer_load_dwordx4 a[124:127], v8, s[4:7], 0 offen offset:3072 sc1
    buffer_load_dwordx4 a[128:131], v8, s[4:7], s52 offen offset:0 sc1
    buffer_load_dwordx4 a[132:135], v8, s[4:7], s52 offen offset:1024 sc1
    s_barrier
    buffer_load_dwordx4 a[136:139], v8, s[4:7], s52 offen offset:2048 sc1
    buffer_load_dwordx4 a[140:143], v8, s[4:7], s52 offen offset:3072 sc1
    s_waitcnt vmcnt(7)
    v_mfma_f32_32x32x16_bf16 v[48:63], a[4:7], a[112:115], 0
    ds_read_b64_tr_b16 a[168:169], v14 offset:0
    ds_read_b64_tr_b16 a[170:171], v14 offset:1024
    buffer_load_dwordx4 a[144:147], v8, s[4:7], s53 offen offset:0 sc1
    v_mfma_f32_32x32x16_bf16 v[32:47], a[0:3], a[112:115], 0
    ds_read_b64_tr_b16 a[172:173], v15 offset:0
    ds_read_b64_tr_b16 a[174:175], v15 offset:1024
    s_waitcnt vmcnt(7)
    v_mfma_f32_32x32x16_bf16 v[48:63], a[12:15], a[116:119], v[48:63]
    ds_read_b64_tr_b16 a[176:177], v14 offset:2048
    ds_read_b64_tr_b16 a[178:179], v14 offset:3072
    buffer_load_dwordx4 a[148:151], v8, s[4:7], s53 offen offset:1024 sc1
    v_mfma_f32_32x32x16_bf16 v[32:47], a[8:11], a[116:119], v[32:47]
    ds_read_b64_tr_b16 a[180:181], v15 offset:2048
    ds_read_b64_tr_b16 a[182:183], v15 offset:3072
    s_waitcnt vmcnt(7)
    v_mfma_f32_32x32x16_bf16 v[48:63], a[20:23], a[120:123], v[48:63]
    ds_read_b64_tr_b16 a[184:185], v14 offset:4096
    ds_read_b64_tr_b16 a[186:187], v14 offset:5120
    buffer_load_dwordx4 a[152:155], v8, s[4:7], s53 offen offset:2048 sc1
    v_mfma_f32_32x32x16_bf16 v[32:47], a[16:19], a[120:123], v[32:47]
    ds_read_b64_tr_b16 a[188:189], v15 offset:4096
    ds_read_b64_tr_b16 a[190:191], v15 offset:5120
    s_waitcnt vmcnt(7)
    v_mfma_f32_32x32x16_bf16 v[48:63], a[28:31], a[124:127], v[48:63]
    ds_read_b64_tr_b16 a[192:193], v14 offset:6144
    ds_read_b64_tr_b16 a[194:195], v14 offset:7168
    buffer_load_dwordx4 a[156:159], v8, s[4:7], s53 offen offset:3072 sc1
    v_mfma_f32_32x32x16_bf16 v[32:47], a[24:27], a[124:127], v[32:47]
    ds_read_b64_tr_b16 a[196:197], v15 offset:6144
    s_waitcnt lgkmcnt(10)
    ds_read_b64_tr_b16 a[198:199], v15 offset:7168
    s_waitcnt vmcnt(7)
    v_mfma_f32_32x32x16_bf16 v[48:63], a[36:39], a[128:131], v[48:63]
    ds_read_b64_tr_b16 v[208:209], v14 offset:8192
    ds_read_b64_tr_b16 v[210:211], v14 offset:9216
    buffer_load_dwordx4 a[160:163], v8, s[4:7], s54 offen offset:0 sc1
    v_mfma_f32_32x32x16_bf16 v[32:47], a[32:35], a[128:131], v[32:47]
    ds_read_b64_tr_b16 v[212:213], v15 offset:8192
    ds_read_b64_tr_b16 v[214:215], v15 offset:9216
    s_waitcnt vmcnt(7)
    v_mfma_f32_32x32x16_bf16 v[48:63], a[44:47], a[132:135], v[48:63]
    s_waitcnt lgkmcnt(10)
    ds_read_b64_tr_b16 v[216:217], v14 offset:10240
    ds_read_b64_tr_b16 v[218:219], v14 offset:11264
    buffer_load_dwordx4 a[164:167], v8, s[4:7], s54 offen offset:1024 sc1
    v_mfma_f32_32x32x16_bf16 v[32:47], a[40:43], a[132:135], v[32:47]
    ds_read_b64_tr_b16 v[220:221], v15 offset:10240
    ds_read_b64_tr_b16 v[222:223], v15 offset:11264
    s_waitcnt vmcnt(7)
    v_mfma_f32_32x32x16_bf16 v[48:63], a[52:55], a[136:139], v[48:63]
    ds_read_b64_tr_b16 v[224:225], v14 offset:12288
    s_waitcnt lgkmcnt(10)
    ds_read_b64_tr_b16 v[226:227], v14 offset:13312
    v_mfma_f32_32x32x16_bf16 v[32:47], a[48:51], a[136:139], v[32:47]
    ds_read_b64_tr_b16 v[228:229], v15 offset:12288
    ds_read_b64_tr_b16 v[230:231], v15 offset:13312
    s_waitcnt vmcnt(6)
    v_mfma_f32_32x32x16_bf16 v[48:63], a[60:63], a[140:143], v[48:63]
    ds_read_b64_tr_b16 v[232:233], v14 offset:14336
    ds_read_b64_tr_b16 v[234:235], v14 offset:15360
    v_mfma_f32_32x32x16_bf16 v[32:47], a[56:59], a[140:143], v[32:47]
    s_waitcnt lgkmcnt(10)
    ds_read_b64_tr_b16 v[236:237], v15 offset:14336
    ds_read_b64_tr_b16 v[238:239], v15 offset:15360
    s_waitcnt vmcnt(5)
    v_mfma_f32_32x32x16_bf16 v[48:63], a[68:71], a[144:147], v[48:63]
    ds_read_b64_tr_b16 v[152:153], v14 offset:16384
    ds_read_b64_tr_b16 v[154:155], v14 offset:17408
    v_mfma_f32_32x32x16_bf16 v[32:47], a[64:67], a[144:147], v[32:47]
    ds_read_b64_tr_b16 v[156:157], v15 offset:16384
    s_waitcnt lgkmcnt(10)
    ds_read_b64_tr_b16 v[158:159], v15 offset:17408
    s_waitcnt vmcnt(4)
    v_mfma_f32_32x32x16_bf16 v[48:63], a[76:79], a[148:151], v[48:63]
    ds_read_b64_tr_b16 v[160:161], v14 offset:18432
    ds_read_b64_tr_b16 v[162:163], v14 offset:19456
    v_mfma_f32_32x32x16_bf16 v[32:47], a[72:75], a[148:151], v[32:47]
    ds_read_b64_tr_b16 v[164:165], v15 offset:18432
    ds_read_b64_tr_b16 v[166:167], v15 offset:19456
    s_waitcnt vmcnt(3)
    v_mfma_f32_32x32x16_bf16 v[48:63], a[84:87], a[152:155], v[48:63]
    s_waitcnt lgkmcnt(10)
    ds_read_b64_tr_b16 v[168:169], v14 offset:20480
    ds_read_b64_tr_b16 v[170:171], v14 offset:21504
    v_mfma_f32_32x32x16_bf16 v[32:47], a[80:83], a[152:155], v[32:47]
    ds_read_b64_tr_b16 v[172:173], v15 offset:20480
    ds_read_b64_tr_b16 v[174:175], v15 offset:21504
    s_waitcnt vmcnt(2)
    v_mfma_f32_32x32x16_bf16 v[48:63], a[92:95], a[156:159], v[48:63]
    ds_read_b64_tr_b16 v[120:121], v14 offset:22528
    s_waitcnt lgkmcnt(10)
    ds_read_b64_tr_b16 v[122:123], v14 offset:23552
    v_mfma_f32_32x32x16_bf16 v[32:47], a[88:91], a[156:159], v[32:47]
    ds_read_b64_tr_b16 v[124:125], v15 offset:22528
    ds_read_b64_tr_b16 v[126:127], v15 offset:23552
    s_waitcnt vmcnt(1)
    v_mfma_f32_32x32x16_bf16 v[48:63], a[100:103], a[160:163], v[48:63]
    ds_read_b64_tr_b16 v[128:129], v14 offset:24576
    ds_read_b64_tr_b16 v[130:131], v14 offset:25600
    v_mfma_f32_32x32x16_bf16 v[32:47], a[96:99], a[160:163], v[32:47]
    s_waitcnt lgkmcnt(10)
    ds_read_b64_tr_b16 v[132:133], v15 offset:24576
    ds_read_b64_tr_b16 v[134:135], v15 offset:25600
    s_waitcnt vmcnt(0)
    v_mfma_f32_32x32x16_bf16 v[48:63], a[108:111], a[164:167], v[48:63]
    ds_read_b64_tr_b16 v[136:137], v14 offset:26624
    ds_read_b64_tr_b16 v[138:139], v14 offset:27648
    v_mfma_f32_32x32x16_bf16 v[32:47], a[104:107], a[164:167], v[32:47]
    ds_read_b64_tr_b16 v[140:141], v15 offset:26624
    s_waitcnt lgkmcnt(10)
    ds_read_b64_tr_b16 v[142:143], v15 offset:27648
    buffer_load_dwordx4 v178, s[8:11], s70 offen offset:2048 lds
    s_nop 9
    ds_write_b128 v199, v[48:51] offset:0
    ds_write_b128 v199, v[52:55] offset:1024
    ds_write_b128 v199, v[56:59] offset:2048
    ds_write_b128 v199, v[60:63] offset:3072
    v_pk_add_f32 v[16:17], v[16:17], v[32:33]
    v_pk_add_f32 v[18:19], v[18:19], v[34:35]
    v_pk_add_f32 v[20:21], v[20:21], v[36:37]
    v_pk_add_f32 v[22:23], v[22:23], v[38:39]
    v_pk_add_f32 v[24:25], v[24:25], v[40:41]
    v_pk_add_f32 v[26:27], v[26:27], v[42:43]
    v_pk_add_f32 v[28:29], v[28:29], v[44:45]
    v_pk_add_f32 v[30:31], v[30:31], v[46:47]
    buffer_load_dwordx4 v179, s[8:11], s70 offen offset:3072 lds
    s_waitcnt lgkmcnt(0)
    s_barrier
    ds_read_b128 v[64:67], v200 offset:0
    ds_read_b128 v[68:71], v200 offset:1024
    ds_read_b128 v[72:75], v200 offset:2048
    ds_read_b128 v[76:79], v200 offset:3072
    s_add_u32 m0, m0, 4096
    s_add_u32 s70, s70, 28672
    buffer_load_dwordx4 v176, s[8:11], s70 offen offset:0 lds
    buffer_load_dwordx4 v177, s[8:11], s70 offen offset:1024 lds
    s_waitcnt lgkmcnt(3)
    v_pk_add_f32 v[16:17], v[16:17], v[64:65]
    v_pk_add_f32 v[18:19], v[18:19], v[66:67]
    s_waitcnt lgkmcnt(2)
    v_pk_add_f32 v[20:21], v[20:21], v[68:69]
    v_pk_add_f32 v[22:23], v[22:23], v[70:71]
    s_waitcnt lgkmcnt(1)
    v_pk_add_f32 v[24:25], v[24:25], v[72:73]
    v_pk_add_f32 v[26:27], v[26:27], v[74:75]
    s_waitcnt lgkmcnt(0)
    v_pk_add_f32 v[28:29], v[28:29], v[76:77]
    v_pk_add_f32 v[30:31], v[30:31], v[78:79]
    v_cvt_pk_bf16_f32 v144, v16, v17
    v_cvt_pk_bf16_f32 v145, v18, v19
    v_cvt_pk_bf16_f32 v146, v20, v21
    v_cvt_pk_bf16_f32 v147, v22, v23
    v_cvt_pk_bf16_f32 v148, v24, v25
    v_cvt_pk_bf16_f32 v149, v26, v27
    v_cvt_pk_bf16_f32 v150, v28, v29
    v_cvt_pk_bf16_f32 v151, v30, v31
    s_cmp_lg_u32 s48, 0
    s_cbranch_scc1 L_slow_17
    buffer_store_dwordx4 v[144:147], v1, s[4:7], s87 offen offset:0
    buffer_store_dwordx4 v[148:151], v1, s[4:7], s87 offen offset:1024
L_join_18:
    v_pk_add_f32 v[112:113], v[16:17], v[18:19]
    v_pk_mul_f32 v[114:115], v[16:17], v[16:17]
    v_pk_add_f32 v[116:117], v[20:21], v[22:23]
    v_pk_mul_f32 v[118:119], v[18:19], v[18:19]
    v_pk_fma_f32 v[114:115], v[20:21], v[20:21], v[114:115]
    v_pk_fma_f32 v[118:119], v[22:23], v[22:23], v[118:119]
    v_pk_fma_f32 v[114:115], v[24:25], v[24:25], v[114:115]
    v_pk_add_f32 v[112:113], v[112:113], v[24:25]
    v_pk_fma_f32 v[118:119], v[26:27], v[26:27], v[118:119]
    v_pk_add_f32 v[116:117], v[116:117], v[26:27]
    v_pk_fma_f32 v[114:115], v[28:29], v[28:29], v[114:115]
    v_pk_add_f32 v[112:113], v[112:113], v[28:29]
    v_pk_fma_f32 v[118:119], v[30:31], v[30:31], v[118:119]
    v_pk_add_f32 v[116:117], v[116:117], v[30:31]
    v_pk_add_f32 v[112:113], v[112:113], v[116:117]
    v_pk_add_f32 v[114:115], v[114:115], v[118:119]
    v_add_f32 v112, v112, v113
    v_add_f32 v113, v114, v115
    s_nop 1
    v_permlane32_swap_b32 v112, v113
    v_add_f32 v112, v112, v113
    s_cmp_lg_u32 s48, 0
    s_cbranch_scc1 L_slow_19
    buffer_store_dword v112, v1, s[4:7], s88 offen
L_join_20:
    s_add_u32 s62, s97, 262144
    v_add_u32 v8, s62, v1
    s_add_u32 s87, s95, 0
    s_mul_i32 s61, s44, 14
    s_mov_b32 s72, 0x3fff
    s_mov_b32 s73, 0
    s_lshl_b64 s[72:73], s[72:73], s61
    s_lshl_b32 s88, s84, 12
    s_add_u32 s88, s88, s80
    s_add_u32 s88, s88, 229376
    v_mov_b32 v176, v240
    v_add_u32 v177, 27648, v240
    v_add_u32 v178, 55296, v240
    v_add_u32 v179, 82944, v240
    s_mov_b32 s8, s28
    s_and_b32 s9, s29, 0xffff
    s_mov_b32 s10, 1605632
    s_mov_b32 s11, 0x20000
    s_mul_i32 s70, s51, 28672
    s_add_u32 s70, s70, s99
    s_add_u32 m0, s70, 57344
    s_mul_i32 s70, s41, 401408
    s_mul_i32 s67, s47, 256
    s_add_u32 s70, s70, s67
    buffer_load_dwordx4 v176, s[8:11], s70 offen offset:0 lds
    buffer_load_dwordx4 v177, s[8:11], s70 offen offset:1024 lds
    buffer_load_dwordx4 v178, s[8:11], s70 offen offset:2048 lds
    buffer_load_dwordx4 v179, s[8:11], s70 offen offset:3072 lds
    s_add_u32 s22, s3, 2
    v_mov_b32 v5, s22
    s_mov_b64 exec, 1
    s_waitcnt vmcnt(4)
    s_cmp_lg_u32 s48, 0
    s_cbranch_scc1 L_slow_21
    buffer_store_dword v5, off, s[4:7], s82
L_join_22:
    s_mov_b64 exec, -1
    s_mul_i32 s60, s51, 29184
    v_add_u32 v14, s60, v2
    v_xor_b32 v15, 512, v14
    s_add_u32 m0, m0, 4096
    s_add_u32 s70, s70, 114688
    buffer_load_dwordx4 v176, s[8:11], s70 offen offset:0 lds
    buffer_load_dwordx4 v177, s[8:11], s70 offen offset:1024 lds
    buffer_load_dwordx4 v178, s[8:11], s70 offen offset:2048 lds
    buffer_load_dwordx4 v179, s[8:11], s70 offen offset:3072 lds
    s_add_u32 m0, m0, 4096
    s_add_u32 s70, s70, 114688
    buffer_load_dwordx4 v176, s[8:11], s70 offen offset:0 lds
    buffer_load_dwordx4 v177, s[8:11], s70 offen offset:1024 lds
    buffer_load_dword v202, v4, s[4:7], 0 offen sc1
    v_accvgpr_read_b32 v96, a216
    v_accvgpr_read_b32 v97, a217
    v_accvgpr_read_b32 v98, a218
    v_accvgpr_read_b32 v99, a219
    v_accvgpr_read_b32 v100, a220
    v_accvgpr_read_b32 v101, a221
    v_accvgpr_read_b32 v102, a222
    v_accvgpr_read_b32 v103, a223
    v_accvgpr_read_b32 v104, a224
    v_accvgpr_read_b32 v105, a225
    v_accvgpr_read_b32 v106, a226
    v_accvgpr_read_b32 v107, a227
    v_accvgpr_read_b32 v108, a228
    v_accvgpr_read_b32 v109, a229
    v_accvgpr_read_b32 v110, a230
    v_accvgpr_read_b32 v111, a231
    s_add_u32 s22, s3, 2
    s_mov_b32 s74, 0
L_poll_24:
    s_waitcnt vmcnt(0)
    v_subrev_u32 v202, s22, v202
    v_cmp_lt_u32 vcc, 31, v202
    s_and_b64 s[60:61], vcc, s[72:73]
    s_cbranch_scc0 L_poll_done_23
    buffer_load_dword v202, v4, s[4:7], 0 offen sc1
    s_add_u32 s74, s74, 1
    s_cmp_lt_u32 s74, 200000
    s_cbranch_scc1 L_poll_24
    s_waitcnt vmcnt(0)
L_poll_done_23:
    buffer_load_dwordx4 a[112:115], v8, s[4:7], 0 offen offset:0 sc1
    buffer_load_dwordx4 a[116:119], v8, s[4:7], 0 offen offset:1024 sc1
    buffer_load_dwordx4 a[120:123], v8, s[4:7], 0 offen offset:2048 sc1
    s_barrier
    buffer_load_dwordx4 a[124:127], v8, s[4:7], 0 offen offset:3072 sc1
    buffer_load_dwordx4 a[128:131], v8, s[4:7], s52 offen offset:0 sc1
    buffer_load_dwordx4 a[132:135], v8, s[4:7], s52 offen offset:1024 sc1
    s_barrier
    buffer_load_dwordx4 a[136:139], v8, s[4:7], s52 offen offset:2048 sc1
    buffer_load_dwordx4 a[140:143], v8, s[4:7], s52 offen offset:3072 sc1
    s_waitcnt vmcnt(7)
    v_mfma_f32_32x32x16_bf16 v[48:63], a[172:175], a[112:115], 0
    ds_read_b64_tr_b16 a[0:1], v14 offset:0
    ds_read_b64_tr_b16 a[2:3], v14 offset:1024
    buffer_load_dwordx4 a[144:147], v8, s[4:7], s53 offen offset:0 sc1
    v_mfma_f32_32x32x16_bf16 v[32:47], a[168:171], a[112:115], 0
    ds_read_b64_tr_b16 a[4:5], v15 offset:0
    ds_read_b64_tr_b16 a[6:7], v15 offset:1024
    s_waitcnt vmcnt(7)
    v_mfma_f32_32x32x16_bf16 v[48:63], a[180:183], a[116:119], v[48:63]
    ds_read_b64_tr_b16 a[8:9], v14 offset:2048
    ds_read_b64_tr_b16 a[10:11], v14 offset:3072
    buffer_load_dwordx4 a[148:151], v8, s[4:7], s53 offen offset:1024 sc1
    v_mfma_f32_32x32x16_bf16 v[32:47], a[176:179], a[116:119], v[32:47]
    ds_read_b64_tr_b16 a[12:13], v15 offset:2048
    ds_read_b64_tr_b16 a[14:15], v15 offset:3072
    s_waitcnt vmcnt(7)
    v_mfma_f32_32x32x16_bf16 v[48:63], a[188:191], a[120:123], v[48:63]
    ds_read_b64_tr_b16 a[16:17], v14 offset:4096
    ds_read_b64_tr_b16 a[18:19], v14 offset:5120
    buffer_load_dwordx4 a[152:155], v8, s[4:7], s53 offen offset:2048 sc1
    v_mfma_f32_32x32x16_bf16 v[32:47], a[184:187], a[120:123], v[32:47]
    ds_read_b64_tr_b16 a[20:21], v15 offset:4096
    ds_read_b64_tr_b16 a[22:23], v15 offset:5120
    s_waitcnt vmcnt(7)
    v_mfma_f32_32x32x16_bf16 v[48:63], a[196:199], a[124:127], v[48:63]
    ds_read_b64_tr_b16 a[24:25], v14 offset:6144
    ds_read_b64_tr_b16 a[26:27], v14 offset:7168
    buffer_load_dwordx4 a[156:159], v8, s[4:7], s53 offen offset:3072 sc1
    v_mfma_f32_32x32x16_bf16 v[32:47], a[192:195], a[124:127], v[32:47]
    ds_read_b64_tr_b16 a[28:29], v15 offset:6144
    s_waitcnt lgkmcnt(10)
    ds_read_b64_tr_b16 a[30:31], v15 offset:7168
    s_waitcnt vmcnt(7)
    v_mfma_f32_32x32x16_bf16 v[48:63], v[212:215], a[128:131], v[48:63]
    ds_read_b64_tr_b16 a[32:33], v14 offset:8192
    ds_read_b64_tr_b16 a[34:35], v14 offset:9216
    buffer_load_dwordx4 a[160:163], v8, s[4:7], s54 offen offset:0 sc1
    v_mfma_f32_32x32x16_bf16 v[32:47], v[208:211], a[128:131], v[32:47]
    ds_read_b64_tr_b16 a[36:37], v15 offset:8192
    ds_read_b64_tr_b16 a[38:39], v15 offset:9216
    s_waitcnt vmcnt(7)
    v_mfma_f32_32x32x16_bf16 v[48:63], v[220:223], a[132:135], v[48:63]
    s_waitcnt lgkmcnt(10)
    ds_read_b64_tr_b16 a[40:41], v14 offset:10240
    ds_read_b64_tr_b16 a[42:43], v14 offset:11264
    buffer_load_dwordx4 a[164:167], v8, s[4:7], s54 offen offset:1024 sc1
    v_mfma_f32_32x32x16_bf16 v[32:47], v[216:219], a[132:135], v[32:47]
    ds_read_b64_tr_b16 a[44:45], v15 offset:10240
    ds_read_b64_tr_b16 a[46:47], v15 offset:11264
    s_waitcnt vmcnt(7)
    v_mfma_f32_32x32x16_bf16 v[48:63], v[228:231], a[136:139], v[48:63]
    ds_read_b64_tr_b16 a[48:49], v14 offset:12288
    s_waitcnt lgkmcnt(10)
    ds_read_b64_tr_b16 a[50:51], v14 offset:13312
    buffer_load_dwordx4 v[80:83], v1, s[4:7], s88 offen offset:0 sc1
    v_mfma_f32_32x32x16_bf16 v[32:47], v[224:227], a[136:139], v[32:47]
    ds_read_b64_tr_b16 a[52:53], v15 offset:12288
    ds_read_b64_tr_b16 a[54:55], v15 offset:13312
    s_waitcnt vmcnt(7)
    v_mfma_f32_32x32x16_bf16 v[48:63], v[236:239], a[140:143], v[48:63]
    ds_read_b64_tr_b16 a[56:57], v14 offset:14336
    ds_read_b64_tr_b16 a[58:59], v14 offset:15360
    buffer_load_dwordx4 v[84:87], v1, s[4:7], s88 offen offset:1024 sc1
    v_mfma_f32_32x32x16_bf16 v[32:47], v[232:235], a[140:143], v[32:47]
    s_waitcnt lgkmcnt(10)
    ds_read_b64_tr_b16 a[60:61], v15 offset:14336
    ds_read_b64_tr_b16 a[62:63], v15 offset:15360
    s_waitcnt vmcnt(7)
    v_mfma_f32_32x32x16_bf16 v[48:63], v[156:159], a[144:147], v[48:63]
    ds_read_b64_tr_b16 a[64:65], v14 offset:16384
    ds_read_b64_tr_b16 a[66:67], v14 offset:17408
    buffer_load_dwordx4 v[88:91], v1, s[4:7], s88 offen offset:2048 sc1
    v_mfma_f32_32x32x16_bf16 v[32:47], v[152:155], a[144:147], v[32:47]
    ds_read_b64_tr_b16 a[68:69], v15 offset:16384
    s_waitcnt lgkmcnt(10)
    ds_read_b64_tr_b16 a[70:71], v15 offset:17408
    s_waitcnt vmcnt(7)
    v_mfma_f32_32x32x16_bf16 v[48:63], v[164:167], a[148:151], v[48:63]
    ds_read_b64_tr_b16 a[72:73], v14 offset:18432
    ds_read_b64_tr_b16 a[74:75], v14 offset:19456
    buffer_load_dwordx2 v[92:93], v1, s[4:7], s88 offen offset:3072 sc1
    v_mfma_f32_32x32x16_bf16 v[32:47], v[160:163], a[148:151], v[32:47]
    ds_read_b64_tr_b16 a[76:77], v15 offset:18432
    ds_read_b64_tr_b16 a[78:79], v15 offset:19456
    s_waitcnt vmcnt(7)
    v_mfma_f32_32x32x16_bf16 v[48:63], v[172:175], a[152:155], v[48:63]
    s_waitcnt lgkmcnt(10)
    ds_read_b64_tr_b16 a[80:81], v14 offset:20480
    ds_read_b64_tr_b16 a[82:83], v14 offset:21504
    v_mfma_f32_32x32x16_bf16 v[32:47], v[168:171], a[152:155], v[32:47]
    ds_read_b64_tr_b16 a[84:85], v15 offset:20480
    ds_read_b64_tr_b16 a[86:87], v15 offset:21504
    s_waitcnt vmcnt(6)
    v_mfma_f32_32x32x16_bf16 v[48:63], v[124:127], a[156:159], v[48:63]
    ds_read_b64_tr_b16 a[88:89], v14 offset:22528
    s_waitcnt lgkmcnt(10)
    ds_read_b64_tr_b16 a[90:91], v14 offset:23552
    v_mfma_f32_32x32x16_bf16 v[32:47], v[120:123], a[156:159], v[32:47]
    ds_read_b64_tr_b16 a[92:93], v15 offset:22528
    ds_read_b64_tr_b16 a[94:95], v15 offset:23552
    s_waitcnt vmcnt(5)
    v_mfma_f32_32x32x16_bf16 v[48:63], v[132:135], a[160:163], v[48:63]
    ds_read_b64_tr_b16 a[96:97], v14 offset:24576
    ds_read_b64_tr_b16 a[98:99], v14 offset:25600
    v_mfma_f32_32x32x16_bf16 v[32:47], v[128:131], a[160:163], v[32:47]
    s_waitcnt lgkmcnt(10)
    ds_read_b64_tr_b16 a[100:101], v15 offset:24576
    ds_read_b64_tr_b16 a[102:103], v15 offset:25600
    s_waitcnt vmcnt(4)
    v_mfma_f32_32x32x16_bf16 v[48:63], v[140:143], a[164:167], v[48:63]
    ds_read_b64_tr_b16 a[104:105], v14 offset:26624
    ds_read_b64_tr_b16 a[106:107], v14 offset:27648
    v_mfma_f32_32x32x16_bf16 v[32:47], v[136:139], a[164:167], v[32:47]
    ds_read_b64_tr_b16 a[108:109], v15 offset:26624
    s_waitcnt lgkmcnt(10)
    ds_read_b64_tr_b16 a[110:111], v15 offset:27648
    buffer_load_dwordx4 v178, s[8:11], s70 offen offset:2048 lds
    s_nop 9
    ds_write_b128 v199, v[48:51] offset:0
    ds_write_b128 v199, v[52:55] offset:1024
    ds_write_b128 v199, v[56:59] offset:2048
    ds_write_b128 v199, v[60:63] offset:3072
    s_waitcnt vmcnt(1)
    v_add_f32 v80, v80, v87
    v_add_f32 v81, v81, v88
    v_add_f32 v82, v82, v89
    v_add_f32 v83, v83, v90
    v_add_f32 v84, v84, v91
    v_add_f32 v85, v85, v92
    v_add_f32 v86, v86, v93
    v_add_f32 v80, v80, v83
    v_add_f32 v81, v81, v84
    v_add_f32 v82, v82, v85
    v_add_f32 v80, v80, v86
    v_add_f32 v81, v81, v82
    v_add_f32 v80, v80, v81
    v_mov_b32 v81, v80
    s_nop 1
    v_permlane32_swap_b32 v81, v80
    v_mul_f32 v12, 0x3b124925, v81
    v_mul_f32 v80, 0x3b124925, v80
    v_fma_f32 v81, -v12, v12, v80
    v_max_f32 v81, 0, v81
    v_add_f32 v86, 0x3727c5ac, v81
    v_rsq_f32 v13, v86
    v_sub_f32 v82, 0, v12
    v_mul_f32 v86, v13, v13
    v_mov_b32 v83, 0x3727c5ac
    v_fmac_f32 v83, v86, v81
    v_rsq_f32 v86, v83
    s_nop 0
    v_mul_f32 v86, v86, v13
    v_rcp_f32 v85, v86
    v_mul_f32 v84, v86, v86
    v_mul_f32 v83, 0xc0135761, v86
    v_mul_f32 v84, v84, v86
    v_mul_f32 v84, 0xbdd2d3e8, v84
    v_pk_fma_f32 v[32:33], v[82:83], v[96:97], v[32:33] op_sel_hi:[0,1,1]
    v_pk_fma_f32 v[34:35], v[82:83], v[98:99], v[34:35] op_sel_hi:[0,1,1]
    v_pk_fma_f32 v[36:37], v[82:83], v[100:101], v[36:37] op_sel_hi:[0,1,1]
    v_pk_fma_f32 v[38:39], v[82:83], v[102:103], v[38:39] op_sel_hi:[0,1,1]
    v_pk_fma_f32 v[40:41], v[82:83], v[104:105], v[40:41] op_sel_hi:[0,1,1]
    v_pk_fma_f32 v[42:43], v[82:83], v[106:107], v[42:43] op_sel_hi:[0,1,1]
    v_pk_fma_f32 v[44:45], v[82:83], v[108:109], v[44:45] op_sel_hi:[0,1,1]
    v_pk_fma_f32 v[46:47], v[82:83], v[110:111], v[46:47] op_sel_hi:[0,1,1]
    buffer_load_dwordx4 v179, s[8:11], s70 offen offset:3072 lds
    s_waitcnt lgkmcnt(0)
    s_barrier
    ds_read_b128 v[64:67], v200 offset:0
    ds_read_b128 v[68:71], v200 offset:1024
    ds_read_b128 v[72:75], v200 offset:2048
    ds_read_b128 v[76:79], v200 offset:3072
    s_add_u32 m0, m0, 4096
    s_add_u32 s70, s70, 114688
    buffer_load_dwordx4 v176, s[8:11], s70 offen offset:0 lds
    buffer_load_dwordx4 v177, s[8:11], s70 offen offset:1024 lds
    s_waitcnt lgkmcnt(3)
    v_pk_add_f32 v[32:33], v[32:33], v[64:65]
    v_pk_add_f32 v[34:35], v[34:35], v[66:67]
    s_waitcnt lgkmcnt(2)
    v_pk_add_f32 v[36:37], v[36:37], v[68:69]
    v_pk_add_f32 v[38:39], v[38:39], v[70:71]
    s_waitcnt lgkmcnt(1)
    v_pk_add_f32 v[40:41], v[40:41], v[72:73]
    v_pk_add_f32 v[42:43], v[42:43], v[74:75]
    s_waitcnt lgkmcnt(0)
    v_pk_add_f32 v[44:45], v[44:45], v[76:77]
    v_pk_add_f32 v[46:47], v[46:47], v[78:79]
    v_pk_mul_f32 v[112:113], v[32:33], v[32:33]
    v_pk_mul_f32 v[114:115], v[34:35], v[34:35]
    v_pk_fma_f32 v[112:113], v[112:113], v[84:85], v[82:83] op_sel:[0,0,1] op_sel_hi:[1,0,1]
    v_pk_fma_f32 v[114:115], v[114:115], v[84:85], v[82:83] op_sel:[0,0,1] op_sel_hi:[1,0,1]
    v_pk_mul_f32 v[112:113], v[112:113], v[32:33]
    v_pk_mul_f32 v[114:115], v[114:115], v[34:35]
    v_exp_f32 v112, v112
    v_exp_f32 v113, v113
    v_exp_f32 v114, v114
    v_exp_f32 v115, v115
    v_pk_fma_f32 v[112:113], v[112:113], v[84:85], v[84:85] op_sel:[0,1,1]
    v_pk_fma_f32 v[114:115], v[114:115], v[84:85], v[84:85] op_sel:[0,1,1]
    v_rcp_f32 v112, v112
    v_rcp_f32 v113, v113
    v_rcp_f32 v114, v114
    v_rcp_f32 v115, v115
    v_pk_mul_f32 v[112:113], v[112:113], v[32:33]
    v_pk_mul_f32 v[114:115], v[114:115], v[34:35]
    v_cvt_pk_bf16_f32 v144, v112, v113
    v_cvt_pk_bf16_f32 v145, v114, v115
    v_pk_mul_f32 v[116:117], v[36:37], v[36:37]
    v_pk_mul_f32 v[118:119], v[38:39], v[38:39]
    v_pk_fma_f32 v[116:117], v[116:117], v[84:85], v[82:83] op_sel:[0,0,1] op_sel_hi:[1,0,1]
    v_pk_fma_f32 v[118:119], v[118:119], v[84:85], v[82:83] op_sel:[0,0,1] op_sel_hi:[1,0,1]
    v_pk_mul_f32 v[116:117], v[116:117], v[36:37]
    v_pk_mul_f32 v[118:119], v[118:119], v[38:39]
    v_exp_f32 v116, v116
    v_exp_f32 v117, v117
    v_exp_f32 v118, v118
    v_exp_f32 v119, v119
    v_pk_fma_f32 v[116:117], v[116:117], v[84:85], v[84:85] op_sel:[0,1,1]
    v_pk_fma_f32 v[118:119], v[118:119], v[84:85], v[84:85] op_sel:[0,1,1]
    v_rcp_f32 v116, v116
    v_rcp_f32 v117, v117
    v_rcp_f32 v118, v118
    v_rcp_f32 v119, v119
    v_pk_mul_f32 v[116:117], v[116:117], v[36:37]
    v_pk_mul_f32 v[118:119], v[118:119], v[38:39]
    v_cvt_pk_bf16_f32 v146, v116, v117
    v_cvt_pk_bf16_f32 v147, v118, v119
    v_pk_mul_f32 v[112:113], v[40:41], v[40:41]
    v_pk_mul_f32 v[114:115], v[42:43], v[42:43]
    v_pk_fma_f32 v[112:113], v[112:113], v[84:85], v[82:83] op_sel:[0,0,1] op_sel_hi:[1,0,1]
    v_pk_fma_f32 v[114:115], v[114:115], v[84:85], v[82:83] op_sel:[0,0,1] op_sel_hi:[1,0,1]
    v_pk_mul_f32 v[112:113], v[112:113], v[40:41]
    v_pk_mul_f32 v[114:115], v[114:115], v[42:43]
    v_exp_f32 v112, v112
    v_exp_f32 v113, v113
    v_exp_f32 v114, v114
    v_exp_f32 v115, v115
    v_pk_fma_f32 v[112:113], v[112:113], v[84:85], v[84:85] op_sel:[0,1,1]
    v_pk_fma_f32 v[114:115], v[114:115], v[84:85], v[84:85] op_sel:[0,1,1]
    v_rcp_f32 v112, v112
    v_rcp_f32 v113, v113
    v_rcp_f32 v114, v114
    v_rcp_f32 v115, v115
    v_pk_mul_f32 v[112:113], v[112:113], v[40:41]
    v_pk_mul_f32 v[114:115], v[114:115], v[42:43]
    v_cvt_pk_bf16_f32 v148, v112, v113
    v_cvt_pk_bf16_f32 v149, v114, v115
    v_pk_mul_f32 v[116:117], v[44:45], v[44:45]
    v_pk_mul_f32 v[118:119], v[46:47], v[46:47]
    v_pk_fma_f32 v[116:117], v[116:117], v[84:85], v[82:83] op_sel:[0,0,1] op_sel_hi:[1,0,1]
    v_pk_fma_f32 v[118:119], v[118:119], v[84:85], v[82:83] op_sel:[0,0,1] op_sel_hi:[1,0,1]
    v_pk_mul_f32 v[116:117], v[116:117], v[44:45]
    v_pk_mul_f32 v[118:119], v[118:119], v[46:47]
    v_exp_f32 v116, v116
    v_exp_f32 v117, v117
    v_exp_f32 v118, v118
    v_exp_f32 v119, v119
    v_pk_fma_f32 v[116:117], v[116:117], v[84:85], v[84:85] op_sel:[0,1,1]
    v_pk_fma_f32 v[118:119], v[118:119], v[84:85], v[84:85] op_sel:[0,1,1]
    v_rcp_f32 v116, v116
    v_rcp_f32 v117, v117
    v_rcp_f32 v118, v118
    v_rcp_f32 v119, v119
    v_pk_mul_f32 v[116:117], v[116:117], v[44:45]
    v_pk_mul_f32 v[118:119], v[118:119], v[46:47]
    v_cvt_pk_bf16_f32 v150, v116, v117
    v_cvt_pk_bf16_f32 v151, v118, v119
    s_cmp_eq_u32 s98, 0
    s_cbranch_scc1 L_nohalo_25
    s_mov_b32 exec_lo, s98
    s_mov_b32 exec_hi, s98
    s_add_u32 s63, s87, s101
    buffer_store_dwordx4 v[144:147], v1, s[4:7], s63 offen offset:0 sc1
    buffer_store_dwordx4 v[148:151], v1, s[4:7], s63 offen offset:1024 sc1
    s_mov_b64 exec, -1
L_nohalo_25:
    s_cmp_lg_u32 s48, 0
    s_cbranch_scc1 L_slow_26
    buffer_store_dwordx4 v[144:147], v1, s[4:7], s87 offen offset:0
    buffer_store_dwordx4 v[148:151], v1, s[4:7], s87 offen offset:1024
L_join_27:
    s_add_u32 s87, s95, 262144
    s_add_u32 s88, s96, 229376
    v_mov_b32 v176, v240
    v_add_u32 v177, 27648, v240
    v_add_u32 v178, 55296, v240
    v_add_u32 v179, 82944, v240
    s_mov_b32 s8, s28
    s_and_b32 s9, s29, 0xffff
    s_mov_b32 s10, 1605632
    s_mov_b32 s11, 0x20000
    s_mul_i32 s70, s51, 4294832128
    s_add_u32 s70, s70, s99
    s_add_u32 m0, s70, 135168
    s_mul_i32 s70, s41, 401408
    s_mul_i32 s67, s47, 256
    s_add_u32 s70, s70, s67
    s_add_u32 s70, s70, 128
    buffer_load_dwordx4 v176, s[8:11], s70 offen offset:0 lds
    buffer_load_dwordx4 v177, s[8:11], s70 offen offset:1024 lds
    buffer_load_dwordx4 v178, s[8:11], s70 offen offset:2048 lds
    buffer_load_dwordx4 v179, s[8:11], s70 offen offset:3072 lds
    s_add_u32 s22, s3, 3
    v_mov_b32 v5, s22
    s_mov_b64 exec, 1
    s_waitcnt vmcnt(4)
    s_cmp_eq_u32 s98, 0
    s_cbranch_scc1 L_nohf_28
    buffer_store_dword v5, off, s[4:7], s90 sc1
L_nohf_28:
    s_cmp_lg_u32 s48, 0
    s_cbranch_scc1 L_slow_29
    buffer_store_dword v5, off, s[4:7], s82
L_join_30:
    s_mov_b64 exec, -1
    s_add_u32 m0, m0, 4096
    s_add_u32 s70, s70, 114688
    buffer_load_dwordx4 v176, s[8:11], s70 offen offset:0 lds
    buffer_load_dwordx4 v177, s[8:11], s70 offen offset:1024 lds
    buffer_load_dwordx4 v178, s[8:11], s70 offen offset:2048 lds
    buffer_load_dwordx4 v179, s[8:11], s70 offen offset:3072 lds
    s_add_u32 m0, m0, 4096
    s_add_u32 s70, s70, 114688
    buffer_load_dwordx4 v176, s[8:11], s70 offen offset:0 lds
    buffer_load_dwordx4 v177, s[8:11], s70 offen offset:1024 lds
    v_mul_f32 v112, v12, v13
    v_pk_fma_f32 v[152:153], v[16:17], v[12:13], v[112:113] op_sel:[0,1,0] op_sel_hi:[1,1,0] neg_lo:[0,0,1] neg_hi:[0,0,1]
    v_pk_fma_f32 v[154:155], v[18:19], v[12:13], v[112:113] op_sel:[0,1,0] op_sel_hi:[1,1,0] neg_lo:[0,0,1] neg_hi:[0,0,1]
    v_pk_fma_f32 v[156:157], v[20:21], v[12:13], v[112:113] op_sel:[0,1,0] op_sel_hi:[1,1,0] neg_lo:[0,0,1] neg_hi:[0,0,1]
    v_pk_fma_f32 v[158:159], v[22:23], v[12:13], v[112:113] op_sel:[0,1,0] op_sel_hi:[1,1,0] neg_lo:[0,0,1] neg_hi:[0,0,1]
    v_pk_fma_f32 v[160:161], v[24:25], v[12:13], v[112:113] op_sel:[0,1,0] op_sel_hi:[1,1,0] neg_lo:[0,0,1] neg_hi:[0,0,1]
    v_pk_fma_f32 v[162:163], v[26:27], v[12:13], v[112:113] op_sel:[0,1,0] op_sel_hi:[1,1,0] neg_lo:[0,0,1] neg_hi:[0,0,1]
    v_pk_fma_f32 v[164:165], v[28:29], v[12:13], v[112:113] op_sel:[0,1,0] op_sel_hi:[1,1,0] neg_lo:[0,0,1] neg_hi:[0,0,1]
    v_pk_fma_f32 v[166:167], v[30:31], v[12:13], v[112:113] op_sel:[0,1,0] op_sel_hi:[1,1,0] neg_lo:[0,0,1] neg_hi:[0,0,1]
    buffer_load_dwordx2 v[6:7], v241, s[4:7], 0 offen sc1
    s_mov_b32 s74, 0
    s_add_u32 s22, s3, 3
L_poll_32:
    s_waitcnt vmcnt(0)
    v_subrev_u32 v6, s22, v6
    v_subrev_u32 v7, s22, v7
    v_cmp_lt_u32 vcc, 31, v6
    s_and_b64 s[60:61], vcc, s[0:1]
    v_cmp_lt_u32 vcc, 31, v7
    s_and_b64 s[62:63], vcc, s[36:37]
    s_or_b64 s[60:61], s[60:61], s[62:63]
    s_cbranch_scc0 L_poll_done_31
    buffer_load_dwordx2 v[6:7], v241, s[4:7], 0 offen sc1
    s_add_u32 s74, s74, 1
    s_cmp_lt_u32 s74, 200000
    s_cbranch_scc1 L_poll_32
    s_waitcnt vmcnt(0)
L_poll_done_31:
    buffer_load_dwordx4 a[112:115], v242, s[4:7], 0 offen offset:0 sc1
    buffer_load_dwordx4 a[116:119], v242, s[4:7], 0 offen offset:1024 sc1
    buffer_load_dwordx4 a[120:123], v242, s[4:7], 0 offen offset:2048 sc1
    s_barrier
    buffer_load_dwordx4 a[124:127], v242, s[4:7], 0 offen offset:3072 sc1
    buffer_load_dwordx4 a[128:131], v242, s[4:7], s52 offen offset:0 sc1
    buffer_load_dwordx4 a[132:135], v242, s[4:7], s52 offen offset:1024 sc1
    s_barrier
    buffer_load_dwordx4 a[136:139], v242, s[4:7], s52 offen offset:2048 sc1
    buffer_load_dwordx4 a[140:143], v243, s[4:7], s52 offen offset:3072 sc1
    s_waitcnt vmcnt(7)
    v_mfma_f32_32x32x16_bf16 v[48:63], a[4:7], a[112:115], 0
    buffer_load_dwordx4 a[144:147], v243, s[4:7], s53 offen offset:0 sc1
    v_mfma_f32_32x32x16_bf16 v[32:47], a[0:3], a[112:115], 0
    s_waitcnt vmcnt(7)
    v_mfma_f32_32x32x16_bf16 v[48:63], a[12:15], a[116:119], v[48:63]
    buffer_load_dwordx4 a[148:151], v243, s[4:7], s53 offen offset:1024 sc1
    v_mfma_f32_32x32x16_bf16 v[32:47], a[8:11], a[116:119], v[32:47]
    s_waitcnt vmcnt(7)
    v_mfma_f32_32x32x16_bf16 v[48:63], a[20:23], a[120:123], v[48:63]
    buffer_load_dwordx4 a[152:155], v243, s[4:7], s53 offen offset:2048 sc1
    v_mfma_f32_32x32x16_bf16 v[32:47], a[16:19], a[120:123], v[32:47]
    s_waitcnt vmcnt(7)
    v_mfma_f32_32x32x16_bf16 v[48:63], a[28:31], a[124:127], v[48:63]
    buffer_load_dwordx4 a[156:159], v243, s[4:7], s53 offen offset:3072 sc1
    v_mfma_f32_32x32x16_bf16 v[32:47], a[24:27], a[124:127], v[32:47]
    s_waitcnt vmcnt(7)
    v_mfma_f32_32x32x16_bf16 v[48:63], a[36:39], a[128:131], v[48:63]
    buffer_load_dwordx4 a[160:163], v243, s[4:7], s54 offen offset:0 sc1
    v_mfma_f32_32x32x16_bf16 v[32:47], a[32:35], a[128:131], v[32:47]
    s_waitcnt vmcnt(7)
    v_mfma_f32_32x32x16_bf16 v[48:63], a[44:47], a[132:135], v[48:63]
    buffer_load_dwordx4 a[164:167], v243, s[4:7], s54 offen offset:1024 sc1
    v_mfma_f32_32x32x16_bf16 v[32:47], a[40:43], a[132:135], v[32:47]
    s_waitcnt vmcnt(7)
    v_mfma_f32_32x32x16_bf16 v[48:63], a[52:55], a[136:139], v[48:63]
    v_mfma_f32_32x32x16_bf16 v[32:47], a[48:51], a[136:139], v[32:47]
    s_waitcnt vmcnt(6)
    v_mfma_f32_32x32x16_bf16 v[48:63], a[60:63], a[140:143], v[48:63]
    v_mfma_f32_32x32x16_bf16 v[32:47], a[56:59], a[140:143], v[32:47]
    s_waitcnt vmcnt(5)
    v_mfma_f32_32x32x16_bf16 v[48:63], a[68:71], a[144:147], v[48:63]
    v_mfma_f32_32x32x16_bf16 v[32:47], a[64:67], a[144:147], v[32:47]
    s_waitcnt vmcnt(4)
    v_mfma_f32_32x32x16_bf16 v[48:63], a[76:79], a[148:151], v[48:63]
    v_mfma_f32_32x32x16_bf16 v[32:47], a[72:75], a[148:151], v[32:47]
    s_waitcnt vmcnt(3)
    v_mfma_f32_32x32x16_bf16 v[48:63], a[84:87], a[152:155], v[48:63]
    v_mfma_f32_32x32x16_bf16 v[32:47], a[80:83], a[152:155], v[32:47]
    s_waitcnt vmcnt(2)
    v_mfma_f32_32x32x16_bf16 v[48:63], a[92:95], a[156:159], v[48:63]
    v_mfma_f32_32x32x16_bf16 v[32:47], a[88:91], a[156:159], v[32:47]
    s_waitcnt vmcnt(1)
    v_mfma_f32_32x32x16_bf16 v[48:63], a[100:103], a[160:163], v[48:63]
    v_mfma_f32_32x32x16_bf16 v[32:47], a[96:99], a[160:163], v[32:47]
    s_waitcnt vmcnt(0)
    v_mfma_f32_32x32x16_bf16 v[48:63], a[108:111], a[164:167], v[48:63]
    v_mfma_f32_32x32x16_bf16 v[32:47], a[104:107], a[164:167], v[32:47]
    buffer_load_dwordx4 v178, s[8:11], s70 offen offset:2048 lds
    s_nop 9
    ds_write_b128 v199, v[48:51] offset:0
    ds_write_b128 v199, v[52:55] offset:1024
    ds_write_b128 v199, v[56:59] offset:2048
    ds_write_b128 v199, v[60:63] offset:3072
    v_pk_add_f32 v[32:33], v[32:33], v[152:153]
    v_pk_add_f32 v[34:35], v[34:35], v[154:155]
    v_pk_add_f32 v[36:37], v[36:37], v[156:157]
    v_pk_add_f32 v[38:39], v[38:39], v[158:159]
    v_pk_add_f32 v[40:41], v[40:41], v[160:161]
    v_pk_add_f32 v[42:43], v[42:43], v[162:163]
    v_pk_add_f32 v[44:45], v[44:45], v[164:165]
    v_pk_add_f32 v[46:47], v[46:47], v[166:167]
    buffer_load_dwordx4 v179, s[8:11], s70 offen offset:3072 lds
    s_waitcnt lgkmcnt(0)
    s_barrier
    ds_read_b128 v[64:67], v200 offset:0
    ds_read_b128 v[68:71], v200 offset:1024
    ds_read_b128 v[72:75], v200 offset:2048
    ds_read_b128 v[76:79], v200 offset:3072
    s_add_u32 m0, m0, 4096
    s_add_u32 s70, s70, 114688
    buffer_load_dwordx4 v176, s[8:11], s70 offen offset:0 lds
    buffer_load_dwordx4 v177, s[8:11], s70 offen offset:1024 lds
    s_waitcnt lgkmcnt(3)
    v_pk_add_f32 v[32:33], v[32:33], v[64:65]
    v_pk_add_f32 v[34:35], v[34:35], v[66:67]
    s_waitcnt lgkmcnt(2)
    v_pk_add_f32 v[36:37], v[36:37], v[68:69]
    v_pk_add_f32 v[38:39], v[38:39], v[70:71]
    s_waitcnt lgkmcnt(1)
    v_pk_add_f32 v[40:41], v[40:41], v[72:73]
    v_pk_add_f32 v[42:43], v[42:43], v[74:75]
    s_waitcnt lgkmcnt(0)
    v_pk_add_f32 v[44:45], v[44:45], v[76:77]
    v_pk_add_f32 v[46:47], v[46:47], v[78:79]
    v_cvt_pk_bf16_f32 v144, v32, v33
    v_cvt_pk_bf16_f32 v145, v34, v35
    v_cvt_pk_bf16_f32 v146, v36, v37
    v_cvt_pk_bf16_f32 v147, v38, v39
    v_cvt_pk_bf16_f32 v148, v40, v41
    v_cvt_pk_bf16_f32 v149, v42, v43
    v_cvt_pk_bf16_f32 v150, v44, v45
    v_cvt_pk_bf16_f32 v151, v46, v47
    s_cmp_lg_u32 s48, 0
    s_cbranch_scc1 L_slow_33
    buffer_store_dwordx4 v[144:147], v1, s[4:7], s87 offen offset:0
    buffer_store_dwordx4 v[148:151], v1, s[4:7], s87 offen offset:1024
L_join_34:
    v_pk_add_f32 v[112:113], v[32:33], v[34:35]
    v_pk_mul_f32 v[114:115], v[32:33], v[32:33]
    v_pk_add_f32 v[116:117], v[36:37], v[38:39]
    v_pk_mul_f32 v[118:119], v[34:35], v[34:35]
    v_pk_fma_f32 v[114:115], v[36:37], v[36:37], v[114:115]
    v_pk_fma_f32 v[118:119], v[38:39], v[38:39], v[118:119]
    v_pk_fma_f32 v[114:115], v[40:41], v[40:41], v[114:115]
    v_pk_add_f32 v[112:113], v[112:113], v[40:41]
    v_pk_fma_f32 v[118:119], v[42:43], v[42:43], v[118:119]
    v_pk_add_f32 v[116:117], v[116:117], v[42:43]
    v_pk_fma_f32 v[114:115], v[44:45], v[44:45], v[114:115]
    v_pk_add_f32 v[112:113], v[112:113], v[44:45]
    v_pk_fma_f32 v[118:119], v[46:47], v[46:47], v[118:119]
    v_pk_add_f32 v[116:117], v[116:117], v[46:47]
    v_pk_add_f32 v[112:113], v[112:113], v[116:117]
    v_pk_add_f32 v[114:115], v[114:115], v[118:119]
    v_add_f32 v112, v112, v113
    v_add_f32 v113, v114, v115
    s_nop 1
    v_permlane32_swap_b32 v112, v113
    v_add_f32 v112, v112, v113
    s_cmp_lg_u32 s48, 0
    s_cbranch_scc1 L_slow_35
    buffer_store_dword v112, v1, s[4:7], s88 offen
L_join_36:
    v_pk_add_f32 v[16:17], v[16:17], v[32:33]
    v_pk_add_f32 v[18:19], v[18:19], v[34:35]
    v_pk_add_f32 v[20:21], v[20:21], v[36:37]
    v_pk_add_f32 v[22:23], v[22:23], v[38:39]
    v_pk_add_f32 v[24:25], v[24:25], v[40:41]
    v_pk_add_f32 v[26:27], v[26:27], v[42:43]
    v_pk_add_f32 v[28:29], v[28:29], v[44:45]
    v_pk_add_f32 v[30:31], v[30:31], v[46:47]
    s_lshl_b32 s62, s39, 3
    s_lshl_b32 s63, s46, 2
    s_add_u32 s62, s62, s63
    s_add_u32 s66, s62, s41
    s_mul_i32 s62, s66, 28672
    s_add_u32 s62, s62, s49
    s_add_u32 s62, s62, 262144
    v_add_u32 v8, s62, v1
    s_mul_i32 s65, s66, 114688
    s_lshl_b32 s63, s47, 13
    s_add_u32 s65, s65, s63
    s_add_u32 s65, s65, s81
    s_add_u32 s87, s65, 491520
    v_add_u32 v9, s87, v1
    s_lshl_b32 s88, s66, 12
    s_add_u32 s88, s88, s80
    s_add_u32 s88, s88, 229376
    s_lshl_b32 s61, s46, 1
    s_add_u32 s61, s61, s51
    s_mul_i32 s61, s61, 14
    s_mov_b32 s72, 0x3fff
    s_mov_b32 s73, 0
    s_lshl_b64 s[72:73], s[72:73], s61
    s_mov_b32 s8, s30
    s_and_b32 s9, s31, 0xffff
    s_mov_b32 s10, 1605632
    s_mov_b32 s11, 0x20000
    s_mul_i32 s92, s41, 7168
    s_mul_i32 s91, s51, 802816
    s_mul_i32 s67, s50, 50176
    s_add_u32 s91, s91, s67
    s_lshl_b32 s67, s45, 7
    s_add_u32 s91, s91, s67
    v_mov_b32 v176, v3
    v_add_u32 v177, 6144, v3
    v_add_u32 v178, 12288, v3
    v_add_u32 v179, 18432, v3
    s_add_u32 s22, s3, 4
    v_mov_b32 v5, s22
    s_mov_b64 exec, 1
    s_waitcnt vmcnt(0)
    s_cmp_lg_u32 s48, 0
    s_cbranch_scc1 L_slow_37
    buffer_store_dword v5, off, s[4:7], s82
L_join_38:
    s_mov_b64 exec, -1
    v_lshlrev_b32 v10, 3, v0
    v_add_u32 v10, 131072, v10
    s_cmp_eq_u32 s38, 0
    s_cbranch_scc1 L_cs0_39
    s_add_u32 m0, s92, 28672
    s_add_u32 s70, s91, 0
    buffer_load_dwordx4 v176, s[8:11], s70 offen offset:0 lds
    buffer_load_dwordx4 v177, s[8:11], s70 offen offset:1024 lds
    buffer_load_dwordx4 v178, s[8:11], s70 offen offset:2048 lds
    buffer_load_dwordx4 v179, s[8:11], s70 offen offset:3072 lds
    s_add_u32 m0, m0, 4096
    s_add_u32 s70, s70, 28672
    buffer_load_dwordx4 v176, s[8:11], s70 offen offset:0 lds
    buffer_load_dwordx4 v177, s[8:11], s70 offen offset:1024 lds
    buffer_load_dwordx4 v178, s[8:11], s70 offen offset:2048 lds
    buffer_load_dword v202, v4, s[4:7], 0 offen sc1
    ds_write_b64 v10, a[232:233]
    s_waitcnt lgkmcnt(0)
L_cs1_40:
    v_add_u32 v14, 57344, v2
    v_add_u32 v15, 135168, v2
    ds_read_b64_tr_b16 a[128:129], v14 offset:0
    ds_read_b64_tr_b16 a[130:131], v14 offset:1024
    ds_read_b64_tr_b16 a[132:133], v14 offset:512
    ds_read_b64_tr_b16 a[134:135], v14 offset:1536
    ds_read_b64_tr_b16 a[136:137], v14 offset:2048
    ds_read_b64_tr_b16 a[138:139], v14 offset:3072
    ds_read_b64_tr_b16 a[140:141], v14 offset:2560
    ds_read_b64_tr_b16 a[142:143], v14 offset:3584
    s_add_u32 s22, s3, 4
    s_mov_b32 s74, 0
L_poll_42:
    s_waitcnt vmcnt(0)
    v_subrev_u32 v202, s22, v202
    v_cmp_lt_u32 vcc, 31, v202
    s_and_b64 s[60:61], vcc, s[72:73]
    s_cbranch_scc0 L_poll_done_41
    buffer_load_dword v202, v4, s[4:7], 0 offen sc1
    s_add_u32 s74, s74, 1
    s_cmp_lt_u32 s74, 200000
    s_cbranch_scc1 L_poll_42
    s_waitcnt vmcnt(0)
L_poll_done_41:
    buffer_load_dwordx4 a[0:3], v8, s[4:7], 0 offen offset:0 sc1
    buffer_load_dwordx4 a[4:7], v8, s[4:7], 0 offen offset:1024 sc1
    buffer_load_dwordx4 a[8:11], v8, s[4:7], 0 offen offset:2048 sc1
    s_barrier
    buffer_load_dwordx4 a[12:15], v8, s[4:7], 0 offen offset:3072 sc1
    buffer_load_dwordx4 a[16:19], v8, s[4:7], s52 offen offset:0 sc1
    buffer_load_dwordx4 a[20:23], v8, s[4:7], s52 offen offset:1024 sc1
    s_barrier
    buffer_load_dwordx4 a[24:27], v8, s[4:7], s52 offen offset:2048 sc1
    buffer_load_dwordx4 a[28:31], v8, s[4:7], s52 offen offset:3072 sc1
    buffer_load_dwordx4 a[32:35], v8, s[4:7], s53 offen offset:0 sc1
    buffer_load_dwordx4 a[36:39], v8, s[4:7], s53 offen offset:1024 sc1
    s_waitcnt vmcnt(9) lgkmcnt(4)
    v_mfma_f32_32x32x16_bf16 v[32:47], a[128:131], a[0:3], 0
    ds_read_b64_tr_b16 a[144:145], v14 offset:4096
    ds_read_b64_tr_b16 a[146:147], v14 offset:5120
    buffer_load_dwordx4 a[40:43], v8, s[4:7], s53 offen offset:2048 sc1
    v_mfma_f32_32x32x16_bf16 v[48:63], a[132:135], a[0:3], 0
    ds_read_b64_tr_b16 a[148:149], v14 offset:4608
    ds_read_b64_tr_b16 a[150:151], v14 offset:5632
    s_waitcnt vmcnt(9) lgkmcnt(4)
    v_mfma_f32_32x32x16_bf16 v[32:47], a[136:139], a[4:7], v[32:47]
    ds_read_b64_tr_b16 a[128:129], v14 offset:6144
    ds_read_b64_tr_b16 a[130:131], v14 offset:7168
    buffer_load_dwordx4 a[44:47], v8, s[4:7], s53 offen offset:3072 sc1
    v_mfma_f32_32x32x16_bf16 v[48:63], a[140:143], a[4:7], v[48:63]
    ds_read_b64_tr_b16 a[132:133], v14 offset:6656
    ds_read_b64_tr_b16 a[134:135], v14 offset:7680
    s_waitcnt vmcnt(9) lgkmcnt(4)
    v_mfma_f32_32x32x16_bf16 v[32:47], a[144:147], a[8:11], v[32:47]
    ds_read_b64_tr_b16 a[136:137], v14 offset:8192
    ds_read_b64_tr_b16 a[138:139], v14 offset:9216
    buffer_load_dwordx4 a[48:51], v8, s[4:7], s54 offen offset:0 sc1
    v_mfma_f32_32x32x16_bf16 v[48:63], a[148:151], a[8:11], v[48:63]
    ds_read_b64_tr_b16 a[140:141], v14 offset:8704
    ds_read_b64_tr_b16 a[142:143], v14 offset:9728
    s_waitcnt vmcnt(9) lgkmcnt(4)
    v_mfma_f32_32x32x16_bf16 v[32:47], a[128:131], a[12:15], v[32:47]
    ds_read_b64_tr_b16 a[144:145], v14 offset:10240
    ds_read_b64_tr_b16 a[146:147], v14 offset:11264
    buffer_load_dwordx4 a[52:55], v8, s[4:7], s54 offen offset:1024 sc1
    v_mfma_f32_32x32x16_bf16 v[48:63], a[132:135], a[12:15], v[48:63]
    ds_read_b64_tr_b16 a[148:149], v14 offset:10752
    ds_read_b64_tr_b16 a[150:151], v14 offset:11776
    s_waitcnt vmcnt(9) lgkmcnt(4)
    v_mfma_f32_32x32x16_bf16 v[32:47], a[136:139], a[16:19], v[32:47]
    ds_read_b64_tr_b16 a[128:129], v14 offset:12288
    ds_read_b64_tr_b16 a[130:131], v14 offset:13312
    buffer_load_dwordx4 a[56:59], v8, s[4:7], s54 offen offset:2048 sc1
    v_mfma_f32_32x32x16_bf16 v[48:63], a[140:143], a[16:19], v[48:63]
    ds_read_b64_tr_b16 a[132:133], v14 offset:12800
    ds_read_b64_tr_b16 a[134:135], v14 offset:13824
    s_waitcnt vmcnt(9) lgkmcnt(4)
    v_mfma_f32_32x32x16_bf16 v[32:47], a[144:147], a[20:23], v[32:47]
    ds_read_b64_tr_b16 a[136:137], v14 offset:14336
    ds_read_b64_tr_b16 a[138:139], v14 offset:15360
    buffer_load_dwordx4 a[60:63], v8, s[4:7], s54 offen offset:3072 sc1
    v_mfma_f32_32x32x16_bf16 v[48:63], a[148:151], a[20:23], v[48:63]
    ds_read_b64_tr_b16 a[140:141], v14 offset:14848
    ds_read_b64_tr_b16 a[142:143], v14 offset:15872
    s_waitcnt vmcnt(9) lgkmcnt(4)
    v_mfma_f32_32x32x16_bf16 v[32:47], a[128:131], a[24:27], v[32:47]
    ds_read_b64_tr_b16 a[144:145], v14 offset:16384
    ds_read_b64_tr_b16 a[146:147], v14 offset:17408
    buffer_load_dwordx4 a[64:67], v8, s[4:7], s55 offen offset:0 sc1
    v_mfma_f32_32x32x16_bf16 v[48:63], a[132:135], a[24:27], v[48:63]
    ds_read_b64_tr_b16 a[148:149], v14 offset:16896
    ds_read_b64_tr_b16 a[150:151], v14 offset:17920
    s_waitcnt vmcnt(9) lgkmcnt(4)
    v_mfma_f32_32x32x16_bf16 v[32:47], a[136:139], a[28:31], v[32:47]
    ds_read_b64_tr_b16 a[128:129], v14 offset:18432
    ds_read_b64_tr_b16 a[130:131], v14 offset:19456
    buffer_load_dwordx4 a[68:71], v8, s[4:7], s55 offen offset:1024 sc1
    v_mfma_f32_32x32x16_bf16 v[48:63], a[140:143], a[28:31], v[48:63]
    ds_read_b64_tr_b16 a[132:133], v14 offset:18944
    ds_read_b64_tr_b16 a[134:135], v14 offset:19968
    s_waitcnt vmcnt(9) lgkmcnt(4)
    v_mfma_f32_32x32x16_bf16 v[32:47], a[144:147], a[32:35], v[32:47]
    ds_read_b64_tr_b16 a[136:137], v14 offset:20480
    ds_read_b64_tr_b16 a[138:139], v14 offset:21504
    buffer_load_dwordx4 a[72:75], v8, s[4:7], s55 offen offset:2048 sc1
    v_mfma_f32_32x32x16_bf16 v[48:63], a[148:151], a[32:35], v[48:63]
    ds_read_b64_tr_b16 a[140:141], v14 offset:20992
    ds_read_b64_tr_b16 a[142:143], v14 offset:22016
    s_waitcnt vmcnt(9) lgkmcnt(4)
    v_mfma_f32_32x32x16_bf16 v[32:47], a[128:131], a[36:39], v[32:47]
    ds_read_b64_tr_b16 a[144:145], v14 offset:22528
    ds_read_b64_tr_b16 a[146:147], v14 offset:23552
    buffer_load_dwordx4 a[76:79], v8, s[4:7], s55 offen offset:3072 sc1
    v_mfma_f32_32x32x16_bf16 v[48:63], a[132:135], a[36:39], v[48:63]
    ds_read_b64_tr_b16 a[148:149], v14 offset:23040
    ds_read_b64_tr_b16 a[150:151], v14 offset:24064
    s_waitcnt vmcnt(9) lgkmcnt(4)
    v_mfma_f32_32x32x16_bf16 v[32:47], a[136:139], a[40:43], v[32:47]
    ds_read_b64_tr_b16 a[128:129], v14 offset:24576
    ds_read_b64_tr_b16 a[130:131], v14 offset:25600
    buffer_load_dwordx4 a[80:83], v8, s[4:7], s56 offen offset:0 sc1
    v_mfma_f32_32x32x16_bf16 v[48:63], a[140:143], a[40:43], v[48:63]
    ds_read_b64_tr_b16 a[132:133], v14 offset:25088
    ds_read_b64_tr_b16 a[134:135], v14 offset:26112
    s_waitcnt vmcnt(9) lgkmcnt(4)
    v_mfma_f32_32x32x16_bf16 v[32:47], a[144:147], a[44:47], v[32:47]
    ds_read_b64_tr_b16 a[136:137], v14 offset:26624
    ds_read_b64_tr_b16 a[138:139], v14 offset:27648
    buffer_load_dwordx4 a[84:87], v8, s[4:7], s56 offen offset:1024 sc1
    v_mfma_f32_32x32x16_bf16 v[48:63], a[148:151], a[44:47], v[48:63]
    ds_read_b64_tr_b16 a[140:141], v14 offset:27136
    ds_read_b64_tr_b16 a[142:143], v14 offset:28160
    s_waitcnt vmcnt(9) lgkmcnt(4)
    v_mfma_f32_32x32x16_bf16 v[32:47], a[128:131], a[48:51], v[32:47]
    ds_read_b64_tr_b16 a[144:145], v14 offset:28672
    ds_read_b64_tr_b16 a[146:147], v14 offset:29696
    buffer_load_dwordx4 a[88:91], v8, s[4:7], s56 offen offset:2048 sc1
    v_mfma_f32_32x32x16_bf16 v[48:63], a[132:135], a[48:51], v[48:63]
    ds_read_b64_tr_b16 a[148:149], v14 offset:29184
    ds_read_b64_tr_b16 a[150:151], v14 offset:30208
    s_waitcnt vmcnt(9) lgkmcnt(4)
    v_mfma_f32_32x32x16_bf16 v[32:47], a[136:139], a[52:55], v[32:47]
    ds_read_b64_tr_b16 a[128:129], v14 offset:30720
    ds_read_b64_tr_b16 a[130:131], v14 offset:31744
    buffer_load_dwordx4 a[92:95], v8, s[4:7], s56 offen offset:3072 sc1
    v_mfma_f32_32x32x16_bf16 v[48:63], a[140:143], a[52:55], v[48:63]
    ds_read_b64_tr_b16 a[132:133], v14 offset:31232
    ds_read_b64_tr_b16 a[134:135], v14 offset:32256
    s_waitcnt vmcnt(9) lgkmcnt(4)
    v_mfma_f32_32x32x16_bf16 v[32:47], a[144:147], a[56:59], v[32:47]
    ds_read_b64_tr_b16 a[136:137], v14 offset:32768
    ds_read_b64_tr_b16 a[138:139], v14 offset:33792
    buffer_load_dwordx4 a[96:99], v8, s[4:7], s57 offen offset:0 sc1
    ds_read_b128 v[96:99], v201 offset:0
    ds_read_b128 v[100:103], v201 offset:32
    v_mfma_f32_32x32x16_bf16 v[48:63], a[148:151], a[56:59], v[48:63]
    ds_read_b64_tr_b16 a[140:141], v14 offset:33280
    ds_read_b64_tr_b16 a[142:143], v14 offset:34304
    ds_read_b128 v[104:107], v201 offset:64
    ds_read_b128 v[108:111], v201 offset:96
    s_waitcnt vmcnt(9) lgkmcnt(8)
    v_mfma_f32_32x32x16_bf16 v[32:47], a[128:131], a[60:63], v[32:47]
    ds_read_b64_tr_b16 a[144:145], v14 offset:34816
    ds_read_b64_tr_b16 a[146:147], v14 offset:35840
    buffer_load_dwordx4 a[100:103], v8, s[4:7], s57 offen offset:1024 sc1
    v_mfma_f32_32x32x16_bf16 v[48:63], a[132:135], a[60:63], v[48:63]
    ds_read_b64_tr_b16 a[148:149], v14 offset:35328
    ds_read_b64_tr_b16 a[150:151], v14 offset:36352
    s_waitcnt vmcnt(9) lgkmcnt(6)
    v_mfma_f32_32x32x16_bf16 v[32:47], a[136:139], a[64:67], v[32:47]
    ds_read_b64_tr_b16 a[128:129], v14 offset:36864
    ds_read_b64_tr_b16 a[130:131], v14 offset:37888
    buffer_load_dwordx4 a[104:107], v8, s[4:7], s57 offen offset:2048 sc1
    ds_read_b128 v[112:115], v201 offset:128
    ds_read_b128 v[116:119], v201 offset:160
    v_mfma_f32_32x32x16_bf16 v[48:63], a[140:143], a[64:67], v[48:63]
    ds_read_b64_tr_b16 a[132:133], v14 offset:37376
    ds_read_b64_tr_b16 a[134:135], v14 offset:38400
    ds_read_b128 v[120:123], v201 offset:192
    ds_read_b128 v[124:127], v201 offset:224
    s_waitcnt vmcnt(9) lgkmcnt(8)
    v_mfma_f32_32x32x16_bf16 v[32:47], a[144:147], a[68:71], v[32:47]
    ds_read_b64_tr_b16 a[136:137], v14 offset:38912
    ds_read_b64_tr_b16 a[138:139], v14 offset:39936
    buffer_load_dwordx4 a[108:111], v8, s[4:7], s57 offen offset:3072 sc1
    v_mfma_f32_32x32x16_bf16 v[48:63], a[148:151], a[68:71], v[48:63]
    ds_read_b64_tr_b16 a[140:141], v14 offset:39424
    ds_read_b64_tr_b16 a[142:143], v14 offset:40448
    s_waitcnt vmcnt(9) lgkmcnt(6)
    v_mfma_f32_32x32x16_bf16 v[32:47], a[128:131], a[72:75], v[32:47]
    ds_read_b64_tr_b16 a[144:145], v14 offset:40960
    ds_read_b64_tr_b16 a[146:147], v14 offset:41984
    buffer_load_dwordx4 v[128:131], v1, s[4:7], s88 offen offset:0 sc1
    ds_read_b64 a[232:233], v10
    v_mfma_f32_32x32x16_bf16 v[48:63], a[132:135], a[72:75], v[48:63]
    ds_read_b64_tr_b16 a[148:149], v14 offset:41472
    ds_read_b64_tr_b16 a[150:151], v14 offset:42496
    s_waitcnt vmcnt(9) lgkmcnt(5)
    v_mfma_f32_32x32x16_bf16 v[32:47], a[136:139], a[76:79], v[32:47]
    ds_read_b64_tr_b16 a[128:129], v14 offset:43008
    ds_read_b64_tr_b16 a[130:131], v14 offset:44032
    buffer_load_dwordx4 v[132:135], v1, s[4:7], s88 offen offset:1024 sc1
    v_mfma_f32_32x32x16_bf16 v[48:63], a[140:143], a[76:79], v[48:63]
    ds_read_b64_tr_b16 a[132:133], v14 offset:43520
    ds_read_b64_tr_b16 a[134:135], v14 offset:44544
    s_waitcnt vmcnt(9) lgkmcnt(4)
    v_mfma_f32_32x32x16_bf16 v[32:47], a[144:147], a[80:83], v[32:47]
    ds_read_b64_tr_b16 a[136:137], v14 offset:45056
    ds_read_b64_tr_b16 a[138:139], v14 offset:46080
    buffer_load_dwordx4 v[136:139], v1, s[4:7], s88 offen offset:2048 sc1
    v_mfma_f32_32x32x16_bf16 v[48:63], a[148:151], a[80:83], v[48:63]
    ds_read_b64_tr_b16 a[140:141], v14 offset:45568
    ds_read_b64_tr_b16 a[142:143], v14 offset:46592
    s_waitcnt vmcnt(9) lgkmcnt(4)
    v_mfma_f32_32x32x16_bf16 v[32:47], a[128:131], a[84:87], v[32:47]
    ds_read_b64_tr_b16 a[144:145], v14 offset:47104
    ds_read_b64_tr_b16 a[146:147], v14 offset:48128
    buffer_load_dwordx2 v[140:141], v1, s[4:7], s88 offen offset:3072 sc1
    v_mfma_f32_32x32x16_bf16 v[48:63], a[132:135], a[84:87], v[48:63]
    ds_read_b64_tr_b16 a[148:149], v14 offset:47616
    ds_read_b64_tr_b16 a[150:151], v14 offset:48640
    s_waitcnt vmcnt(9) lgkmcnt(4)
    v_mfma_f32_32x32x16_bf16 v[32:47], a[136:139], a[88:91], v[32:47]
    ds_read_b64_tr_b16 a[128:129], v14 offset:49152
    ds_read_b64_tr_b16 a[130:131], v14 offset:50176
    v_mfma_f32_32x32x16_bf16 v[48:63], a[140:143], a[88:91], v[48:63]
    ds_read_b64_tr_b16 a[132:133], v14 offset:49664
    ds_read_b64_tr_b16 a[134:135], v14 offset:50688
    s_waitcnt vmcnt(8) lgkmcnt(4)
    v_mfma_f32_32x32x16_bf16 v[32:47], a[144:147], a[92:95], v[32:47]
    ds_read_b64_tr_b16 a[136:137], v14 offset:51200
    ds_read_b64_tr_b16 a[138:139], v14 offset:52224
    v_mfma_f32_32x32x16_bf16 v[48:63], a[148:151], a[92:95], v[48:63]
    ds_read_b64_tr_b16 a[140:141], v14 offset:51712
    ds_read_b64_tr_b16 a[142:143], v14 offset:52736
    s_waitcnt vmcnt(7) lgkmcnt(4)
    v_mfma_f32_32x32x16_bf16 v[32:47], a[128:131], a[96:99], v[32:47]
    ds_read_b64_tr_b16 a[144:145], v14 offset:53248
    ds_read_b64_tr_b16 a[146:147], v14 offset:54272
    v_mfma_f32_32x32x16_bf16 v[48:63], a[132:135], a[96:99], v[48:63]
    ds_read_b64_tr_b16 a[148:149], v14 offset:53760
    ds_read_b64_tr_b16 a[150:151], v14 offset:54784
    s_waitcnt vmcnt(6) lgkmcnt(4)
    v_mfma_f32_32x32x16_bf16 v[32:47], a[136:139], a[100:103], v[32:47]
    ds_read_b64_tr_b16 a[128:129], v14 offset:55296
    ds_read_b64_tr_b16 a[130:131], v14 offset:56320
    v_mfma_f32_32x32x16_bf16 v[48:63], a[140:143], a[100:103], v[48:63]
    ds_read_b64_tr_b16 a[132:133], v14 offset:55808
    ds_read_b64_tr_b16 a[134:135], v14 offset:56832
    s_waitcnt vmcnt(5) lgkmcnt(4)
    v_mfma_f32_32x32x16_bf16 v[32:47], a[144:147], a[104:107], v[32:47]
    ds_read_b64_tr_b16 a[136:137], v15 offset:0
    ds_read_b64_tr_b16 a[138:139], v15 offset:1024
    v_mfma_f32_32x32x16_bf16 v[48:63], a[148:151], a[104:107], v[48:63]
    ds_read_b64_tr_b16 a[140:141], v15 offset:512
    ds_read_b64_tr_b16 a[142:143], v15 offset:1536
    s_waitcnt vmcnt(4) lgkmcnt(4)
    v_mfma_f32_32x32x16_bf16 v[32:47], a[128:131], a[108:111], v[32:47]
    ds_read_b64_tr_b16 a[144:145], v15 offset:2048
    ds_read_b64_tr_b16 a[146:147], v15 offset:3072
    v_mfma_f32_32x32x16_bf16 v[48:63], a[132:135], a[108:111], v[48:63]
    ds_read_b64_tr_b16 a[148:149], v15 offset:2560
    ds_read_b64_tr_b16 a[150:151], v15 offset:3584
    s_barrier
    s_waitcnt vmcnt(0) lgkmcnt(4)
    v_mfma_f32_32x32x16_bf16 v[64:79], a[136:139], a[0:3], 0
    ds_read_b64_tr_b16 a[128:129], v15 offset:4096
    ds_read_b64_tr_b16 a[130:131], v15 offset:5120
    s_add_u32 m0, s92, 57344
    s_add_u32 s70, s91, 100352
    buffer_load_dwordx4 v176, s[8:11], s70 offen offset:0 lds
    v_add_f32 v128, v128, v135
    v_add_f32 v129, v129, v136
    v_add_f32 v130, v130, v137
    v_mfma_f32_32x32x16_bf16 v[80:95], a[140:143], a[0:3], 0
    ds_read_b64_tr_b16 a[132:133], v15 offset:4608
    ds_read_b64_tr_b16 a[134:135], v15 offset:5632
    v_add_f32 v131, v131, v138
    v_add_f32 v132, v132, v139
    v_add_f32 v133, v133, v140
    s_waitcnt lgkmcnt(4)
    v_mfma_f32_32x32x16_bf16 v[64:79], a[144:147], a[4:7], v[64:79]
    ds_read_b64_tr_b16 a[136:137], v15 offset:6144
    ds_read_b64_tr_b16 a[138:139], v15 offset:7168
    buffer_load_dwordx4 v177, s[8:11], s70 offen offset:1024 lds
    v_add_f32 v134, v134, v141
    v_add_f32 v128, v128, v131
    v_add_f32 v129, v129, v132
    v_mfma_f32_32x32x16_bf16 v[80:95], a[148:151], a[4:7], v[80:95]
    ds_read_b64_tr_b16 a[140:141], v15 offset:6656
    ds_read_b64_tr_b16 a[142:143], v15 offset:7680
    v_add_f32 v130, v130, v133
    v_add_f32 v128, v128, v134
    v_add_f32 v129, v129, v130
    s_waitcnt lgkmcnt(4)
    v_mfma_f32_32x32x16_bf16 v[64:79], a[128:131], a[8:11], v[64:79]
    ds_read_b64_tr_b16 a[144:145], v15 offset:8192
    ds_read_b64_tr_b16 a[146:147], v15 offset:9216
    buffer_load_dwordx4 v178, s[8:11], s70 offen offset:2048 lds
    v_add_f32 v128, v128, v129
    v_mov_b32 v129, v128
    s_nop 1
    v_mfma_f32_32x32x16_bf16 v[80:95], a[132:135], a[8:11], v[80:95]
    ds_read_b64_tr_b16 a[148:149], v15 offset:8704
    ds_read_b64_tr_b16 a[150:151], v15 offset:9728
    v_permlane32_swap_b32 v129, v128
    v_mul_f32 v135, 0x3b124925, v129
    v_mul_f32 v128, 0x3b124925, v128
    s_waitcnt lgkmcnt(4)
    v_mfma_f32_32x32x16_bf16 v[64:79], a[136:139], a[12:15], v[64:79]
    ds_read_b64_tr_b16 a[128:129], v15 offset:10240
    ds_read_b64_tr_b16 a[130:131], v15 offset:11264
    buffer_load_dwordx4 v179, s[8:11], s70 offen offset:3072 lds
    v_fma_f32 v129, -v135, v135, v128
    v_max_f32 v129, 0, v129
    v_add_f32 v134, 0x3727c5ac, v129
    v_mfma_f32_32x32x16_bf16 v[80:95], a[140:143], a[12:15], v[80:95]
    ds_read_b64_tr_b16 a[132:133], v15 offset:10752
    ds_read_b64_tr_b16 a[134:135], v15 offset:11776
    v_rsq_f32 v134, v134
    v_sub_f32 v130, 0, v135
    v_rcp_f32 v133, v134
    s_waitcnt lgkmcnt(4)
    v_mfma_f32_32x32x16_bf16 v[64:79], a[144:147], a[16:19], v[64:79]
    ds_read_b64_tr_b16 a[136:137], v15 offset:12288
    ds_read_b64_tr_b16 a[138:139], v15 offset:13312
    s_add_u32 m0, m0, 4096
    s_add_u32 s70, s70, 28672
    buffer_load_dwordx4 v176, s[8:11], s70 offen offset:0 lds
    v_mul_f32 v132, v134, v134
    v_mul_f32 v131, 0xc0135761, v134
    v_mul_f32 v132, v132, v134
    v_mfma_f32_32x32x16_bf16 v[80:95], a[148:151], a[16:19], v[80:95]
    ds_read_b64_tr_b16 a[140:141], v15 offset:12800
    ds_read_b64_tr_b16 a[142:143], v15 offset:13824
    v_mul_f32 v132, 0xbdd2d3e8, v132
    v_fmac_f32 v32, v130, v96
    v_fmac_f32 v33, v130, v97
    s_waitcnt lgkmcnt(4)
    v_mfma_f32_32x32x16_bf16 v[64:79], a[128:131], a[20:23], v[64:79]
    ds_read_b64_tr_b16 a[144:145], v15 offset:14336
    ds_read_b64_tr_b16 a[146:147], v15 offset:15360
    buffer_load_dwordx4 v177, s[8:11], s70 offen offset:1024 lds
    v_fmac_f32 v34, v130, v98
    v_fmac_f32 v35, v130, v99
    v_mul_f32 v144, v32, v32
    v_mfma_f32_32x32x16_bf16 v[80:95], a[132:135], a[20:23], v[80:95]
    ds_read_b64_tr_b16 a[148:149], v15 offset:14848
    ds_read_b64_tr_b16 a[150:151], v15 offset:15872
    v_mul_f32 v145, v33, v33
    v_mul_f32 v146, v34, v34
    v_mul_f32 v147, v35, v35
    s_waitcnt lgkmcnt(4)
    v_mfma_f32_32x32x16_bf16 v[64:79], a[136:139], a[24:27], v[64:79]
    ds_read_b64_tr_b16 a[128:129], v15 offset:16384
    ds_read_b64_tr_b16 a[130:131], v15 offset:17408
    buffer_load_dwordx4 v178, s[8:11], s70 offen offset:2048 lds
    v_fma_f32 v144, v144, v132, v131
    v_fma_f32 v145, v145, v132, v131
    v_fma_f32 v146, v146, v132, v131
    v_mfma_f32_32x32x16_bf16 v[80:95], a[140:143], a[24:27], v[80:95]
    ds_read_b64_tr_b16 a[132:133], v15 offset:16896
    ds_read_b64_tr_b16 a[134:135], v15 offset:17920
    v_fma_f32 v147, v147, v132, v131
    v_mul_f32 v144, v144, v32
    v_mul_f32 v145, v145, v33
    s_waitcnt lgkmcnt(4)
    v_mfma_f32_32x32x16_bf16 v[64:79], a[144:147], a[28:31], v[64:79]
    ds_read_b64_tr_b16 a[136:137], v15 offset:18432
    ds_read_b64_tr_b16 a[138:139], v15 offset:19456
    s_add_u32 m0, s92, 86016
    s_add_u32 s70, s91, 200704
    buffer_load_dwordx4 v176, s[8:11], s70 offen offset:0 lds
    v_mul_f32 v146, v146, v34
    v_mul_f32 v147, v147, v35
    v_exp_f32 v144, v144
    v_mfma_f32_32x32x16_bf16 v[80:95], a[148:151], a[28:31], v[80:95]
    ds_read_b64_tr_b16 a[140:141], v15 offset:18944
    ds_read_b64_tr_b16 a[142:143], v15 offset:19968
    v_exp_f32 v145, v145
    v_exp_f32 v146, v146
    v_exp_f32 v147, v147
    s_waitcnt lgkmcnt(4)
    v_mfma_f32_32x32x16_bf16 v[64:79], a[128:131], a[32:35], v[64:79]
    ds_read_b64_tr_b16 a[144:145], v15 offset:20480
    ds_read_b64_tr_b16 a[146:147], v15 offset:21504
    buffer_load_dwordx4 v177, s[8:11], s70 offen offset:1024 lds
    v_fma_f32 v144, v144, v133, v133
    v_fma_f32 v145, v145, v133, v133
    v_fma_f32 v146, v146, v133, v133
    v_mfma_f32_32x32x16_bf16 v[80:95], a[132:135], a[32:35], v[80:95]
    ds_read_b64_tr_b16 a[148:149], v15 offset:20992
    ds_read_b64_tr_b16 a[150:151], v15 offset:22016
    v_fma_f32 v147, v147, v133, v133
    v_rcp_f32 v144, v144
    v_rcp_f32 v145, v145
    s_waitcnt lgkmcnt(4)
    v_mfma_f32_32x32x16_bf16 v[64:79], a[136:139], a[36:39], v[64:79]
    ds_read_b64_tr_b16 a[128:129], v15 offset:22528
    ds_read_b64_tr_b16 a[130:131], v15 offset:23552
    buffer_load_dwordx4 v178, s[8:11], s70 offen offset:2048 lds
    v_rcp_f32 v146, v146
    v_rcp_f32 v147, v147
    v_mul_f32 v144, v144, v32
    v_mfma_f32_32x32x16_bf16 v[80:95], a[140:143], a[36:39], v[80:95]
    ds_read_b64_tr_b16 a[132:133], v15 offset:23040
    ds_read_b64_tr_b16 a[134:135], v15 offset:24064
    v_mul_f32 v145, v145, v33
    v_mul_f32 v146, v146, v34
    v_mul_f32 v147, v147, v35
    s_waitcnt lgkmcnt(4)
    v_mfma_f32_32x32x16_bf16 v[64:79], a[144:147], a[40:43], v[64:79]
    ds_read_b64_tr_b16 a[136:137], v15 offset:24576
    ds_read_b64_tr_b16 a[138:139], v15 offset:25600
    buffer_load_dwordx4 v179, s[8:11], s70 offen offset:3072 lds
    v_cvt_pk_bf16_f32 v160, v144, v145
    v_cvt_pk_bf16_f32 v161, v146, v147
    v_fmac_f32 v36, v130, v100
    v_mfma_f32_32x32x16_bf16 v[80:95], a[148:151], a[40:43], v[80:95]
    ds_read_b64_tr_b16 a[140:141], v15 offset:25088
    ds_read_b64_tr_b16 a[142:143], v15 offset:26112
    v_fmac_f32 v37, v130, v101
    v_fmac_f32 v38, v130, v102
    v_fmac_f32 v39, v130, v103
    s_waitcnt lgkmcnt(4)
    v_mfma_f32_32x32x16_bf16 v[64:79], a[128:131], a[44:47], v[64:79]
    ds_read_b64_tr_b16 a[144:145], v15 offset:26624
    ds_read_b64_tr_b16 a[146:147], v15 offset:27648
    s_add_u32 m0, m0, 4096
    s_add_u32 s70, s70, 28672
    buffer_load_dwordx4 v176, s[8:11], s70 offen offset:0 lds
    v_mul_f32 v148, v36, v36
    v_mul_f32 v149, v37, v37
    v_mul_f32 v150, v38, v38
    v_mfma_f32_32x32x16_bf16 v[80:95], a[132:135], a[44:47], v[80:95]
    ds_read_b64_tr_b16 a[148:149], v15 offset:27136
    ds_read_b64_tr_b16 a[150:151], v15 offset:28160
    v_mul_f32 v151, v39, v39
    v_fma_f32 v148, v148, v132, v131
    v_fma_f32 v149, v149, v132, v131
    s_waitcnt lgkmcnt(4)
    v_mfma_f32_32x32x16_bf16 v[64:79], a[136:139], a[48:51], v[64:79]
    ds_read_b64_tr_b16 a[128:129], v2 offset:0
    ds_read_b64_tr_b16 a[130:131], v2 offset:1024
    buffer_load_dwordx4 v177, s[8:11], s70 offen offset:1024 lds
    v_fma_f32 v150, v150, v132, v131
    v_fma_f32 v151, v151, v132, v131
    v_mul_f32 v148, v148, v36
    v_mfma_f32_32x32x16_bf16 v[80:95], a[140:143], a[48:51], v[80:95]
    ds_read_b64_tr_b16 a[132:133], v2 offset:512
    ds_read_b64_tr_b16 a[134:135], v2 offset:1536
    v_mul_f32 v149, v149, v37
    v_mul_f32 v150, v150, v38
    v_mul_f32 v151, v151, v39
    s_waitcnt lgkmcnt(4)
    v_mfma_f32_32x32x16_bf16 v[64:79], a[144:147], a[52:55], v[64:79]
    ds_read_b64_tr_b16 a[136:137], v2 offset:2048
    ds_read_b64_tr_b16 a[138:139], v2 offset:3072
    buffer_load_dwordx4 v178, s[8:11], s70 offen offset:2048 lds
    v_exp_f32 v148, v148
    v_exp_f32 v149, v149
    v_exp_f32 v150, v150
    v_mfma_f32_32x32x16_bf16 v[80:95], a[148:151], a[52:55], v[80:95]
    ds_read_b64_tr_b16 a[140:141], v2 offset:2560
    ds_read_b64_tr_b16 a[142:143], v2 offset:3584
    v_exp_f32 v151, v151
    v_fma_f32 v148, v148, v133, v133
    v_fma_f32 v149, v149, v133, v133
    s_waitcnt lgkmcnt(4)
    v_mfma_f32_32x32x16_bf16 v[64:79], a[128:131], a[56:59], v[64:79]
    ds_read_b64_tr_b16 a[144:145], v2 offset:4096
    ds_read_b64_tr_b16 a[146:147], v2 offset:5120
    v_fma_f32 v150, v150, v133, v133
    v_fma_f32 v151, v151, v133, v133
    v_rcp_f32 v148, v148
    v_mfma_f32_32x32x16_bf16 v[80:95], a[132:135], a[56:59], v[80:95]
    ds_read_b64_tr_b16 a[148:149], v2 offset:4608
    ds_read_b64_tr_b16 a[150:151], v2 offset:5632
    v_rcp_f32 v149, v149
    v_rcp_f32 v150, v150
    v_rcp_f32 v151, v151
    s_waitcnt lgkmcnt(4)
    v_mfma_f32_32x32x16_bf16 v[64:79], a[136:139], a[60:63], v[64:79]
    ds_read_b64_tr_b16 a[128:129], v2 offset:6144
    ds_read_b64_tr_b16 a[130:131], v2 offset:7168
    v_mul_f32 v148, v148, v36
    v_mul_f32 v149, v149, v37
    v_mul_f32 v150, v150, v38
    v_mfma_f32_32x32x16_bf16 v[80:95], a[140:143], a[60:63], v[80:95]
    ds_read_b64_tr_b16 a[132:133], v2 offset:6656
    ds_read_b64_tr_b16 a[134:135], v2 offset:7680
    v_mul_f32 v151, v151, v39
    v_cvt_pk_bf16_f32 v162, v148, v149
    v_cvt_pk_bf16_f32 v163, v150, v151
    s_barrier
    s_waitcnt lgkmcnt(4)
    v_mfma_f32_32x32x16_bf16 v[64:79], a[144:147], a[64:67], v[64:79]
    ds_read_b64_tr_b16 a[136:137], v2 offset:8192
    ds_read_b64_tr_b16 a[138:139], v2 offset:9216
    s_add_u32 m0, s92, 135168
    s_add_u32 s70, s91, 301056
    buffer_load_dwordx4 v176, s[8:11], s70 offen offset:0 lds
    v_fmac_f32 v40, v130, v104
    v_fmac_f32 v41, v130, v105
    v_fmac_f32 v42, v130, v106
    v_mfma_f32_32x32x16_bf16 v[80:95], a[148:151], a[64:67], v[80:95]
    ds_read_b64_tr_b16 a[140:141], v2 offset:8704
    ds_read_b64_tr_b16 a[142:143], v2 offset:9728
    v_fmac_f32 v43, v130, v107
    v_mul_f32 v144, v40, v40
    v_mul_f32 v145, v41, v41
    s_waitcnt lgkmcnt(4)
    v_mfma_f32_32x32x16_bf16 v[64:79], a[128:131], a[68:71], v[64:79]
    ds_read_b64_tr_b16 a[144:145], v2 offset:10240
    ds_read_b64_tr_b16 a[146:147], v2 offset:11264
    buffer_load_dwordx4 v177, s[8:11], s70 offen offset:1024 lds
    v_mul_f32 v146, v42, v42
    v_mul_f32 v147, v43, v43
    v_fma_f32 v144, v144, v132, v131
    v_mfma_f32_32x32x16_bf16 v[80:95], a[132:135], a[68:71], v[80:95]
    ds_read_b64_tr_b16 a[148:149], v2 offset:10752
    ds_read_b64_tr_b16 a[150:151], v2 offset:11776
    v_fma_f32 v145, v145, v132, v131
    v_fma_f32 v146, v146, v132, v131
    v_fma_f32 v147, v147, v132, v131
    s_waitcnt lgkmcnt(4)
    v_mfma_f32_32x32x16_bf16 v[64:79], a[136:139], a[72:75], v[64:79]
    ds_read_b64_tr_b16 a[128:129], v2 offset:12288
    ds_read_b64_tr_b16 a[130:131], v2 offset:13312
    buffer_load_dwordx4 v178, s[8:11], s70 offen offset:2048 lds
    v_mul_f32 v144, v144, v40
    v_mul_f32 v145, v145, v41
    v_mul_f32 v146, v146, v42
    v_mfma_f32_32x32x16_bf16 v[80:95], a[140:143], a[72:75], v[80:95]
    ds_read_b64_tr_b16 a[132:133], v2 offset:12800
    ds_read_b64_tr_b16 a[134:135], v2 offset:13824
    v_mul_f32 v147, v147, v43
    v_exp_f32 v144, v144
    v_exp_f32 v145, v145
    s_waitcnt lgkmcnt(4)
    v_mfma_f32_32x32x16_bf16 v[64:79], a[144:147], a[76:79], v[64:79]
    ds_read_b64_tr_b16 a[136:137], v2 offset:14336
    ds_read_b64_tr_b16 a[138:139], v2 offset:15360
    buffer_load_dwordx4 v179, s[8:11], s70 offen offset:3072 lds
    v_exp_f32 v146, v146
    v_exp_f32 v147, v147
    v_fma_f32 v144, v144, v133, v133
    v_mfma_f32_32x32x16_bf16 v[80:95], a[148:151], a[76:79], v[80:95]
    ds_read_b64_tr_b16 a[140:141], v2 offset:14848
    ds_read_b64_tr_b16 a[142:143], v2 offset:15872
    v_fma_f32 v145, v145, v133, v133
    v_fma_f32 v146, v146, v133, v133
    v_fma_f32 v147, v147, v133, v133
    s_waitcnt lgkmcnt(4)
    v_mfma_f32_32x32x16_bf16 v[64:79], a[128:131], a[80:83], v[64:79]
    ds_read_b64_tr_b16 a[144:145], v2 offset:16384
    ds_read_b64_tr_b16 a[146:147], v2 offset:17408
    s_add_u32 m0, m0, 4096
    s_add_u32 s70, s70, 28672
    buffer_load_dwordx4 v176, s[8:11], s70 offen offset:0 lds
    v_rcp_f32 v144, v144
    v_rcp_f32 v145, v145
    v_rcp_f32 v146, v146
    v_mfma_f32_32x32x16_bf16 v[80:95], a[132:135], a[80:83], v[80:95]
    ds_read_b64_tr_b16 a[148:149], v2 offset:16896
    ds_read_b64_tr_b16 a[150:151], v2 offset:17920
    v_rcp_f32 v147, v147
    v_mul_f32 v144, v144, v40
    v_mul_f32 v145, v145, v41
    s_waitcnt lgkmcnt(4)
    v_mfma_f32_32x32x16_bf16 v[64:79], a[136:139], a[84:87], v[64:79]
    ds_read_b64_tr_b16 a[128:129], v2 offset:18432
    ds_read_b64_tr_b16 a[130:131], v2 offset:19456
    buffer_load_dwordx4 v177, s[8:11], s70 offen offset:1024 lds
    v_mul_f32 v146, v146, v42
    v_mul_f32 v147, v147, v43
    v_cvt_pk_bf16_f32 v164, v144, v145
    v_mfma_f32_32x32x16_bf16 v[80:95], a[140:143], a[84:87], v[80:95]
    ds_read_b64_tr_b16 a[132:133], v2 offset:18944
    ds_read_b64_tr_b16 a[134:135], v2 offset:19968
    v_cvt_pk_bf16_f32 v165, v146, v147
    v_fmac_f32 v44, v130, v108
    v_fmac_f32 v45, v130, v109
    s_waitcnt lgkmcnt(4)
    v_mfma_f32_32x32x16_bf16 v[64:79], a[144:147], a[88:91], v[64:79]
    ds_read_b64_tr_b16 a[136:137], v2 offset:20480
    ds_read_b64_tr_b16 a[138:139], v2 offset:21504
    buffer_load_dwordx4 v178, s[8:11], s70 offen offset:2048 lds
    v_fmac_f32 v46, v130, v110
    v_fmac_f32 v47, v130, v111
    v_mul_f32 v148, v44, v44
    v_mfma_f32_32x32x16_bf16 v[80:95], a[148:151], a[88:91], v[80:95]
    ds_read_b64_tr_b16 a[140:141], v2 offset:20992
    ds_read_b64_tr_b16 a[142:143], v2 offset:22016
    v_mul_f32 v149, v45, v45
    v_mul_f32 v150, v46, v46
    v_mul_f32 v151, v47, v47
    s_waitcnt lgkmcnt(4)
    v_mfma_f32_32x32x16_bf16 v[64:79], a[128:131], a[92:95], v[64:79]
    ds_read_b64_tr_b16 a[144:145], v2 offset:22528
    ds_read_b64_tr_b16 a[146:147], v2 offset:23552
    v_fma_f32 v148, v148, v132, v131
    v_fma_f32 v149, v149, v132, v131
    v_fma_f32 v150, v150, v132, v131
    v_mfma_f32_32x32x16_bf16 v[80:95], a[132:135], a[92:95], v[80:95]
    ds_read_b64_tr_b16 a[148:149], v2 offset:23040
    ds_read_b64_tr_b16 a[150:151], v2 offset:24064
    v_fma_f32 v151, v151, v132, v131
    v_mul_f32 v148, v148, v44
    v_mul_f32 v149, v149, v45
    s_waitcnt lgkmcnt(4)
    v_mfma_f32_32x32x16_bf16 v[64:79], a[136:139], a[96:99], v[64:79]
    ds_read_b64_tr_b16 a[128:129], v2 offset:24576
    ds_read_b64_tr_b16 a[130:131], v2 offset:25600
    v_mul_f32 v150, v150, v46
    v_mul_f32 v151, v151, v47
    v_exp_f32 v148, v148
    v_mfma_f32_32x32x16_bf16 v[80:95], a[140:143], a[96:99], v[80:95]
    ds_read_b64_tr_b16 a[132:133], v2 offset:25088
    ds_read_b64_tr_b16 a[134:135], v2 offset:26112
    v_exp_f32 v149, v149
    v_exp_f32 v150, v150
    v_exp_f32 v151, v151
    s_waitcnt lgkmcnt(4)
    v_mfma_f32_32x32x16_bf16 v[64:79], a[144:147], a[100:103], v[64:79]
    ds_read_b64_tr_b16 a[136:137], v2 offset:26624
    ds_read_b64_tr_b16 a[138:139], v2 offset:27648
    v_fma_f32 v148, v148, v133, v133
    v_fma_f32 v149, v149, v133, v133
    v_fma_f32 v150, v150, v133, v133
    v_mfma_f32_32x32x16_bf16 v[80:95], a[148:151], a[100:103], v[80:95]
    ds_read_b64_tr_b16 a[140:141], v2 offset:27136
    ds_read_b64_tr_b16 a[142:143], v2 offset:28160
    v_fma_f32 v151, v151, v133, v133
    v_rcp_f32 v148, v148
    v_rcp_f32 v149, v149
    s_waitcnt lgkmcnt(4)
    v_mfma_f32_32x32x16_bf16 v[64:79], a[128:131], a[104:107], v[64:79]
    v_rcp_f32 v150, v150
    v_rcp_f32 v151, v151
    v_mul_f32 v148, v148, v44
    v_mfma_f32_32x32x16_bf16 v[80:95], a[132:135], a[104:107], v[80:95]
    v_mul_f32 v149, v149, v45
    v_mul_f32 v150, v150, v46
    v_mul_f32 v151, v151, v47
    s_waitcnt lgkmcnt(0)
    v_mfma_f32_32x32x16_bf16 v[64:79], a[136:139], a[108:111], v[64:79]
    v_cvt_pk_bf16_f32 v166, v148, v149
    v_cvt_pk_bf16_f32 v167, v150, v151
    v_mfma_f32_32x32x16_bf16 v[80:95], a[140:143], a[108:111], v[80:95]
    s_cmp_lg_u32 s48, 0
    s_cbranch_scc1 L_slow_43
    buffer_store_dwordx4 v[160:163], v9, s[4:7], 0 offen offset:0
    buffer_store_dwordx4 v[164:167], v9, s[4:7], 0 offen offset:1024
L_join_44:
    ds_read_b128 v[96:99], v201 offset:256
    ds_read_b128 v[100:103], v201 offset:288
    ds_read_b128 v[104:107], v201 offset:320
    ds_read_b128 v[108:111], v201 offset:352
    s_waitcnt lgkmcnt(0)
    v_pk_fma_f32 v[48:49], v[130:131], v[112:113], v[48:49] op_sel_hi:[0,1,1]
    v_pk_fma_f32 v[50:51], v[130:131], v[114:115], v[50:51] op_sel_hi:[0,1,1]
    v_pk_mul_f32 v[144:145], v[48:49], v[48:49]
    v_pk_mul_f32 v[146:147], v[50:51], v[50:51]
    v_pk_fma_f32 v[144:145], v[144:145], v[132:133], v[130:131] op_sel:[0,0,1] op_sel_hi:[1,0,1]
    v_pk_fma_f32 v[146:147], v[146:147], v[132:133], v[130:131] op_sel:[0,0,1] op_sel_hi:[1,0,1]
    v_pk_mul_f32 v[144:145], v[144:145], v[48:49]
    v_pk_mul_f32 v[146:147], v[146:147], v[50:51]
    v_exp_f32 v144, v144
    v_exp_f32 v145, v145
    v_exp_f32 v146, v146
    v_exp_f32 v147, v147
    v_pk_fma_f32 v[144:145], v[144:145], v[132:133], v[132:133] op_sel:[0,1,1]
    v_pk_fma_f32 v[146:147], v[146:147], v[132:133], v[132:133] op_sel:[0,1,1]
    v_rcp_f32 v144, v144
    v_rcp_f32 v145, v145
    v_rcp_f32 v146, v146
    v_rcp_f32 v147, v147
    v_pk_mul_f32 v[144:145], v[144:145], v[48:49]
    v_pk_mul_f32 v[146:147], v[146:147], v[50:51]
    v_cvt_pk_bf16_f32 v168, v144, v145
    v_cvt_pk_bf16_f32 v169, v146, v147
    v_pk_fma_f32 v[52:53], v[130:131], v[116:117], v[52:53] op_sel_hi:[0,1,1]
    v_pk_fma_f32 v[54:55], v[130:131], v[118:119], v[54:55] op_sel_hi:[0,1,1]
    v_pk_mul_f32 v[148:149], v[52:53], v[52:53]
    v_pk_mul_f32 v[150:151], v[54:55], v[54:55]
    v_pk_fma_f32 v[148:149], v[148:149], v[132:133], v[130:131] op_sel:[0,0,1] op_sel_hi:[1,0,1]
    v_pk_fma_f32 v[150:151], v[150:151], v[132:133], v[130:131] op_sel:[0,0,1] op_sel_hi:[1,0,1]
    v_pk_mul_f32 v[148:149], v[148:149], v[52:53]
    v_pk_mul_f32 v[150:151], v[150:151], v[54:55]
    v_exp_f32 v148, v148
    v_exp_f32 v149, v149
    v_exp_f32 v150, v150
    v_exp_f32 v151, v151
    v_pk_fma_f32 v[148:149], v[148:149], v[132:133], v[132:133] op_sel:[0,1,1]
    v_pk_fma_f32 v[150:151], v[150:151], v[132:133], v[132:133] op_sel:[0,1,1]
    v_rcp_f32 v148, v148
    v_rcp_f32 v149, v149
    v_rcp_f32 v150, v150
    v_rcp_f32 v151, v151
    v_pk_mul_f32 v[148:149], v[148:149], v[52:53]
    v_pk_mul_f32 v[150:151], v[150:151], v[54:55]
    v_cvt_pk_bf16_f32 v170, v148, v149
    v_cvt_pk_bf16_f32 v171, v150, v151
    v_pk_fma_f32 v[56:57], v[130:131], v[120:121], v[56:57] op_sel_hi:[0,1,1]
    v_pk_fma_f32 v[58:59], v[130:131], v[122:123], v[58:59] op_sel_hi:[0,1,1]
    v_pk_mul_f32 v[144:145], v[56:57], v[56:57]
    v_pk_mul_f32 v[146:147], v[58:59], v[58:59]
    v_pk_fma_f32 v[144:145], v[144:145], v[132:133], v[130:131] op_sel:[0,0,1] op_sel_hi:[1,0,1]
    v_pk_fma_f32 v[146:147], v[146:147], v[132:133], v[130:131] op_sel:[0,0,1] op_sel_hi:[1,0,1]
    v_pk_mul_f32 v[144:145], v[144:145], v[56:57]
    v_pk_mul_f32 v[146:147], v[146:147], v[58:59]
    v_exp_f32 v144, v144
    v_exp_f32 v145, v145
    v_exp_f32 v146, v146
    v_exp_f32 v147, v147
    v_pk_fma_f32 v[144:145], v[144:145], v[132:133], v[132:133] op_sel:[0,1,1]
    v_pk_fma_f32 v[146:147], v[146:147], v[132:133], v[132:133] op_sel:[0,1,1]
    v_rcp_f32 v144, v144
    v_rcp_f32 v145, v145
    v_rcp_f32 v146, v146
    v_rcp_f32 v147, v147
    v_pk_mul_f32 v[144:145], v[144:145], v[56:57]
    v_pk_mul_f32 v[146:147], v[146:147], v[58:59]
    v_cvt_pk_bf16_f32 v172, v144, v145
    v_cvt_pk_bf16_f32 v173, v146, v147
    v_pk_fma_f32 v[60:61], v[130:131], v[124:125], v[60:61] op_sel_hi:[0,1,1]
    v_pk_fma_f32 v[62:63], v[130:131], v[126:127], v[62:63] op_sel_hi:[0,1,1]
    v_pk_mul_f32 v[148:149], v[60:61], v[60:61]
    v_pk_mul_f32 v[150:151], v[62:63], v[62:63]
    v_pk_fma_f32 v[148:149], v[148:149], v[132:133], v[130:131] op_sel:[0,0,1] op_sel_hi:[1,0,1]
    v_pk_fma_f32 v[150:151], v[150:151], v[132:133], v[130:131] op_sel:[0,0,1] op_sel_hi:[1,0,1]
    v_pk_mul_f32 v[148:149], v[148:149], v[60:61]
    v_pk_mul_f32 v[150:151], v[150:151], v[62:63]
    v_exp_f32 v148, v148
    v_exp_f32 v149, v149
    v_exp_f32 v150, v150
    v_exp_f32 v151, v151
    v_pk_fma_f32 v[148:149], v[148:149], v[132:133], v[132:133] op_sel:[0,1,1]
    v_pk_fma_f32 v[150:151], v[150:151], v[132:133], v[132:133] op_sel:[0,1,1]
    v_rcp_f32 v148, v148
    v_rcp_f32 v149, v149
    v_rcp_f32 v150, v150
    v_rcp_f32 v151, v151
    v_pk_mul_f32 v[148:149], v[148:149], v[60:61]
    v_pk_mul_f32 v[150:151], v[150:151], v[62:63]
    v_cvt_pk_bf16_f32 v174, v148, v149
    v_cvt_pk_bf16_f32 v175, v150, v151
    ds_read_b128 v[112:115], v201 offset:384
    ds_read_b128 v[116:119], v201 offset:416
    ds_read_b128 v[120:123], v201 offset:448
    ds_read_b128 v[124:127], v201 offset:480
    s_cmp_lg_u32 s48, 0
    s_cbranch_scc1 L_slow_45
    buffer_store_dwordx4 v[168:171], v9, s[4:7], 0 offen offset:2048
    buffer_store_dwordx4 v[172:175], v9, s[4:7], 0 offen offset:3072
L_join_46:
    s_waitcnt lgkmcnt(0)
    v_pk_fma_f32 v[64:65], v[130:131], v[96:97], v[64:65] op_sel_hi:[0,1,1]
    v_pk_fma_f32 v[66:67], v[130:131], v[98:99], v[66:67] op_sel_hi:[0,1,1]
    v_pk_mul_f32 v[144:145], v[64:65], v[64:65]
    v_pk_mul_f32 v[146:147], v[66:67], v[66:67]
    v_pk_fma_f32 v[144:145], v[144:145], v[132:133], v[130:131] op_sel:[0,0,1] op_sel_hi:[1,0,1]
    v_pk_fma_f32 v[146:147], v[146:147], v[132:133], v[130:131] op_sel:[0,0,1] op_sel_hi:[1,0,1]
    v_pk_mul_f32 v[144:145], v[144:145], v[64:65]
    v_pk_mul_f32 v[146:147], v[146:147], v[66:67]
    v_exp_f32 v144, v144
    v_exp_f32 v145, v145
    v_exp_f32 v146, v146
    v_exp_f32 v147, v147
    v_pk_fma_f32 v[144:145], v[144:145], v[132:133], v[132:133] op_sel:[0,1,1]
    v_pk_fma_f32 v[146:147], v[146:147], v[132:133], v[132:133] op_sel:[0,1,1]
    v_rcp_f32 v144, v144
    v_rcp_f32 v145, v145
    v_rcp_f32 v146, v146
    v_rcp_f32 v147, v147
    v_pk_mul_f32 v[144:145], v[144:145], v[64:65]
    v_pk_mul_f32 v[146:147], v[146:147], v[66:67]
    v_cvt_pk_bf16_f32 v160, v144, v145
    v_cvt_pk_bf16_f32 v161, v146, v147
    v_pk_fma_f32 v[68:69], v[130:131], v[100:101], v[68:69] op_sel_hi:[0,1,1]
    v_pk_fma_f32 v[70:71], v[130:131], v[102:103], v[70:71] op_sel_hi:[0,1,1]
    v_pk_mul_f32 v[148:149], v[68:69], v[68:69]
    v_pk_mul_f32 v[150:151], v[70:71], v[70:71]
    v_pk_fma_f32 v[148:149], v[148:149], v[132:133], v[130:131] op_sel:[0,0,1] op_sel_hi:[1,0,1]
    v_pk_fma_f32 v[150:151], v[150:151], v[132:133], v[130:131] op_sel:[0,0,1] op_sel_hi:[1,0,1]
    v_pk_mul_f32 v[148:149], v[148:149], v[68:69]
    v_pk_mul_f32 v[150:151], v[150:151], v[70:71]
    v_exp_f32 v148, v148
    v_exp_f32 v149, v149
    v_exp_f32 v150, v150
    v_exp_f32 v151, v151
    v_pk_fma_f32 v[148:149], v[148:149], v[132:133], v[132:133] op_sel:[0,1,1]
    v_pk_fma_f32 v[150:151], v[150:151], v[132:133], v[132:133] op_sel:[0,1,1]
    v_rcp_f32 v148, v148
    v_rcp_f32 v149, v149
    v_rcp_f32 v150, v150
    v_rcp_f32 v151, v151
    v_pk_mul_f32 v[148:149], v[148:149], v[68:69]
    v_pk_mul_f32 v[150:151], v[150:151], v[70:71]
    v_cvt_pk_bf16_f32 v162, v148, v149
    v_cvt_pk_bf16_f32 v163, v150, v151
    v_pk_fma_f32 v[72:73], v[130:131], v[104:105], v[72:73] op_sel_hi:[0,1,1]
    v_pk_fma_f32 v[74:75], v[130:131], v[106:107], v[74:75] op_sel_hi:[0,1,1]
    v_pk_mul_f32 v[144:145], v[72:73], v[72:73]
    v_pk_mul_f32 v[146:147], v[74:75], v[74:75]
    v_pk_fma_f32 v[144:145], v[144:145], v[132:133], v[130:131] op_sel:[0,0,1] op_sel_hi:[1,0,1]
    v_pk_fma_f32 v[146:147], v[146:147], v[132:133], v[130:131] op_sel:[0,0,1] op_sel_hi:[1,0,1]
    v_pk_mul_f32 v[144:145], v[144:145], v[72:73]
    v_pk_mul_f32 v[146:147], v[146:147], v[74:75]
    v_exp_f32 v144, v144
    v_exp_f32 v145, v145
    v_exp_f32 v146, v146
    v_exp_f32 v147, v147
    v_pk_fma_f32 v[144:145], v[144:145], v[132:133], v[132:133] op_sel:[0,1,1]
    v_pk_fma_f32 v[146:147], v[146:147], v[132:133], v[132:133] op_sel:[0,1,1]
    v_rcp_f32 v144, v144
    v_rcp_f32 v145, v145
    v_rcp_f32 v146, v146
    v_rcp_f32 v147, v147
    v_pk_mul_f32 v[144:145], v[144:145], v[72:73]
    v_pk_mul_f32 v[146:147], v[146:147], v[74:75]
    v_cvt_pk_bf16_f32 v164, v144, v145
    v_cvt_pk_bf16_f32 v165, v146, v147
    v_pk_fma_f32 v[76:77], v[130:131], v[108:109], v[76:77] op_sel_hi:[0,1,1]
    v_pk_fma_f32 v[78:79], v[130:131], v[110:111], v[78:79] op_sel_hi:[0,1,1]
    v_pk_mul_f32 v[148:149], v[76:77], v[76:77]
    v_pk_mul_f32 v[150:151], v[78:79], v[78:79]
    v_pk_fma_f32 v[148:149], v[148:149], v[132:133], v[130:131] op_sel:[0,0,1] op_sel_hi:[1,0,1]
    v_pk_fma_f32 v[150:151], v[150:151], v[132:133], v[130:131] op_sel:[0,0,1] op_sel_hi:[1,0,1]
    v_pk_mul_f32 v[148:149], v[148:149], v[76:77]
    v_pk_mul_f32 v[150:151], v[150:151], v[78:79]
    v_exp_f32 v148, v148
    v_exp_f32 v149, v149
    v_exp_f32 v150, v150
    v_exp_f32 v151, v151
    v_pk_fma_f32 v[148:149], v[148:149], v[132:133], v[132:133] op_sel:[0,1,1]
    v_pk_fma_f32 v[150:151], v[150:151], v[132:133], v[132:133] op_sel:[0,1,1]
    v_rcp_f32 v148, v148
    v_rcp_f32 v149, v149
    v_rcp_f32 v150, v150
    v_rcp_f32 v151, v151
    v_pk_mul_f32 v[148:149], v[148:149], v[76:77]
    v_pk_mul_f32 v[150:151], v[150:151], v[78:79]
    v_cvt_pk_bf16_f32 v166, v148, v149
    v_cvt_pk_bf16_f32 v167, v150, v151
    s_cmp_lg_u32 s48, 0
    s_cbranch_scc1 L_slow_47
    buffer_store_dwordx4 v[160:163], v9, s[4:7], s52 offen offset:0
    buffer_store_dwordx4 v[164:167], v9, s[4:7], s52 offen offset:1024
L_join_48:
    s_waitcnt lgkmcnt(0)
    v_pk_fma_f32 v[80:81], v[130:131], v[112:113], v[80:81] op_sel_hi:[0,1,1]
    v_pk_fma_f32 v[82:83], v[130:131], v[114:115], v[82:83] op_sel_hi:[0,1,1]
    v_pk_mul_f32 v[144:145], v[80:81], v[80:81]
    v_pk_mul_f32 v[146:147], v[82:83], v[82:83]
    v_pk_fma_f32 v[144:145], v[144:145], v[132:133], v[130:131] op_sel:[0,0,1] op_sel_hi:[1,0,1]
    v_pk_fma_f32 v[146:147], v[146:147], v[132:133], v[130:131] op_sel:[0,0,1] op_sel_hi:[1,0,1]
    v_pk_mul_f32 v[144:145], v[144:145], v[80:81]
    v_pk_mul_f32 v[146:147], v[146:147], v[82:83]
    v_exp_f32 v144, v144
    v_exp_f32 v145, v145
    v_exp_f32 v146, v146
    v_exp_f32 v147, v147
    v_pk_fma_f32 v[144:145], v[144:145], v[132:133], v[132:133] op_sel:[0,1,1]
    v_pk_fma_f32 v[146:147], v[146:147], v[132:133], v[132:133] op_sel:[0,1,1]
    v_rcp_f32 v144, v144
    v_rcp_f32 v145, v145
    v_rcp_f32 v146, v146
    v_rcp_f32 v147, v147
    v_pk_mul_f32 v[144:145], v[144:145], v[80:81]
    v_pk_mul_f32 v[146:147], v[146:147], v[82:83]
    v_cvt_pk_bf16_f32 v168, v144, v145
    v_cvt_pk_bf16_f32 v169, v146, v147
    v_pk_fma_f32 v[84:85], v[130:131], v[116:117], v[84:85] op_sel_hi:[0,1,1]
    v_pk_fma_f32 v[86:87], v[130:131], v[118:119], v[86:87] op_sel_hi:[0,1,1]
    v_pk_mul_f32 v[148:149], v[84:85], v[84:85]
    v_pk_mul_f32 v[150:151], v[86:87], v[86:87]
    v_pk_fma_f32 v[148:149], v[148:149], v[132:133], v[130:131] op_sel:[0,0,1] op_sel_hi:[1,0,1]
    v_pk_fma_f32 v[150:151], v[150:151], v[132:133], v[130:131] op_sel:[0,0,1] op_sel_hi:[1,0,1]
    v_pk_mul_f32 v[148:149], v[148:149], v[84:85]
    v_pk_mul_f32 v[150:151], v[150:151], v[86:87]
    v_exp_f32 v148, v148
    v_exp_f32 v149, v149
    v_exp_f32 v150, v150
    v_exp_f32 v151, v151
    v_pk_fma_f32 v[148:149], v[148:149], v[132:133], v[132:133] op_sel:[0,1,1]
    v_pk_fma_f32 v[150:151], v[150:151], v[132:133], v[132:133] op_sel:[0,1,1]
    v_rcp_f32 v148, v148
    v_rcp_f32 v149, v149
    v_rcp_f32 v150, v150
    v_rcp_f32 v151, v151
    v_pk_mul_f32 v[148:149], v[148:149], v[84:85]
    v_pk_mul_f32 v[150:151], v[150:151], v[86:87]
    v_cvt_pk_bf16_f32 v170, v148, v149
    v_cvt_pk_bf16_f32 v171, v150, v151
    v_pk_fma_f32 v[88:89], v[130:131], v[120:121], v[88:89] op_sel_hi:[0,1,1]
    v_pk_fma_f32 v[90:91], v[130:131], v[122:123], v[90:91] op_sel_hi:[0,1,1]
    v_pk_mul_f32 v[144:145], v[88:89], v[88:89]
    v_pk_mul_f32 v[146:147], v[90:91], v[90:91]
    v_pk_fma_f32 v[144:145], v[144:145], v[132:133], v[130:131] op_sel:[0,0,1] op_sel_hi:[1,0,1]
    v_pk_fma_f32 v[146:147], v[146:147], v[132:133], v[130:131] op_sel:[0,0,1] op_sel_hi:[1,0,1]
    v_pk_mul_f32 v[144:145], v[144:145], v[88:89]
    v_pk_mul_f32 v[146:147], v[146:147], v[90:91]
    v_exp_f32 v144, v144
    v_exp_f32 v145, v145
    v_exp_f32 v146, v146
    v_exp_f32 v147, v147
    v_pk_fma_f32 v[144:145], v[144:145], v[132:133], v[132:133] op_sel:[0,1,1]
    v_pk_fma_f32 v[146:147], v[146:147], v[132:133], v[132:133] op_sel:[0,1,1]
    v_rcp_f32 v144, v144
    v_rcp_f32 v145, v145
    v_rcp_f32 v146, v146
    v_rcp_f32 v147, v147
    v_pk_mul_f32 v[144:145], v[144:145], v[88:89]
    v_pk_mul_f32 v[146:147], v[146:147], v[90:91]
    v_cvt_pk_bf16_f32 v172, v144, v145
    v_cvt_pk_bf16_f32 v173, v146, v147
    v_pk_fma_f32 v[92:93], v[130:131], v[124:125], v[92:93] op_sel_hi:[0,1,1]
    v_pk_fma_f32 v[94:95], v[130:131], v[126:127], v[94:95] op_sel_hi:[0,1,1]
    v_pk_mul_f32 v[148:149], v[92:93], v[92:93]
    v_pk_mul_f32 v[150:151], v[94:95], v[94:95]
    v_pk_fma_f32 v[148:149], v[148:149], v[132:133], v[130:131] op_sel:[0,0,1] op_sel_hi:[1,0,1]
    v_pk_fma_f32 v[150:151], v[150:151], v[132:133], v[130:131] op_sel:[0,0,1] op_sel_hi:[1,0,1]
    v_pk_mul_f32 v[148:149], v[148:149], v[92:93]
    v_pk_mul_f32 v[150:151], v[150:151], v[94:95]
    v_exp_f32 v148, v148
    v_exp_f32 v149, v149
    v_exp_f32 v150, v150
    v_exp_f32 v151, v151
    v_pk_fma_f32 v[148:149], v[148:149], v[132:133], v[132:133] op_sel:[0,1,1]
    v_pk_fma_f32 v[150:151], v[150:151], v[132:133], v[132:133] op_sel:[0,1,1]
    v_rcp_f32 v148, v148
    v_rcp_f32 v149, v149
    v_rcp_f32 v150, v150
    v_rcp_f32 v151, v151
    v_pk_mul_f32 v[148:149], v[148:149], v[92:93]
    v_pk_mul_f32 v[150:151], v[150:151], v[94:95]
    v_cvt_pk_bf16_f32 v174, v148, v149
    v_cvt_pk_bf16_f32 v175, v150, v151
    s_cmp_lg_u32 s48, 0
    s_cbranch_scc1 L_slow_49
    buffer_store_dwordx4 v[168:171], v9, s[4:7], s52 offen offset:2048
    buffer_store_dwordx4 v[172:175], v9, s[4:7], s52 offen offset:3072
L_join_50:
    s_mul_i32 s60, s51, 14848
    v_add_u32 v14, s60, v2
    v_xor_b32 v15, 512, v14
    v_add_u32 v80, 0, v14
    v_add_u32 v81, 0, v15
    v_add_u32 v82, 28672, v14
    v_add_u32 v83, 28672, v15
    v_add_u32 v84, 57344, v14
    v_add_u32 v85, 57344, v15
    v_add_u32 v86, 86016, v14
    v_add_u32 v87, 86016, v15
    v_add_u32 v88, 135168, v14
    v_add_u32 v89, 135168, v15
    s_mul_i32 s62, s84, 114688
    s_mul_i32 s63, s51, 57344
    s_add_u32 s62, s62, s63
    s_add_u32 s62, s62, s81
    s_add_u32 s62, s62, 491520
    v_add_u32 v8, s62, v1
    v_add_u32 v9, 28672, v8
    s_add_u32 s87, s95, 262144
    s_add_u32 s88, s96, 229376
    s_mul_i32 s94, s41, 7168
    s_mul_i32 s93, s43, 90112
    s_add_u32 s93, s93, s94
    s_add_u32 s93, s93, 13631488
    s_lshl_b32 s67, s38, 30
    s_add_u32 s93, s93, s67
    s_mov_b32 s12, s32
    s_and_b32 s13, s33, 0xffff
    s_mov_b32 s14, 1835008
    s_mov_b32 s15, 0x20000
    v_and_b32 v5, 31, v0
    v_mul_u32_u24 v90, 896, v5
    v_lshrrev_b32 v5, 5, v0
    v_lshl_add_u32 v90, v5, 4, v90
    s_mul_i32 s60, s84, 28672
    s_lshl_b32 s61, s85, 6
    s_add_u32 s60, s60, s61
    v_add_u32 v90, s60, v90
    s_lshl_b32 s61, s46, 1
    s_add_u32 s61, s61, s51
    s_mul_i32 s61, s61, 14
    s_and_b32 s60, s44, 1
    s_add_u32 s61, s61, s60
    s_mov_b32 s72, 0x1555
    s_mov_b32 s73, 0
    s_lshl_b64 s[72:73], s[72:73], s61
    s_add_u32 s22, s3, 5
    v_mov_b32 v5, s22
    s_mov_b64 exec, 1
    s_waitcnt vmcnt(0)
    s_cmp_lg_u32 s48, 0
    s_cbranch_scc1 L_slow_51
    buffer_store_dword v5, off, s[4:7], s82
L_join_52:
    s_mov_b64 exec, -1
    s_waitcnt lgkmcnt(0)
    s_barrier
    s_add_u32 m0, s92, 0
    s_add_u32 s70, s91, 401408
    buffer_load_dwordx4 v176, s[8:11], s70 offen offset:0 lds
    buffer_load_dwordx4 v177, s[8:11], s70 offen offset:1024 lds
    buffer_load_dwordx4 v178, s[8:11], s70 offen offset:2048 lds
    buffer_load_dwordx4 v179, s[8:11], s70 offen offset:3072 lds
    s_add_u32 m0, m0, 4096
    s_add_u32 s70, s70, 28672
    buffer_load_dwordx4 v176, s[8:11], s70 offen offset:0 lds
    buffer_load_dwordx4 v177, s[8:11], s70 offen offset:1024 lds
    buffer_load_dwordx4 v178, s[8:11], s70 offen offset:2048 lds
    buffer_load_dword v202, v4, s[4:7], 0 offen sc1
    ds_read_b64_tr_b16 a[128:129], v82 offset:0
    ds_read_b64_tr_b16 a[130:131], v82 offset:1024
    ds_read_b64_tr_b16 a[132:133], v83 offset:0
    ds_read_b64_tr_b16 a[134:135], v83 offset:1024
    ds_read_b64_tr_b16 a[136:137], v82 offset:2048
    ds_read_b64_tr_b16 a[138:139], v82 offset:3072
    ds_read_b64_tr_b16 a[140:141], v83 offset:2048
    ds_read_b64_tr_b16 a[142:143], v83 offset:3072
    s_add_u32 s22, s3, 5
    s_mov_b32 s74, 0
L_poll_54:
    s_waitcnt vmcnt(0)
    v_subrev_u32 v202, s22, v202
    v_cmp_lt_u32 vcc, 31, v202
    s_and_b64 s[60:61], vcc, s[72:73]
    s_cbranch_scc0 L_poll_done_53
    buffer_load_dword v202, v4, s[4:7], 0 offen sc1
    s_add_u32 s74, s74, 1
    s_cmp_lt_u32 s74, 200000
    s_cbranch_scc1 L_poll_54
    s_waitcnt vmcnt(0)
L_poll_done_53:
    buffer_load_dwordx4 a[0:3], v8, s[4:7], 0 offen offset:0 sc1
    buffer_load_dwordx4 a[4:7], v8, s[4:7], 0 offen offset:1024 sc1
    buffer_load_dwordx4 a[8:11], v8, s[4:7], 0 offen offset:2048 sc1
    s_barrier
    buffer_load_dwordx4 a[12:15], v8, s[4:7], 0 offen offset:3072 sc1
    buffer_load_dwordx4 a[16:19], v8, s[4:7], s52 offen offset:0 sc1
    buffer_load_dwordx4 a[20:23], v8, s[4:7], s52 offen offset:1024 sc1
    s_barrier
    buffer_load_dwordx4 a[24:27], v8, s[4:7], s52 offen offset:2048 sc1
    buffer_load_dwordx4 a[28:31], v8, s[4:7], s52 offen offset:3072 sc1
    buffer_load_dwordx4 a[32:35], v8, s[4:7], s53 offen offset:0 sc1
    buffer_load_dwordx4 a[36:39], v8, s[4:7], s53 offen offset:1024 sc1
    s_waitcnt vmcnt(9) lgkmcnt(4)
    v_mfma_f32_32x32x16_bf16 v[48:63], a[132:135], a[0:3], 0
    ds_read_b64_tr_b16 a[144:145], v82 offset:4096
    ds_read_b64_tr_b16 a[146:147], v82 offset:5120
    buffer_load_dwordx4 a[40:43], v8, s[4:7], s53 offen offset:2048 sc1
    v_mfma_f32_32x32x16_bf16 v[32:47], a[128:131], a[0:3], 0
    ds_read_b64_tr_b16 a[148:149], v83 offset:4096
    ds_read_b64_tr_b16 a[150:151], v83 offset:5120
    buffer_load_dwordx4 a[44:47], v8, s[4:7], s53 offen offset:3072 sc1
    s_waitcnt vmcnt(10) lgkmcnt(4)
    v_mfma_f32_32x32x16_bf16 v[48:63], a[140:143], a[4:7], v[48:63]
    ds_read_b64_tr_b16 a[128:129], v82 offset:6144
    ds_read_b64_tr_b16 a[130:131], v82 offset:7168
    buffer_load_dwordx4 a[48:51], v8, s[4:7], s54 offen offset:0 sc1
    v_mfma_f32_32x32x16_bf16 v[32:47], a[136:139], a[4:7], v[32:47]
    ds_read_b64_tr_b16 a[132:133], v83 offset:6144
    ds_read_b64_tr_b16 a[134:135], v83 offset:7168
    buffer_load_dwordx4 a[52:55], v8, s[4:7], s54 offen offset:1024 sc1
    s_waitcnt vmcnt(11) lgkmcnt(4)
    v_mfma_f32_32x32x16_bf16 v[48:63], a[148:151], a[8:11], v[48:63]
    ds_read_b64_tr_b16 a[136:137], v82 offset:8192
    ds_read_b64_tr_b16 a[138:139], v82 offset:9216
    buffer_load_dwordx4 a[56:59], v8, s[4:7], s54 offen offset:2048 sc1
    v_mfma_f32_32x32x16_bf16 v[32:47], a[144:147], a[8:11], v[32:47]
    ds_read_b64_tr_b16 a[140:141], v83 offset:8192
    ds_read_b64_tr_b16 a[142:143], v83 offset:9216
    buffer_load_dwordx4 a[60:63], v8, s[4:7], s54 offen offset:3072 sc1
    s_waitcnt vmcnt(12) lgkmcnt(4)
    v_mfma_f32_32x32x16_bf16 v[48:63], a[132:135], a[12:15], v[48:63]
    ds_read_b64_tr_b16 a[144:145], v82 offset:10240
    ds_read_b64_tr_b16 a[146:147], v82 offset:11264
    buffer_load_dwordx4 a[64:67], v8, s[4:7], s55 offen offset:0 sc1
    v_mfma_f32_32x32x16_bf16 v[32:47], a[128:131], a[12:15], v[32:47]
    ds_read_b64_tr_b16 a[148:149], v83 offset:10240
    ds_read_b64_tr_b16 a[150:151], v83 offset:11264
    s_waitcnt vmcnt(12) lgkmcnt(4)
    v_mfma_f32_32x32x16_bf16 v[48:63], a[140:143], a[16:19], v[48:63]
    ds_read_b64_tr_b16 a[128:129], v82 offset:12288
    ds_read_b64_tr_b16 a[130:131], v82 offset:13312
    buffer_load_dwordx4 a[68:71], v8, s[4:7], s55 offen offset:1024 sc1
    v_mfma_f32_32x32x16_bf16 v[32:47], a[136:139], a[16:19], v[32:47]
    ds_read_b64_tr_b16 a[132:133], v83 offset:12288
    ds_read_b64_tr_b16 a[134:135], v83 offset:13312
    s_waitcnt vmcnt(12) lgkmcnt(4)
    v_mfma_f32_32x32x16_bf16 v[48:63], a[148:151], a[20:23], v[48:63]
    ds_read_b64_tr_b16 a[136:137], v84 offset:0
    ds_read_b64_tr_b16 a[138:139], v84 offset:1024
    buffer_load_dwordx4 a[72:75], v8, s[4:7], s55 offen offset:2048 sc1
    v_mfma_f32_32x32x16_bf16 v[32:47], a[144:147], a[20:23], v[32:47]
    ds_read_b64_tr_b16 a[140:141], v85 offset:0
    ds_read_b64_tr_b16 a[142:143], v85 offset:1024
    s_waitcnt vmcnt(12) lgkmcnt(4)
    v_mfma_f32_32x32x16_bf16 v[48:63], a[132:135], a[24:27], v[48:63]
    ds_read_b64_tr_b16 a[144:145], v84 offset:2048
    ds_read_b64_tr_b16 a[146:147], v84 offset:3072
    buffer_load_dwordx4 a[76:79], v8, s[4:7], s55 offen offset:3072 sc1
    v_mfma_f32_32x32x16_bf16 v[32:47], a[128:131], a[24:27], v[32:47]
    ds_read_b64_tr_b16 a[148:149], v85 offset:2048
    ds_read_b64_tr_b16 a[150:151], v85 offset:3072
    s_waitcnt vmcnt(12) lgkmcnt(4)
    v_mfma_f32_32x32x16_bf16 v[48:63], a[140:143], a[28:31], v[48:63]
    ds_read_b64_tr_b16 a[128:129], v84 offset:4096
    ds_read_b64_tr_b16 a[130:131], v84 offset:5120
    buffer_load_dwordx4 a[80:83], v8, s[4:7], s56 offen offset:0 sc1
    v_mfma_f32_32x32x16_bf16 v[32:47], a[136:139], a[28:31], v[32:47]
    ds_read_b64_tr_b16 a[132:133], v85 offset:4096
    ds_read_b64_tr_b16 a[134:135], v85 offset:5120
    s_waitcnt vmcnt(12) lgkmcnt(4)
    v_mfma_f32_32x32x16_bf16 v[48:63], a[148:151], a[32:35], v[48:63]
    ds_read_b64_tr_b16 a[136:137], v84 offset:6144
    ds_read_b64_tr_b16 a[138:139], v84 offset:7168
    buffer_load_dwordx4 a[84:87], v8, s[4:7], s56 offen offset:1024 sc1
    v_mfma_f32_32x32x16_bf16 v[32:47], a[144:147], a[32:35], v[32:47]
    ds_read_b64_tr_b16 a[140:141], v85 offset:6144
    ds_read_b64_tr_b16 a[142:143], v85 offset:7168
    s_waitcnt vmcnt(12) lgkmcnt(4)
    v_mfma_f32_32x32x16_bf16 v[48:63], a[132:135], a[36:39], v[48:63]
    ds_read_b64_tr_b16 a[144:145], v84 offset:8192
    ds_read_b64_tr_b16 a[146:147], v84 offset:9216
    buffer_load_dwordx4 a[88:91], v8, s[4:7], s56 offen offset:2048 sc1
    v_mfma_f32_32x32x16_bf16 v[32:47], a[128:131], a[36:39], v[32:47]
    ds_read_b64_tr_b16 a[148:149], v85 offset:8192
    ds_read_b64_tr_b16 a[150:151], v85 offset:9216
    s_waitcnt vmcnt(12) lgkmcnt(4)
    v_mfma_f32_32x32x16_bf16 v[48:63], a[140:143], a[40:43], v[48:63]
    ds_read_b64_tr_b16 a[128:129], v84 offset:10240
    ds_read_b64_tr_b16 a[130:131], v84 offset:11264
    buffer_load_dwordx4 a[92:95], v8, s[4:7], s56 offen offset:3072 sc1
    v_mfma_f32_32x32x16_bf16 v[32:47], a[136:139], a[40:43], v[32:47]
    ds_read_b64_tr_b16 a[132:133], v85 offset:10240
    ds_read_b64_tr_b16 a[134:135], v85 offset:11264
    s_barrier
    s_waitcnt vmcnt(12) lgkmcnt(4)
    v_mfma_f32_32x32x16_bf16 v[48:63], a[148:151], a[44:47], v[48:63]
    ds_read_b64_tr_b16 a[136:137], v84 offset:12288
    ds_read_b64_tr_b16 a[138:139], v84 offset:13312
    buffer_load_dwordx4 a[96:99], v8, s[4:7], s57 offen offset:0 sc1
    v_mfma_f32_32x32x16_bf16 v[32:47], a[144:147], a[44:47], v[32:47]
    ds_read_b64_tr_b16 a[140:141], v85 offset:12288
    ds_read_b64_tr_b16 a[142:143], v85 offset:13312
    s_add_u32 m0, s92, 28672
    s_add_u32 s70, s91, 501760
    buffer_load_dwordx4 v176, s[8:11], s70 offen offset:0 lds
    s_waitcnt vmcnt(13) lgkmcnt(4)
    v_mfma_f32_32x32x16_bf16 v[48:63], a[132:135], a[48:51], v[48:63]
    ds_read_b64_tr_b16 a[144:145], v86 offset:0
    ds_read_b64_tr_b16 a[146:147], v86 offset:1024
    buffer_load_dwordx4 a[100:103], v8, s[4:7], s57 offen offset:1024 sc1
    v_mfma_f32_32x32x16_bf16 v[32:47], a[128:131], a[48:51], v[32:47]
    ds_read_b64_tr_b16 a[148:149], v87 offset:0
    ds_read_b64_tr_b16 a[150:151], v87 offset:1024
    buffer_load_dwordx4 v177, s[8:11], s70 offen offset:1024 lds
    s_waitcnt vmcnt(14) lgkmcnt(4)
    v_mfma_f32_32x32x16_bf16 v[48:63], a[140:143], a[52:55], v[48:63]
    ds_read_b64_tr_b16 a[128:129], v86 offset:2048
    ds_read_b64_tr_b16 a[130:131], v86 offset:3072
    buffer_load_dwordx4 a[104:107], v8, s[4:7], s57 offen offset:2048 sc1
    v_mfma_f32_32x32x16_bf16 v[32:47], a[136:139], a[52:55], v[32:47]
    ds_read_b64_tr_b16 a[132:133], v87 offset:2048
    ds_read_b64_tr_b16 a[134:135], v87 offset:3072
    buffer_load_dwordx4 v178, s[8:11], s70 offen offset:2048 lds
    s_waitcnt vmcnt(15) lgkmcnt(4)
    v_mfma_f32_32x32x16_bf16 v[48:63], a[148:151], a[56:59], v[48:63]
    ds_read_b64_tr_b16 a[136:137], v86 offset:4096
    ds_read_b64_tr_b16 a[138:139], v86 offset:5120
    buffer_load_dwordx4 a[108:111], v8, s[4:7], s57 offen offset:3072 sc1
    v_mfma_f32_32x32x16_bf16 v[32:47], a[144:147], a[56:59], v[32:47]
    ds_read_b64_tr_b16 a[140:141], v87 offset:4096
    ds_read_b64_tr_b16 a[142:143], v87 offset:5120
    buffer_load_dwordx4 v179, s[8:11], s70 offen offset:3072 lds
    s_waitcnt vmcnt(16) lgkmcnt(4)
    v_mfma_f32_32x32x16_bf16 v[48:63], a[132:135], a[60:63], v[48:63]
    ds_read_b64_tr_b16 a[144:145], v86 offset:6144
    ds_read_b64_tr_b16 a[146:147], v86 offset:7168
    buffer_load_dwordx4 a[0:3], v9, s[4:7], 0 offen offset:0 sc1
    v_mfma_f32_32x32x16_bf16 v[32:47], a[128:131], a[60:63], v[32:47]
    ds_read_b64_tr_b16 a[148:149], v87 offset:6144
    ds_read_b64_tr_b16 a[150:151], v87 offset:7168
    s_add_u32 m0, m0, 4096
    s_add_u32 s70, s70, 28672
    buffer_load_dwordx4 v176, s[8:11], s70 offen offset:0 lds
    s_waitcnt vmcnt(17) lgkmcnt(4)
    v_mfma_f32_32x32x16_bf16 v[48:63], a[140:143], a[64:67], v[48:63]
    ds_read_b64_tr_b16 a[128:129], v86 offset:8192
    ds_read_b64_tr_b16 a[130:131], v86 offset:9216
    buffer_load_dwordx4 a[4:7], v9, s[4:7], 0 offen offset:1024 sc1
    v_mfma_f32_32x32x16_bf16 v[32:47], a[136:139], a[64:67], v[32:47]
    ds_read_b64_tr_b16 a[132:133], v87 offset:8192
    ds_read_b64_tr_b16 a[134:135], v87 offset:9216
    buffer_load_dwordx4 v177, s[8:11], s70 offen offset:1024 lds
    s_waitcnt vmcnt(18) lgkmcnt(4)
    v_mfma_f32_32x32x16_bf16 v[48:63], a[148:151], a[68:71], v[48:63]
    ds_read_b64_tr_b16 a[136:137], v86 offset:10240
    ds_read_b64_tr_b16 a[138:139], v86 offset:11264
    buffer_load_dwordx4 a[8:11], v9, s[4:7], 0 offen offset:2048 sc1
    v_mfma_f32_32x32x16_bf16 v[32:47], a[144:147], a[68:71], v[32:47]
    ds_read_b64_tr_b16 a[140:141], v87 offset:10240
    ds_read_b64_tr_b16 a[142:143], v87 offset:11264
    buffer_load_dwordx4 v178, s[8:11], s70 offen offset:2048 lds
    s_barrier
    s_waitcnt vmcnt(19) lgkmcnt(4)
    v_mfma_f32_32x32x16_bf16 v[48:63], a[132:135], a[72:75], v[48:63]
    ds_read_b64_tr_b16 a[144:145], v86 offset:12288
    ds_read_b64_tr_b16 a[146:147], v86 offset:13312
    buffer_load_dwordx4 a[12:15], v9, s[4:7], 0 offen offset:3072 sc1
    v_mfma_f32_32x32x16_bf16 v[32:47], a[128:131], a[72:75], v[32:47]
    ds_read_b64_tr_b16 a[148:149], v87 offset:12288
    ds_read_b64_tr_b16 a[150:151], v87 offset:13312
    s_add_u32 m0, s92, 57344
    s_add_u32 s70, s91, 602112
    buffer_load_dwordx4 v176, s[8:11], s70 offen offset:0 lds
    s_waitcnt vmcnt(20) lgkmcnt(4)
    v_mfma_f32_32x32x16_bf16 v[48:63], a[140:143], a[76:79], v[48:63]
    ds_read_b64_tr_b16 a[128:129], v88 offset:0
    ds_read_b64_tr_b16 a[130:131], v88 offset:1024
    buffer_load_dwordx4 a[16:19], v9, s[4:7], s52 offen offset:0 sc1
    v_mfma_f32_32x32x16_bf16 v[32:47], a[136:139], a[76:79], v[32:47]
    ds_read_b64_tr_b16 a[132:133], v89 offset:0
    ds_read_b64_tr_b16 a[134:135], v89 offset:1024
    buffer_load_dwordx4 v177, s[8:11], s70 offen offset:1024 lds
    s_waitcnt vmcnt(21) lgkmcnt(4)
    v_mfma_f32_32x32x16_bf16 v[48:63], a[148:151], a[80:83], v[48:63]
    ds_read_b64_tr_b16 a[136:137], v88 offset:2048
    ds_read_b64_tr_b16 a[138:139], v88 offset:3072
    buffer_load_dwordx4 a[20:23], v9, s[4:7], s52 offen offset:1024 sc1
    v_mfma_f32_32x32x16_bf16 v[32:47], a[144:147], a[80:83], v[32:47]
    ds_read_b64_tr_b16 a[140:141], v89 offset:2048
    ds_read_b64_tr_b16 a[142:143], v89 offset:3072
    buffer_load_dwordx4 v178, s[8:11], s70 offen offset:2048 lds
    s_waitcnt vmcnt(22) lgkmcnt(4)
    v_mfma_f32_32x32x16_bf16 v[48:63], a[132:135], a[84:87], v[48:63]
    ds_read_b64_tr_b16 a[144:145], v88 offset:4096
    ds_read_b64_tr_b16 a[146:147], v88 offset:5120
    buffer_load_dwordx4 a[24:27], v9, s[4:7], s52 offen offset:2048 sc1
    v_mfma_f32_32x32x16_bf16 v[32:47], a[128:131], a[84:87], v[32:47]
    ds_read_b64_tr_b16 a[148:149], v89 offset:4096
    ds_read_b64_tr_b16 a[150:151], v89 offset:5120
    buffer_load_dwordx4 v179, s[8:11], s70 offen offset:3072 lds
    s_waitcnt vmcnt(23) lgkmcnt(4)
    v_mfma_f32_32x32x16_bf16 v[48:63], a[140:143], a[88:91], v[48:63]
    ds_read_b64_tr_b16 a[128:129], v88 offset:6144
    ds_read_b64_tr_b16 a[130:131], v88 offset:7168
    buffer_load_dwordx4 a[28:31], v9, s[4:7], s52 offen offset:3072 sc1
    v_mfma_f32_32x32x16_bf16 v[32:47], a[136:139], a[88:91], v[32:47]
    ds_read_b64_tr_b16 a[132:133], v89 offset:6144
    ds_read_b64_tr_b16 a[134:135], v89 offset:7168
    s_add_u32 m0, m0, 4096
    s_add_u32 s70, s70, 28672
    buffer_load_dwordx4 v176, s[8:11], s70 offen offset:0 lds
    s_waitcnt vmcnt(24) lgkmcnt(4)
    v_mfma_f32_32x32x16_bf16 v[48:63], a[148:151], a[92:95], v[48:63]
    ds_read_b64_tr_b16 a[136:137], v88 offset:8192
    ds_read_b64_tr_b16 a[138:139], v88 offset:9216
    buffer_load_dwordx4 a[32:35], v9, s[4:7], s53 offen offset:0 sc1
    v_mfma_f32_32x32x16_bf16 v[32:47], a[144:147], a[92:95], v[32:47]
    ds_read_b64_tr_b16 a[140:141], v89 offset:8192
    ds_read_b64_tr_b16 a[142:143], v89 offset:9216
    buffer_load_dwordx4 v177, s[8:11], s70 offen offset:1024 lds
    s_waitcnt vmcnt(25) lgkmcnt(4)
    v_mfma_f32_32x32x16_bf16 v[48:63], a[132:135], a[96:99], v[48:63]
    ds_read_b64_tr_b16 a[144:145], v88 offset:10240
    ds_read_b64_tr_b16 a[146:147], v88 offset:11264
    buffer_load_dwordx4 a[36:39], v9, s[4:7], s53 offen offset:1024 sc1
    v_mfma_f32_32x32x16_bf16 v[32:47], a[128:131], a[96:99], v[32:47]
    ds_read_b64_tr_b16 a[148:149], v89 offset:10240
    ds_read_b64_tr_b16 a[150:151], v89 offset:11264
    buffer_load_dwordx4 v178, s[8:11], s70 offen offset:2048 lds
    s_barrier
    s_waitcnt vmcnt(25) lgkmcnt(4)
    v_mfma_f32_32x32x16_bf16 v[48:63], a[140:143], a[100:103], v[48:63]
    ds_read_b64_tr_b16 a[128:129], v88 offset:12288
    ds_read_b64_tr_b16 a[130:131], v88 offset:13312
    buffer_load_dwordx4 a[40:43], v9, s[4:7], s53 offen offset:2048 sc1
    v_mfma_f32_32x32x16_bf16 v[32:47], a[136:139], a[100:103], v[32:47]
    ds_read_b64_tr_b16 a[132:133], v89 offset:12288
    ds_read_b64_tr_b16 a[134:135], v89 offset:13312
    s_add_u32 m0, s92, 86016
    s_add_u32 s70, s91, 702464
    buffer_load_dwordx4 v176, s[8:11], s70 offen offset:0 lds
    s_waitcnt vmcnt(25) lgkmcnt(4)
    v_mfma_f32_32x32x16_bf16 v[48:63], a[148:151], a[104:107], v[48:63]
    ds_read_b64_tr_b16 a[136:137], v80 offset:0
    ds_read_b64_tr_b16 a[138:139], v80 offset:1024
    buffer_load_dwordx4 a[44:47], v9, s[4:7], s53 offen offset:3072 sc1
    v_mfma_f32_32x32x16_bf16 v[32:47], a[144:147], a[104:107], v[32:47]
    ds_read_b64_tr_b16 a[140:141], v81 offset:0
    ds_read_b64_tr_b16 a[142:143], v81 offset:1024
    buffer_load_dwordx4 v177, s[8:11], s70 offen offset:1024 lds
    s_waitcnt vmcnt(25) lgkmcnt(4)
    v_mfma_f32_32x32x16_bf16 v[48:63], a[132:135], a[108:111], v[48:63]
    ds_read_b64_tr_b16 a[144:145], v80 offset:2048
    ds_read_b64_tr_b16 a[146:147], v80 offset:3072
    buffer_load_dwordx4 a[48:51], v9, s[4:7], s54 offen offset:0 sc1
    v_mfma_f32_32x32x16_bf16 v[32:47], a[128:131], a[108:111], v[32:47]
    ds_read_b64_tr_b16 a[148:149], v81 offset:2048
    ds_read_b64_tr_b16 a[150:151], v81 offset:3072
    buffer_load_dwordx4 v178, s[8:11], s70 offen offset:2048 lds
    s_waitcnt vmcnt(25) lgkmcnt(4)
    v_mfma_f32_32x32x16_bf16 v[48:63], a[140:143], a[0:3], v[48:63]
    ds_read_b64_tr_b16 a[128:129], v80 offset:4096
    ds_read_b64_tr_b16 a[130:131], v80 offset:5120
    buffer_load_dwordx4 a[52:55], v9, s[4:7], s54 offen offset:1024 sc1
    v_mfma_f32_32x32x16_bf16 v[32:47], a[136:139], a[0:3], v[32:47]
    ds_read_b64_tr_b16 a[132:133], v81 offset:4096
    ds_read_b64_tr_b16 a[134:135], v81 offset:5120
    buffer_load_dwordx4 v179, s[8:11], s70 offen offset:3072 lds
    s_waitcnt vmcnt(25) lgkmcnt(4)
    v_mfma_f32_32x32x16_bf16 v[48:63], a[148:151], a[4:7], v[48:63]
    ds_read_b64_tr_b16 a[136:137], v80 offset:6144
    ds_read_b64_tr_b16 a[138:139], v80 offset:7168
    buffer_load_dwordx4 a[56:59], v9, s[4:7], s54 offen offset:2048 sc1
    v_mfma_f32_32x32x16_bf16 v[32:47], a[144:147], a[4:7], v[32:47]
    ds_read_b64_tr_b16 a[140:141], v81 offset:6144
    ds_read_b64_tr_b16 a[142:143], v81 offset:7168
    s_add_u32 m0, m0, 4096
    s_add_u32 s70, s70, 28672
    buffer_load_dwordx4 v176, s[8:11], s70 offen offset:0 lds
    s_waitcnt vmcnt(25) lgkmcnt(4)
    v_mfma_f32_32x32x16_bf16 v[48:63], a[132:135], a[8:11], v[48:63]
    ds_read_b64_tr_b16 a[144:145], v80 offset:8192
    ds_read_b64_tr_b16 a[146:147], v80 offset:9216
    buffer_load_dwordx4 a[60:63], v9, s[4:7], s54 offen offset:3072 sc1
    v_mfma_f32_32x32x16_bf16 v[32:47], a[128:131], a[8:11], v[32:47]
    ds_read_b64_tr_b16 a[148:149], v81 offset:8192
    ds_read_b64_tr_b16 a[150:151], v81 offset:9216
    buffer_load_dwordx4 v177, s[8:11], s70 offen offset:1024 lds
    s_waitcnt vmcnt(25) lgkmcnt(4)
    v_mfma_f32_32x32x16_bf16 v[48:63], a[140:143], a[12:15], v[48:63]
    ds_read_b64_tr_b16 a[128:129], v80 offset:10240
    ds_read_b64_tr_b16 a[130:131], v80 offset:11264
    buffer_load_dwordx4 a[64:67], v9, s[4:7], s55 offen offset:0 sc1
    v_mfma_f32_32x32x16_bf16 v[32:47], a[136:139], a[12:15], v[32:47]
    ds_read_b64_tr_b16 a[132:133], v81 offset:10240
    ds_read_b64_tr_b16 a[134:135], v81 offset:11264
    buffer_load_dwordx4 v178, s[8:11], s70 offen offset:2048 lds
    s_barrier
    s_waitcnt vmcnt(25) lgkmcnt(4)
    v_mfma_f32_32x32x16_bf16 v[48:63], a[148:151], a[16:19], v[48:63]
    ds_read_b64_tr_b16 a[136:137], v80 offset:12288
    ds_read_b64_tr_b16 a[138:139], v80 offset:13312
    buffer_load_dwordx4 a[68:71], v9, s[4:7], s55 offen offset:1024 sc1
    v_mfma_f32_32x32x16_bf16 v[32:47], a[144:147], a[16:19], v[32:47]
    ds_read_b64_tr_b16 a[140:141], v81 offset:12288
    ds_read_b64_tr_b16 a[142:143], v81 offset:13312
    s_waitcnt vmcnt(24) lgkmcnt(4)
    v_mfma_f32_32x32x16_bf16 v[48:63], a[132:135], a[20:23], v[48:63]
    ds_read_b64_tr_b16 a[144:145], v82 offset:0
    ds_read_b64_tr_b16 a[146:147], v82 offset:1024
    buffer_load_dwordx4 a[72:75], v9, s[4:7], s55 offen offset:2048 sc1
    v_mfma_f32_32x32x16_bf16 v[32:47], a[128:131], a[20:23], v[32:47]
    ds_read_b64_tr_b16 a[148:149], v83 offset:0
    ds_read_b64_tr_b16 a[150:151], v83 offset:1024
    s_waitcnt vmcnt(23) lgkmcnt(4)
    v_mfma_f32_32x32x16_bf16 v[48:63], a[140:143], a[24:27], v[48:63]
    ds_read_b64_tr_b16 a[128:129], v82 offset:2048
    ds_read_b64_tr_b16 a[130:131], v82 offset:3072
    buffer_load_dwordx4 a[76:79], v9, s[4:7], s55 offen offset:3072 sc1
    v_mfma_f32_32x32x16_bf16 v[32:47], a[136:139], a[24:27], v[32:47]
    ds_read_b64_tr_b16 a[132:133], v83 offset:2048
    ds_read_b64_tr_b16 a[134:135], v83 offset:3072
    s_waitcnt vmcnt(22) lgkmcnt(4)
    v_mfma_f32_32x32x16_bf16 v[48:63], a[148:151], a[28:31], v[48:63]
    ds_read_b64_tr_b16 a[136:137], v82 offset:4096
    ds_read_b64_tr_b16 a[138:139], v82 offset:5120
    buffer_load_dwordx4 a[80:83], v9, s[4:7], s56 offen offset:0 sc1
    v_mfma_f32_32x32x16_bf16 v[32:47], a[144:147], a[28:31], v[32:47]
    ds_read_b64_tr_b16 a[140:141], v83 offset:4096
    ds_read_b64_tr_b16 a[142:143], v83 offset:5120
    s_waitcnt vmcnt(21) lgkmcnt(4)
    v_mfma_f32_32x32x16_bf16 v[48:63], a[132:135], a[32:35], v[48:63]
    ds_read_b64_tr_b16 a[144:145], v82 offset:6144
    ds_read_b64_tr_b16 a[146:147], v82 offset:7168
    buffer_load_dwordx4 a[84:87], v9, s[4:7], s56 offen offset:1024 sc1
    v_mfma_f32_32x32x16_bf16 v[32:47], a[128:131], a[32:35], v[32:47]
    ds_read_b64_tr_b16 a[148:149], v83 offset:6144
    ds_read_b64_tr_b16 a[150:151], v83 offset:7168
    s_waitcnt vmcnt(20) lgkmcnt(4)
    v_mfma_f32_32x32x16_bf16 v[48:63], a[140:143], a[36:39], v[48:63]
    ds_read_b64_tr_b16 a[128:129], v82 offset:8192
    ds_read_b64_tr_b16 a[130:131], v82 offset:9216
    buffer_load_dwordx4 a[88:91], v9, s[4:7], s56 offen offset:2048 sc1
    v_mfma_f32_32x32x16_bf16 v[32:47], a[136:139], a[36:39], v[32:47]
    ds_read_b64_tr_b16 a[132:133], v83 offset:8192
    ds_read_b64_tr_b16 a[134:135], v83 offset:9216
    s_waitcnt vmcnt(19) lgkmcnt(4)
    v_mfma_f32_32x32x16_bf16 v[48:63], a[148:151], a[40:43], v[48:63]
    ds_read_b64_tr_b16 a[136:137], v82 offset:10240
    ds_read_b64_tr_b16 a[138:139], v82 offset:11264
    buffer_load_dwordx4 a[92:95], v9, s[4:7], s56 offen offset:3072 sc1
    v_mfma_f32_32x32x16_bf16 v[32:47], a[144:147], a[40:43], v[32:47]
    ds_read_b64_tr_b16 a[140:141], v83 offset:10240
    ds_read_b64_tr_b16 a[142:143], v83 offset:11264
    s_barrier
    s_waitcnt vmcnt(18) lgkmcnt(4)
    v_mfma_f32_32x32x16_bf16 v[48:63], a[132:135], a[44:47], v[48:63]
    ds_read_b64_tr_b16 a[144:145], v82 offset:12288
    ds_read_b64_tr_b16 a[146:147], v82 offset:13312
    buffer_load_dwordx4 a[96:99], v9, s[4:7], s57 offen offset:0 sc1
    v_mfma_f32_32x32x16_bf16 v[32:47], a[128:131], a[44:47], v[32:47]
    ds_read_b64_tr_b16 a[148:149], v83 offset:12288
    ds_read_b64_tr_b16 a[150:151], v83 offset:13312
    s_waitcnt vmcnt(17) lgkmcnt(4)
    v_mfma_f32_32x32x16_bf16 v[48:63], a[140:143], a[48:51], v[48:63]
    ds_read_b64_tr_b16 a[128:129], v84 offset:0
    ds_read_b64_tr_b16 a[130:131], v84 offset:1024
    buffer_load_dwordx4 a[100:103], v9, s[4:7], s57 offen offset:1024 sc1
    v_mfma_f32_32x32x16_bf16 v[32:47], a[136:139], a[48:51], v[32:47]
    ds_read_b64_tr_b16 a[132:133], v85 offset:0
    ds_read_b64_tr_b16 a[134:135], v85 offset:1024
    s_waitcnt vmcnt(16) lgkmcnt(4)
    v_mfma_f32_32x32x16_bf16 v[48:63], a[148:151], a[52:55], v[48:63]
    ds_read_b64_tr_b16 a[136:137], v84 offset:2048
    ds_read_b64_tr_b16 a[138:139], v84 offset:3072
    buffer_load_dwordx4 a[104:107], v9, s[4:7], s57 offen offset:2048 sc1
    v_mfma_f32_32x32x16_bf16 v[32:47], a[144:147], a[52:55], v[32:47]
    ds_read_b64_tr_b16 a[140:141], v85 offset:2048
    ds_read_b64_tr_b16 a[142:143], v85 offset:3072
    s_waitcnt vmcnt(15) lgkmcnt(4)
    v_mfma_f32_32x32x16_bf16 v[48:63], a[132:135], a[56:59], v[48:63]
    ds_read_b64_tr_b16 a[144:145], v84 offset:4096
    ds_read_b64_tr_b16 a[146:147], v84 offset:5120
    buffer_load_dwordx4 a[108:111], v9, s[4:7], s57 offen offset:3072 sc1
    v_mfma_f32_32x32x16_bf16 v[32:47], a[128:131], a[56:59], v[32:47]
    ds_read_b64_tr_b16 a[148:149], v85 offset:4096
    ds_read_b64_tr_b16 a[150:151], v85 offset:5120
    s_waitcnt vmcnt(14) lgkmcnt(4)
    v_mfma_f32_32x32x16_bf16 v[48:63], a[140:143], a[60:63], v[48:63]
    ds_read_b64_tr_b16 a[128:129], v84 offset:6144
    ds_read_b64_tr_b16 a[130:131], v84 offset:7168
    v_mfma_f32_32x32x16_bf16 v[32:47], a[136:139], a[60:63], v[32:47]
    ds_read_b64_tr_b16 a[132:133], v85 offset:6144
    ds_read_b64_tr_b16 a[134:135], v85 offset:7168
    s_waitcnt vmcnt(12) lgkmcnt(4)
    v_mfma_f32_32x32x16_bf16 v[48:63], a[148:151], a[64:67], v[48:63]
    ds_read_b64_tr_b16 a[136:137], v84 offset:8192
    ds_read_b64_tr_b16 a[138:139], v84 offset:9216
    v_mfma_f32_32x32x16_bf16 v[32:47], a[144:147], a[64:67], v[32:47]
    ds_read_b64_tr_b16 a[140:141], v85 offset:8192
    ds_read_b64_tr_b16 a[142:143], v85 offset:9216
    s_waitcnt vmcnt(10) lgkmcnt(4)
    v_mfma_f32_32x32x16_bf16 v[48:63], a[132:135], a[68:71], v[48:63]
    ds_read_b64_tr_b16 a[144:145], v84 offset:10240
    ds_read_b64_tr_b16 a[146:147], v84 offset:11264
    v_mfma_f32_32x32x16_bf16 v[32:47], a[128:131], a[68:71], v[32:47]
    ds_read_b64_tr_b16 a[148:149], v85 offset:10240
    ds_read_b64_tr_b16 a[150:151], v85 offset:11264
    s_barrier
    s_waitcnt vmcnt(9) lgkmcnt(4)
    v_mfma_f32_32x32x16_bf16 v[48:63], a[140:143], a[72:75], v[48:63]
    ds_read_b64_tr_b16 a[128:129], v84 offset:12288
    ds_read_b64_tr_b16 a[130:131], v84 offset:13312
    v_mfma_f32_32x32x16_bf16 v[32:47], a[136:139], a[72:75], v[32:47]
    ds_read_b64_tr_b16 a[132:133], v85 offset:12288
    ds_read_b64_tr_b16 a[134:135], v85 offset:13312
    s_add_u32 m0, s94, 135168
    s_add_u32 s70, s93, 0
    buffer_load_dwordx4 v1, s[4:7], s70 offen offset:0 sc1 lds
    s_waitcnt vmcnt(9) lgkmcnt(4)
    v_mfma_f32_32x32x16_bf16 v[48:63], a[148:151], a[76:79], v[48:63]
    ds_read_b64_tr_b16 a[136:137], v86 offset:0
    ds_read_b64_tr_b16 a[138:139], v86 offset:1024
    v_mfma_f32_32x32x16_bf16 v[32:47], a[144:147], a[76:79], v[32:47]
    ds_read_b64_tr_b16 a[140:141], v87 offset:0
    ds_read_b64_tr_b16 a[142:143], v87 offset:1024
    buffer_load_dwordx4 v1, s[4:7], s70 offen offset:1024 sc1 lds
    s_waitcnt vmcnt(9) lgkmcnt(4)
    v_mfma_f32_32x32x16_bf16 v[48:63], a[132:135], a[80:83], v[48:63]
    ds_read_b64_tr_b16 a[144:145], v86 offset:2048
    ds_read_b64_tr_b16 a[146:147], v86 offset:3072
    v_mfma_f32_32x32x16_bf16 v[32:47], a[128:131], a[80:83], v[32:47]
    ds_read_b64_tr_b16 a[148:149], v87 offset:2048
    ds_read_b64_tr_b16 a[150:151], v87 offset:3072
    buffer_load_dwordx4 v1, s[4:7], s70 offen offset:2048 sc1 lds
    s_waitcnt vmcnt(9) lgkmcnt(4)
    v_mfma_f32_32x32x16_bf16 v[48:63], a[140:143], a[84:87], v[48:63]
    ds_read_b64_tr_b16 a[128:129], v86 offset:4096
    ds_read_b64_tr_b16 a[130:131], v86 offset:5120
    v_mfma_f32_32x32x16_bf16 v[32:47], a[136:139], a[84:87], v[32:47]
    ds_read_b64_tr_b16 a[132:133], v87 offset:4096
    ds_read_b64_tr_b16 a[134:135], v87 offset:5120
    buffer_load_dwordx4 v1, s[4:7], s70 offen offset:3072 sc1 lds
    s_waitcnt vmcnt(9) lgkmcnt(4)
    v_mfma_f32_32x32x16_bf16 v[48:63], a[148:151], a[88:91], v[48:63]
    ds_read_b64_tr_b16 a[136:137], v86 offset:6144
    ds_read_b64_tr_b16 a[138:139], v86 offset:7168
    v_mfma_f32_32x32x16_bf16 v[32:47], a[144:147], a[88:91], v[32:47]
    ds_read_b64_tr_b16 a[140:141], v87 offset:6144
    ds_read_b64_tr_b16 a[142:143], v87 offset:7168
    s_add_u32 m0, m0, 4096
    s_add_u32 s70, s70, 4096
    buffer_load_dwordx4 v1, s[4:7], s70 offen offset:0 sc1 lds
    s_waitcnt vmcnt(9) lgkmcnt(4)
    v_mfma_f32_32x32x16_bf16 v[48:63], a[132:135], a[92:95], v[48:63]
    ds_read_b64_tr_b16 a[144:145], v86 offset:8192
    ds_read_b64_tr_b16 a[146:147], v86 offset:9216
    v_mfma_f32_32x32x16_bf16 v[32:47], a[128:131], a[92:95], v[32:47]
    ds_read_b64_tr_b16 a[148:149], v87 offset:8192
    ds_read_b64_tr_b16 a[150:151], v87 offset:9216
    buffer_load_dwordx4 v1, s[4:7], s70 offen offset:1024 sc1 lds
    s_waitcnt vmcnt(9) lgkmcnt(4)
    v_mfma_f32_32x32x16_bf16 v[48:63], a[140:143], a[96:99], v[48:63]
    ds_read_b64_tr_b16 a[128:129], v86 offset:10240
    ds_read_b64_tr_b16 a[130:131], v86 offset:11264
    v_mfma_f32_32x32x16_bf16 v[32:47], a[136:139], a[96:99], v[32:47]
    ds_read_b64_tr_b16 a[132:133], v87 offset:10240
    ds_read_b64_tr_b16 a[134:135], v87 offset:11264
    buffer_load_dwordx4 v1, s[4:7], s70 offen offset:2048 sc1 lds
    s_waitcnt vmcnt(9) lgkmcnt(4)
    v_mfma_f32_32x32x16_bf16 v[48:63], a[148:151], a[100:103], v[48:63]
    ds_read_b64_tr_b16 a[136:137], v86 offset:12288
    ds_read_b64_tr_b16 a[138:139], v86 offset:13312
    v_mfma_f32_32x32x16_bf16 v[32:47], a[144:147], a[100:103], v[32:47]
    ds_read_b64_tr_b16 a[140:141], v87 offset:12288
    ds_read_b64_tr_b16 a[142:143], v87 offset:13312
    s_waitcnt vmcnt(8) lgkmcnt(4)
    v_mfma_f32_32x32x16_bf16 v[48:63], a[132:135], a[104:107], v[48:63]
    v_mfma_f32_32x32x16_bf16 v[32:47], a[128:131], a[104:107], v[32:47]
    s_waitcnt vmcnt(7) lgkmcnt(0)
    v_mfma_f32_32x32x16_bf16 v[48:63], a[140:143], a[108:111], v[48:63]
    v_mfma_f32_32x32x16_bf16 v[32:47], a[136:139], a[108:111], v[32:47]
    s_cmp_lg_u32 s38, 0
    s_cbranch_scc1 L_final
    s_nop 8
    ds_write_b128 v199, v[48:51] offset:0
    ds_write_b128 v199, v[52:55] offset:1024
    ds_write_b128 v199, v[56:59] offset:2048
    ds_write_b128 v199, v[60:63] offset:3072
    v_pk_add_f32 v[16:17], v[16:17], v[32:33]
    v_pk_add_f32 v[18:19], v[18:19], v[34:35]
    v_pk_add_f32 v[20:21], v[20:21], v[36:37]
    v_pk_add_f32 v[22:23], v[22:23], v[38:39]
    v_pk_add_f32 v[24:25], v[24:25], v[40:41]
    v_pk_add_f32 v[26:27], v[26:27], v[42:43]
    v_pk_add_f32 v[28:29], v[28:29], v[44:45]
    v_pk_add_f32 v[30:31], v[30:31], v[46:47]
    s_waitcnt lgkmcnt(0)
    s_barrier
    ds_read_b128 v[64:67], v200 offset:0
    ds_read_b128 v[68:71], v200 offset:1024
    ds_read_b128 v[72:75], v200 offset:2048
    ds_read_b128 v[76:79], v200 offset:3072
    s_waitcnt lgkmcnt(3)
    v_pk_add_f32 v[16:17], v[16:17], v[64:65]
    v_pk_add_f32 v[18:19], v[18:19], v[66:67]
    s_waitcnt lgkmcnt(2)
    v_pk_add_f32 v[20:21], v[20:21], v[68:69]
    v_pk_add_f32 v[22:23], v[22:23], v[70:71]
    s_waitcnt lgkmcnt(1)
    v_pk_add_f32 v[24:25], v[24:25], v[72:73]
    v_pk_add_f32 v[26:27], v[26:27], v[74:75]
    s_waitcnt lgkmcnt(0)
    v_pk_add_f32 v[28:29], v[28:29], v[76:77]
    v_pk_add_f32 v[30:31], v[30:31], v[78:79]
    v_cvt_pk_bf16_f32 v144, v16, v17
    v_cvt_pk_bf16_f32 v145, v18, v19
    v_cvt_pk_bf16_f32 v146, v20, v21
    v_cvt_pk_bf16_f32 v147, v22, v23
    v_cvt_pk_bf16_f32 v148, v24, v25
    v_cvt_pk_bf16_f32 v149, v26, v27
    v_cvt_pk_bf16_f32 v150, v28, v29
    v_cvt_pk_bf16_f32 v151, v30, v31
    s_cmp_lg_u32 s48, 0
    s_cbranch_scc1 L_slow_55
    buffer_store_dwordx4 v[144:147], v1, s[4:7], s87 offen offset:0
    buffer_store_dwordx4 v[148:151], v1, s[4:7], s87 offen offset:1024
L_join_56:
    v_pk_add_f32 v[112:113], v[16:17], v[18:19]
    v_pk_mul_f32 v[114:115], v[16:17], v[16:17]
    v_pk_add_f32 v[116:117], v[20:21], v[22:23]
    v_pk_mul_f32 v[118:119], v[18:19], v[18:19]
    v_pk_fma_f32 v[114:115], v[20:21], v[20:21], v[114:115]
    v_pk_fma_f32 v[118:119], v[22:23], v[22:23], v[118:119]
    v_pk_fma_f32 v[114:115], v[24:25], v[24:25], v[114:115]
    v_pk_add_f32 v[112:113], v[112:113], v[24:25]
    v_pk_fma_f32 v[118:119], v[26:27], v[26:27], v[118:119]
    v_pk_add_f32 v[116:117], v[116:117], v[26:27]
    v_pk_fma_f32 v[114:115], v[28:29], v[28:29], v[114:115]
    v_pk_add_f32 v[112:113], v[112:113], v[28:29]
    v_pk_fma_f32 v[118:119], v[30:31], v[30:31], v[118:119]
    v_pk_add_f32 v[116:117], v[116:117], v[30:31]
    v_pk_add_f32 v[112:113], v[112:113], v[116:117]
    v_pk_add_f32 v[114:115], v[114:115], v[118:119]
    v_add_f32 v112, v112, v113
    v_add_f32 v113, v114, v115
    s_nop 1
    v_permlane32_swap_b32 v112, v113
    v_add_f32 v112, v112, v113
    s_cmp_lg_u32 s48, 0
    s_cbranch_scc1 L_slow_57
    buffer_store_dword v112, v1, s[4:7], s88 offen
L_join_58:
    s_add_u32 m0, s94, 0
    s_add_u32 s70, s93, 28672
    buffer_load_dwordx4 v1, s[4:7], s70 offen offset:0 sc1 lds
    buffer_load_dwordx4 v1, s[4:7], s70 offen offset:1024 sc1 lds
    buffer_load_dwordx4 v1, s[4:7], s70 offen offset:2048 sc1 lds
    buffer_load_dwordx4 v1, s[4:7], s70 offen offset:3072 sc1 lds
    s_add_u32 m0, m0, 4096
    s_add_u32 s70, s70, 4096
    buffer_load_dwordx4 v1, s[4:7], s70 offen offset:0 sc1 lds
    buffer_load_dwordx4 v1, s[4:7], s70 offen offset:1024 sc1 lds
    s_add_u32 s22, s3, 6
    v_mov_b32 v5, s22
    s_mov_b64 exec, 1
    s_waitcnt vmcnt(6)
    s_cmp_lg_u32 s48, 0
    s_cbranch_scc1 L_slow_59
    buffer_store_dword v5, off, s[4:7], s82
L_join_60:
    s_mov_b64 exec, -1
    buffer_load_dwordx4 v1, s[4:7], s70 offen offset:2048 sc1 lds
    s_add_u32 m0, s94, 28672
    s_add_u32 s70, s93, 57344
    buffer_load_dwordx4 v1, s[4:7], s70 offen offset:0 sc1 lds
    buffer_load_dwordx4 v1, s[4:7], s70 offen offset:1024 sc1 lds
    buffer_load_dwordx4 v1, s[4:7], s70 offen offset:2048 sc1 lds
    buffer_load_dwordx4 v1, s[4:7], s70 offen offset:3072 sc1 lds
    s_add_u32 m0, m0, 4096
    s_add_u32 s70, s70, 4096
    buffer_load_dwordx4 v1, s[4:7], s70 offen offset:0 sc1 lds
    buffer_load_dwordx4 v1, s[4:7], s70 offen offset:1024 sc1 lds
    buffer_load_dwordx4 v1, s[4:7], s70 offen offset:2048 sc1 lds
    s_mov_b32 m0, 131072
    s_sub_u32 s70, s93, s94
    s_add_u32 s70, s70, 86016
    s_mov_b64 exec, 0xffffff
    buffer_load_dwordx4 v1, s[4:7], s70 offen sc1 lds
    s_mov_b64 exec, -1
    v_accvgpr_write_b32 a200, v16
    v_accvgpr_write_b32 a201, v17
    v_accvgpr_write_b32 a202, v18
    v_accvgpr_write_b32 a203, v19
    v_accvgpr_write_b32 a204, v20
    v_accvgpr_write_b32 a205, v21
    v_accvgpr_write_b32 a206, v22
    v_accvgpr_write_b32 a207, v23
    v_accvgpr_write_b32 a208, v24
    v_accvgpr_write_b32 a209, v25
    v_accvgpr_write_b32 a210, v26
    v_accvgpr_write_b32 a211, v27
    v_accvgpr_write_b32 a212, v28
    v_accvgpr_write_b32 a213, v29
    v_accvgpr_write_b32 a214, v30
    v_accvgpr_write_b32 a215, v31
    s_branch L_qkv
L_idle:
    s_cmp_lg_u32 s38, 0
    s_cbranch_scc1 L_idl1_61
    s_mul_i32 s94, s41, 7168
    s_mul_i32 s93, s43, 90112
    s_add_u32 s93, s93, s94
    s_add_u32 s93, s93, 13631488
    s_lshl_b32 s67, s38, 30
    s_add_u32 s93, s93, s67
    s_add_u32 m0, s94, 135168
    s_add_u32 s70, s93, 0
    buffer_load_dwordx4 v1, s[4:7], s70 offen offset:0 sc1 lds
    buffer_load_dwordx4 v1, s[4:7], s70 offen offset:1024 sc1 lds
    buffer_load_dwordx4 v1, s[4:7], s70 offen offset:2048 sc1 lds
    buffer_load_dwordx4 v1, s[4:7], s70 offen offset:3072 sc1 lds
    s_add_u32 m0, m0, 4096
    s_add_u32 s70, s70, 4096
    buffer_load_dwordx4 v1, s[4:7], s70 offen offset:0 sc1 lds
    buffer_load_dwordx4 v1, s[4:7], s70 offen offset:1024 sc1 lds
    buffer_load_dwordx4 v1, s[4:7], s70 offen offset:2048 sc1 lds
    s_add_u32 m0, s94, 0
    s_add_u32 s70, s93, 28672
    buffer_load_dwordx4 v1, s[4:7], s70 offen offset:0 sc1 lds
    buffer_load_dwordx4 v1, s[4:7], s70 offen offset:1024 sc1 lds
    buffer_load_dwordx4 v1, s[4:7], s70 offen offset:2048 sc1 lds
    buffer_load_dwordx4 v1, s[4:7], s70 offen offset:3072 sc1 lds
    s_add_u32 m0, m0, 4096
    s_add_u32 s70, s70, 4096
    buffer_load_dwordx4 v1, s[4:7], s70 offen offset:0 sc1 lds
    buffer_load_dwordx4 v1, s[4:7], s70 offen offset:1024 sc1 lds
    buffer_load_dwordx4 v1, s[4:7], s70 offen offset:2048 sc1 lds
    s_add_u32 m0, s94, 28672
    s_add_u32 s70, s93, 57344
    buffer_load_dwordx4 v1, s[4:7], s70 offen offset:0 sc1 lds
    buffer_load_dwordx4 v1, s[4:7], s70 offen offset:1024 sc1 lds
    buffer_load_dwordx4 v1, s[4:7], s70 offen offset:2048 sc1 lds
    buffer_load_dwordx4 v1, s[4:7], s70 offen offset:3072 sc1 lds
    s_add_u32 m0, m0, 4096
    s_add_u32 s70, s70, 4096
    buffer_load_dwordx4 v1, s[4:7], s70 offen offset:0 sc1 lds
    buffer_load_dwordx4 v1, s[4:7], s70 offen offset:1024 sc1 lds
    buffer_load_dwordx4 v1, s[4:7], s70 offen offset:2048 sc1 lds
    s_mov_b32 m0, 131072
    s_sub_u32 s70, s93, s94
    s_add_u32 s70, s70, 86016
    s_mov_b64 exec, 0xffffff
    buffer_load_dwordx4 v1, s[4:7], s70 offen sc1 lds
    s_mov_b64 exec, -1
L_idl1_61:
    s_sub_u32 s62, s40, 28
    s_lshl_b32 s62, s62, 2
    s_add_u32 s62, s62, s41
    s_cmp_eq_u32 s38, 0
    s_cbranch_scc1 L_iw_62
    s_mov_b32 s8, s28
    s_and_b32 s9, s29, 0xffff
    s_mov_b32 s10, 1605632
    s_mov_b32 s11, 0x20000
    v_lshlrev_b32 v5, 8, v0
    s_lshl_b32 s63, s62, 14
    buffer_load_dword v198, v5, s[8:11], s63 offen offset:0
    s_add_u32 s63, s63, 262144
    buffer_load_dword v198, v5, s[8:11], s63 offen offset:0
    s_add_u32 s63, s63, 262144
    buffer_load_dword v198, v5, s[8:11], s63 offen offset:0
    s_add_u32 s63, s63, 262144
    buffer_load_dword v198, v5, s[8:11], s63 offen offset:0
    s_add_u32 s63, s63, 262144
    buffer_load_dword v198, v5, s[8:11], s63 offen offset:0
    s_add_u32 s63, s63, 262144
    buffer_load_dword v198, v5, s[8:11], s63 offen offset:0
    s_add_u32 s63, s63, 262144
    buffer_load_dword v198, v5, s[8:11], s63 offen offset:0
    s_lshl_b32 s63, s62, 14
    buffer_load_dword v198, v5, s[8:11], s63 offen offset:128
    s_add_u32 s63, s63, 262144
    buffer_load_dword v198, v5, s[8:11], s63 offen offset:128
    s_add_u32 s63, s63, 262144
    buffer_load_dword v198, v5, s[8:11], s63 offen offset:128
    s_add_u32 s63, s63, 262144
    buffer_load_dword v198, v5, s[8:11], s63 offen offset:128
    s_add_u32 s63, s63, 262144
    buffer_load_dword v198, v5, s[8:11], s63 offen offset:128
    s_add_u32 s63, s63, 262144
    buffer_load_dword v198, v5, s[8:11], s63 offen offset:128
    s_add_u32 s63, s63, 262144
    buffer_load_dword v198, v5, s[8:11], s63 offen offset:128
    s_branch L_iw_63
L_iw_62:
    v_lshlrev_b32 v5, 7, v0
    s_mul_i32 s63, s39, 1409024
    s_mul_i32 s64, s62, 57344
    s_add_u32 s63, s63, s64
    s_add_u32 s63, s63, 17268736
    buffer_load_dword v198, v5, s[4:7], s63 offen sc1
    s_add_u32 s63, s63, 8192
    buffer_load_dword v198, v5, s[4:7], s63 offen sc1
    s_add_u32 s63, s63, 8192
    buffer_load_dword v198, v5, s[4:7], s63 offen sc1
    s_add_u32 s63, s63, 8192
    buffer_load_dword v198, v5, s[4:7], s63 offen sc1
    s_add_u32 s63, s63, 8192
    buffer_load_dword v198, v5, s[4:7], s63 offen sc1
    s_add_u32 s63, s63, 8192
    buffer_load_dword v198, v5, s[4:7], s63 offen sc1
    s_add_u32 s63, s63, 8192
    buffer_load_dword v198, v5, s[4:7], s63 offen sc1
    s_add_u32 s63, s63, 8192
L_iw_63:
    s_mov_b32 s8, s30
    s_and_b32 s9, s31, 0xffff
    s_mov_b32 s10, 1605632
    s_mov_b32 s11, 0x20000
    v_min_u32 v5, 48, v0
    v_lshlrev_b32 v5, 7, v5
    s_lshr_b32 s63, s62, 3
    s_mul_i32 s63, s63, 802816
    s_and_b32 s64, s62, 7
    s_mul_i32 s64, s64, 12544
    s_add_u32 s63, s63, s64
    buffer_load_dword v198, v5, s[8:11], s63 offen
    s_add_u32 s63, s63, 6272
    buffer_load_dword v198, v5, s[8:11], s63 offen
    s_add_u32 s63, s63, 94080
    buffer_load_dword v198, v5, s[8:11], s63 offen
    s_add_u32 s63, s63, 6272
    buffer_load_dword v198, v5, s[8:11], s63 offen
    s_add_u32 s63, s63, 94080
    buffer_load_dword v198, v5, s[8:11], s63 offen
    s_add_u32 s63, s63, 6272
    buffer_load_dword v198, v5, s[8:11], s63 offen
    s_add_u32 s63, s63, 94080
    buffer_load_dword v198, v5, s[8:11], s63 offen
    s_add_u32 s63, s63, 6272
    buffer_load_dword v198, v5, s[8:11], s63 offen
    s_add_u32 s63, s63, 94080
    buffer_load_dword v198, v5, s[8:11], s63 offen
    s_add_u32 s63, s63, 6272
    buffer_load_dword v198, v5, s[8:11], s63 offen
    s_add_u32 s63, s63, 94080
    v_lshlrev_b32 v5, 7, v0
    s_mul_i32 s63, s39, 1409024
    s_mul_i32 s64, s62, 57344
    s_add_u32 s63, s63, s64
    s_add_u32 s63, s63, 17268736
    buffer_load_dword v198, v5, s[4:7], s63 offen sc1
    s_add_u32 s63, s63, 8192
    buffer_load_dword v198, v5, s[4:7], s63 offen sc1
    s_add_u32 s63, s63, 8192
    buffer_load_dword v198, v5, s[4:7], s63 offen sc1
    s_add_u32 s63, s63, 8192
    buffer_load_dword v198, v5, s[4:7], s63 offen sc1
    s_add_u32 s63, s63, 8192
    buffer_load_dword v198, v5, s[4:7], s63 offen sc1
    s_add_u32 s63, s63, 8192
    buffer_load_dword v198, v5, s[4:7], s63 offen sc1
    s_add_u32 s63, s63, 8192
    buffer_load_dword v198, v5, s[4:7], s63 offen sc1
    s_add_u32 s63, s63, 8192
    s_mov_b32 s8, s30
    s_and_b32 s9, s31, 0xffff
    s_mov_b32 s10, 1605632
    s_mov_b32 s11, 0x20000
    v_min_u32 v5, 48, v0
    v_lshlrev_b32 v5, 7, v5
    s_lshr_b32 s63, s62, 3
    s_mul_i32 s63, s63, 802816
    s_and_b32 s64, s62, 7
    s_mul_i32 s64, s64, 12544
    s_add_u32 s63, s63, s64
    s_add_u32 s63, s63, 501760
    buffer_load_dword v198, v5, s[8:11], s63 offen
    s_add_u32 s63, s63, 6272
    buffer_load_dword v198, v5, s[8:11], s63 offen
    s_add_u32 s63, s63, 94080
    buffer_load_dword v198, v5, s[8:11], s63 offen
    s_add_u32 s63, s63, 6272
    buffer_load_dword v198, v5, s[8:11], s63 offen
    s_add_u32 s63, s63, 94080
    buffer_load_dword v198, v5, s[8:11], s63 offen
    s_add_u32 s63, s63, 6272
    buffer_load_dword v198, v5, s[8:11], s63 offen
    s_add_u32 s63, s63, 94080
    s_cmp_lg_u32 s38, 0
    s_cbranch_scc1 L_end
    s_sub_u32 s65, s40, 28
    s_lshl_b32 s65, s65, 2
    s_add_u32 s65, s65, s41
    s_mul_i32 s65, s65, 90112
    s_add_u32 s65, s65, 13631488
    v_lshlrev_b32 v5, 7, v0
    s_lshl_b32 s64, s38, 31
    v_or_b32 v5, s64, v5
    buffer_load_dword v198, v5, s[4:7], s65 offen sc1
    s_add_u32 s65, s65, 8192
    buffer_load_dword v198, v5, s[4:7], s65 offen sc1
    s_add_u32 s65, s65, 8192
    buffer_load_dword v198, v5, s[4:7], s65 offen sc1
    s_add_u32 s65, s65, 8192
    buffer_load_dword v198, v5, s[4:7], s65 offen sc1
    s_add_u32 s65, s65, 8192
    buffer_load_dword v198, v5, s[4:7], s65 offen sc1
    s_add_u32 s65, s65, 8192
    buffer_load_dword v198, v5, s[4:7], s65 offen sc1
    s_add_u32 s65, s65, 8192
    buffer_load_dword v198, v5, s[4:7], s65 offen sc1
    s_add_u32 s65, s65, 8192
    buffer_load_dword v198, v5, s[4:7], s65 offen sc1
    s_add_u32 s65, s65, 8192
    buffer_load_dword v198, v5, s[4:7], s65 offen sc1
    s_add_u32 s65, s65, 8192
    buffer_load_dword v198, v5, s[4:7], s65 offen sc1
    s_add_u32 s65, s65, 8192
    buffer_load_dword v198, v5, s[4:7], s65 offen sc1
    s_add_u32 s65, s65, 8192
L_qkv:
    v_add_u32 v14, 135168, v2
    v_add_u32 v15, 0, v2
    v_add_u32 v11, 28672, v2
    s_lshl_b32 s60, s41, 8
    s_add_u32 s60, s60, 131584
    v_lshl_add_u32 v9, v0, 2, s60
    s_sub_u32 s60, s60, 131072
    v_add_u32 v10, s60, v201
    v_and_b32 v8, 31, v0
    v_lshlrev_b32 v8, 2, v8
    v_add_u32 v8, 131328, v8
    s_lshl_b32 s62, s86, 12
    s_add_u32 s62, s62, s80
    s_add_u32 s62, s62, 229376
    s_mul_i32 s60, s86, 28672
    s_add_u32 s60, s60, s49
    s_add_u32 s60, s60, 262144
    v_add_u32 v7, s60, v1
    s_lshr_b32 s61, s40, 4
    s_lshl_b32 s61, s61, 1
    s_add_u32 s61, s61, s51
    s_mul_i32 s61, s61, 14
    s_mov_b32 s72, 0x3fff
    s_mov_b32 s73, 0
    s_lshl_b64 s[72:73], s[72:73], s61
    buffer_load_dword v202, v4, s[4:7], 0 offen sc1
    s_add_u32 s22, s3, 6
    s_mov_b32 s74, 0
L_poll_65:
    s_waitcnt vmcnt(0)
    v_subrev_u32 v202, s22, v202
    v_cmp_lt_u32 vcc, 31, v202
    s_and_b64 s[60:61], vcc, s[72:73]
    s_cbranch_scc0 L_poll_done_64
    buffer_load_dword v202, v4, s[4:7], 0 offen sc1
    s_add_u32 s74, s74, 1
    s_cmp_lt_u32 s74, 200000
    s_cbranch_scc1 L_poll_65
    s_waitcnt vmcnt(0)
L_poll_done_64:
    buffer_load_dwordx4 a[0:3], v7, s[4:7], 0 offen offset:0 sc1
    buffer_load_dwordx4 a[4:7], v7, s[4:7], 0 offen offset:1024 sc1
    buffer_load_dwordx4 a[8:11], v7, s[4:7], 0 offen offset:2048 sc1
    s_barrier
    ds_read_b64_tr_b16 a[128:129], v14 offset:0
    ds_read_b64_tr_b16 a[130:131], v14 offset:512
    ds_read_b64_tr_b16 a[132:133], v15 offset:0
    ds_read_b64_tr_b16 a[134:135], v15 offset:512
    ds_read_b64_tr_b16 a[136:137], v11 offset:0
    ds_read_b64_tr_b16 a[138:139], v11 offset:512
    ds_read_b64_tr_b16 a[140:141], v14 offset:1024
    ds_read_b64_tr_b16 a[142:143], v14 offset:1536
    ds_read_b64_tr_b16 a[144:145], v15 offset:1024
    ds_read_b64_tr_b16 a[146:147], v15 offset:1536
    ds_read_b64_tr_b16 a[148:149], v11 offset:1024
    ds_read_b64_tr_b16 a[150:151], v11 offset:1536
    buffer_load_dwordx4 a[12:15], v7, s[4:7], 0 offen offset:3072 sc1
    buffer_load_dwordx4 a[16:19], v7, s[4:7], s52 offen offset:0 sc1
    buffer_load_dwordx4 a[20:23], v7, s[4:7], s52 offen offset:1024 sc1
    s_barrier
    buffer_load_dwordx4 a[24:27], v7, s[4:7], s52 offen offset:2048 sc1
    buffer_load_dwordx4 a[28:31], v7, s[4:7], s52 offen offset:3072 sc1
    buffer_load_dwordx4 a[32:35], v7, s[4:7], s53 offen offset:0 sc1
    s_waitcnt vmcnt(8) lgkmcnt(6)
    v_mfma_f32_32x32x16_bf16 v[176:191], a[128:131], a[0:3], 0
    ds_read_b64_tr_b16 a[152:153], v14 offset:2048
    ds_read_b64_tr_b16 a[154:155], v14 offset:2560
    buffer_load_dwordx4 a[36:39], v7, s[4:7], s53 offen offset:1024 sc1
    v_mfma_f32_32x32x16_bf16 v[208:223], a[132:135], a[0:3], 0
    ds_read_b64_tr_b16 a[156:157], v15 offset:2048
    ds_read_b64_tr_b16 a[158:159], v15 offset:2560
    buffer_load_dwordx4 a[40:43], v7, s[4:7], s53 offen offset:2048 sc1
    v_mfma_f32_32x32x16_bf16 v[224:239], a[0:3], a[136:139], 0
    ds_read_b64_tr_b16 a[160:161], v11 offset:2048
    ds_read_b64_tr_b16 a[162:163], v11 offset:2560
    s_waitcnt vmcnt(9) lgkmcnt(6)
    v_mfma_f32_32x32x16_bf16 v[176:191], a[140:143], a[4:7], v[176:191]
    ds_read_b64_tr_b16 a[128:129], v14 offset:3072
    ds_read_b64_tr_b16 a[130:131], v14 offset:3584
    buffer_load_dwordx4 a[44:47], v7, s[4:7], s53 offen offset:3072 sc1
    ds_read_b128 v[64:67], v201 offset:0
    v_mfma_f32_32x32x16_bf16 v[208:223], a[144:147], a[4:7], v[208:223]
    ds_read_b64_tr_b16 a[132:133], v15 offset:3072
    ds_read_b64_tr_b16 a[134:135], v15 offset:3584
    buffer_load_dwordx4 v[32:35], v1, s[4:7], s62 offen offset:0 sc1
    v_mfma_f32_32x32x16_bf16 v[224:239], a[4:7], a[148:151], v[224:239]
    ds_read_b64_tr_b16 a[136:137], v11 offset:3072
    ds_read_b64_tr_b16 a[138:139], v11 offset:3584
    s_waitcnt vmcnt(10) lgkmcnt(7)
    v_mfma_f32_32x32x16_bf16 v[176:191], a[152:155], a[8:11], v[176:191]
    ds_read_b64_tr_b16 a[140:141], v14 offset:4096
    ds_read_b64_tr_b16 a[142:143], v14 offset:4608
    buffer_load_dwordx4 v[36:39], v1, s[4:7], s62 offen offset:1024 sc1
    ds_read_b128 v[68:71], v201 offset:32
    v_mfma_f32_32x32x16_bf16 v[208:223], a[156:159], a[8:11], v[208:223]
    ds_read_b64_tr_b16 a[144:145], v15 offset:4096
    ds_read_b64_tr_b16 a[146:147], v15 offset:4608
    buffer_load_dwordx4 v[40:43], v1, s[4:7], s62 offen offset:2048 sc1
    v_mfma_f32_32x32x16_bf16 v[224:239], a[8:11], a[160:163], v[224:239]
    ds_read_b64_tr_b16 a[148:149], v11 offset:4096
    ds_read_b64_tr_b16 a[150:151], v11 offset:4608
    s_waitcnt vmcnt(11) lgkmcnt(7)
    v_mfma_f32_32x32x16_bf16 v[176:191], a[128:131], a[12:15], v[176:191]
    ds_read_b64_tr_b16 a[152:153], v14 offset:5120
    ds_read_b64_tr_b16 a[154:155], v14 offset:5632
    buffer_load_dwordx2 v[44:45], v1, s[4:7], s62 offen offset:3072 sc1
    ds_read_b128 v[72:75], v201 offset:64
    v_mfma_f32_32x32x16_bf16 v[208:223], a[132:135], a[12:15], v[208:223]
    ds_read_b64_tr_b16 a[156:157], v15 offset:5120
    ds_read_b64_tr_b16 a[158:159], v15 offset:5632
    buffer_load_dwordx4 a[48:51], v7, s[4:7], s54 offen offset:0 sc1
    v_mfma_f32_32x32x16_bf16 v[224:239], a[12:15], a[136:139], v[224:239]
    ds_read_b64_tr_b16 a[160:161], v11 offset:5120
    ds_read_b64_tr_b16 a[162:163], v11 offset:5632
    s_waitcnt vmcnt(12) lgkmcnt(7)
    v_mfma_f32_32x32x16_bf16 v[176:191], a[140:143], a[16:19], v[176:191]
    ds_read_b64_tr_b16 a[128:129], v14 offset:6144
    ds_read_b64_tr_b16 a[130:131], v14 offset:6656
    buffer_load_dwordx4 a[52:55], v7, s[4:7], s54 offen offset:1024 sc1
    ds_read_b128 v[76:79], v201 offset:96
    v_mfma_f32_32x32x16_bf16 v[208:223], a[144:147], a[16:19], v[208:223]
    ds_read_b64_tr_b16 a[132:133], v15 offset:6144
    ds_read_b64_tr_b16 a[134:135], v15 offset:6656
    buffer_load_dwordx4 a[56:59], v7, s[4:7], s54 offen offset:2048 sc1
    v_mfma_f32_32x32x16_bf16 v[224:239], a[16:19], a[148:151], v[224:239]
    ds_read_b64_tr_b16 a[136:137], v11 offset:6144
    ds_read_b64_tr_b16 a[138:139], v11 offset:6656
    s_waitcnt vmcnt(13) lgkmcnt(7)
    v_mfma_f32_32x32x16_bf16 v[176:191], a[152:155], a[20:23], v[176:191]
    ds_read_b64_tr_b16 a[140:141], v14 offset:7168
    ds_read_b64_tr_b16 a[142:143], v14 offset:7680
    buffer_load_dwordx4 a[60:63], v7, s[4:7], s54 offen offset:3072 sc1
    ds_read_b128 v[80:83], v201 offset:128
    v_mfma_f32_32x32x16_bf16 v[208:223], a[156:159], a[20:23], v[208:223]
    ds_read_b64_tr_b16 a[144:145], v15 offset:7168
    ds_read_b64_tr_b16 a[146:147], v15 offset:7680
    buffer_load_dwordx4 a[64:67], v7, s[4:7], s55 offen offset:0 sc1
    v_mfma_f32_32x32x16_bf16 v[224:239], a[20:23], a[160:163], v[224:239]
    ds_read_b64_tr_b16 a[148:149], v11 offset:7168
    ds_read_b64_tr_b16 a[150:151], v11 offset:7680
    s_waitcnt vmcnt(14) lgkmcnt(7)
    v_mfma_f32_32x32x16_bf16 v[176:191], a[128:131], a[24:27], v[176:191]
    ds_read_b64_tr_b16 a[152:153], v14 offset:8192
    ds_read_b64_tr_b16 a[154:155], v14 offset:8704
    buffer_load_dwordx4 a[68:71], v7, s[4:7], s55 offen offset:1024 sc1
    ds_read_b128 v[84:87], v201 offset:160
    v_mfma_f32_32x32x16_bf16 v[208:223], a[132:135], a[24:27], v[208:223]
    ds_read_b64_tr_b16 a[156:157], v15 offset:8192
    ds_read_b64_tr_b16 a[158:159], v15 offset:8704
    v_mfma_f32_32x32x16_bf16 v[224:239], a[24:27], a[136:139], v[224:239]
    ds_read_b64_tr_b16 a[160:161], v11 offset:8192
    ds_read_b64_tr_b16 a[162:163], v11 offset:8704
    s_waitcnt vmcnt(14) lgkmcnt(7)
    v_mfma_f32_32x32x16_bf16 v[176:191], a[140:143], a[28:31], v[176:191]
    ds_read_b64_tr_b16 a[128:129], v14 offset:9216
    ds_read_b64_tr_b16 a[130:131], v14 offset:9728
    buffer_load_dwordx4 a[72:75], v7, s[4:7], s55 offen offset:2048 sc1
    ds_read_b128 v[88:91], v201 offset:192
    v_mfma_f32_32x32x16_bf16 v[208:223], a[144:147], a[28:31], v[208:223]
    ds_read_b64_tr_b16 a[132:133], v15 offset:9216
    ds_read_b64_tr_b16 a[134:135], v15 offset:9728
    v_mfma_f32_32x32x16_bf16 v[224:239], a[28:31], a[148:151], v[224:239]
    ds_read_b64_tr_b16 a[136:137], v11 offset:9216
    ds_read_b64_tr_b16 a[138:139], v11 offset:9728
    s_waitcnt vmcnt(14) lgkmcnt(7)
    v_mfma_f32_32x32x16_bf16 v[176:191], a[152:155], a[32:35], v[176:191]
    ds_read_b64_tr_b16 a[140:141], v14 offset:10240
    ds_read_b64_tr_b16 a[142:143], v14 offset:10752
    buffer_load_dwordx4 a[76:79], v7, s[4:7], s55 offen offset:3072 sc1
    ds_read_b128 v[92:95], v201 offset:224
    v_mfma_f32_32x32x16_bf16 v[208:223], a[156:159], a[32:35], v[208:223]
    ds_read_b64_tr_b16 a[144:145], v15 offset:10240
    ds_read_b64_tr_b16 a[146:147], v15 offset:10752
    v_mfma_f32_32x32x16_bf16 v[224:239], a[32:35], a[160:163], v[224:239]
    ds_read_b64_tr_b16 a[148:149], v11 offset:10240
    ds_read_b64_tr_b16 a[150:151], v11 offset:10752
    s_waitcnt vmcnt(14) lgkmcnt(7)
    v_mfma_f32_32x32x16_bf16 v[176:191], a[128:131], a[36:39], v[176:191]
    ds_read_b64_tr_b16 a[152:153], v14 offset:11264
    ds_read_b64_tr_b16 a[154:155], v14 offset:11776
    buffer_load_dwordx4 a[80:83], v7, s[4:7], s56 offen offset:0 sc1
    ds_read_b32 v50, v8
    v_mfma_f32_32x32x16_bf16 v[208:223], a[132:135], a[36:39], v[208:223]
    ds_read_b64_tr_b16 a[156:157], v15 offset:11264
    ds_read_b64_tr_b16 a[158:159], v15 offset:11776
    v_mfma_f32_32x32x16_bf16 v[224:239], a[36:39], a[136:139], v[224:239]
    ds_read_b64_tr_b16 a[160:161], v11 offset:11264
    ds_read_b64_tr_b16 a[162:163], v11 offset:11776
    s_waitcnt vmcnt(14) lgkmcnt(7)
    v_mfma_f32_32x32x16_bf16 v[176:191], a[140:143], a[40:43], v[176:191]
    ds_read_b64_tr_b16 a[128:129], v14 offset:12288
    ds_read_b64_tr_b16 a[130:131], v14 offset:12800
    buffer_load_dwordx4 a[84:87], v7, s[4:7], s56 offen offset:1024 sc1
    v_mfma_f32_32x32x16_bf16 v[208:223], a[144:147], a[40:43], v[208:223]
    ds_read_b64_tr_b16 a[132:133], v15 offset:12288
    ds_read_b64_tr_b16 a[134:135], v15 offset:12800
    v_mfma_f32_32x32x16_bf16 v[224:239], a[40:43], a[148:151], v[224:239]
    ds_read_b64_tr_b16 a[136:137], v11 offset:12288
    ds_read_b64_tr_b16 a[138:139], v11 offset:12800
    s_waitcnt vmcnt(10) lgkmcnt(6)
    v_mfma_f32_32x32x16_bf16 v[176:191], a[152:155], a[44:47], v[176:191]
    ds_read_b64_tr_b16 a[140:141], v14 offset:13312
    ds_read_b64_tr_b16 a[142:143], v14 offset:13824
    buffer_load_dwordx4 a[88:91], v7, s[4:7], s56 offen offset:2048 sc1
    v_add_f32 v32, v32, v39
    v_add_f32 v33, v33, v40
    v_mfma_f32_32x32x16_bf16 v[208:223], a[156:159], a[44:47], v[208:223]
    ds_read_b64_tr_b16 a[144:145], v15 offset:13312
    ds_read_b64_tr_b16 a[146:147], v15 offset:13824
    v_add_f32 v34, v34, v41
    v_add_f32 v35, v35, v42
    v_mfma_f32_32x32x16_bf16 v[224:239], a[44:47], a[160:163], v[224:239]
    ds_read_b64_tr_b16 a[148:149], v11 offset:13312
    ds_read_b64_tr_b16 a[150:151], v11 offset:13824
    v_add_f32 v36, v36, v43
    s_waitcnt vmcnt(10) lgkmcnt(6)
    v_mfma_f32_32x32x16_bf16 v[176:191], a[128:131], a[48:51], v[176:191]
    ds_read_b64_tr_b16 a[152:153], v14 offset:14336
    ds_read_b64_tr_b16 a[154:155], v14 offset:14848
    buffer_load_dwordx4 a[92:95], v7, s[4:7], s56 offen offset:3072 sc1
    v_add_f32 v37, v37, v44
    v_add_f32 v38, v38, v45
    v_mfma_f32_32x32x16_bf16 v[208:223], a[132:135], a[48:51], v[208:223]
    ds_read_b64_tr_b16 a[156:157], v15 offset:14336
    ds_read_b64_tr_b16 a[158:159], v15 offset:14848
    v_add_f32 v32, v32, v35
    v_add_f32 v33, v33, v36
    v_mfma_f32_32x32x16_bf16 v[224:239], a[48:51], a[136:139], v[224:239]
    ds_read_b64_tr_b16 a[160:161], v11 offset:14336
    ds_read_b64_tr_b16 a[162:163], v11 offset:14848
    v_add_f32 v34, v34, v37
    s_waitcnt vmcnt(10) lgkmcnt(6)
    v_mfma_f32_32x32x16_bf16 v[176:191], a[140:143], a[52:55], v[176:191]
    ds_read_b64_tr_b16 a[128:129], v14 offset:15360
    ds_read_b64_tr_b16 a[130:131], v14 offset:15872
    buffer_load_dwordx4 a[96:99], v7, s[4:7], s57 offen offset:0 sc1
    v_add_f32 v32, v32, v38
    v_add_f32 v33, v33, v34
    v_mfma_f32_32x32x16_bf16 v[208:223], a[144:147], a[52:55], v[208:223]
    ds_read_b64_tr_b16 a[132:133], v15 offset:15360
    ds_read_b64_tr_b16 a[134:135], v15 offset:15872
    v_add_f32 v32, v32, v33
    v_mov_b32 v33, v32
    v_mfma_f32_32x32x16_bf16 v[224:239], a[52:55], a[148:151], v[224:239]
    ds_read_b64_tr_b16 a[136:137], v11 offset:15360
    ds_read_b64_tr_b16 a[138:139], v11 offset:15872
    s_nop 1
    s_waitcnt vmcnt(10) lgkmcnt(6)
    v_mfma_f32_32x32x16_bf16 v[176:191], a[152:155], a[56:59], v[176:191]
    ds_read_b64_tr_b16 a[140:141], v14 offset:16384
    ds_read_b64_tr_b16 a[142:143], v14 offset:16896
    buffer_load_dwordx4 a[100:103], v7, s[4:7], s57 offen offset:1024 sc1
    v_permlane32_swap_b32 v33, v32
    v_mul_f32 v12, 0x3b124925, v33
    v_mfma_f32_32x32x16_bf16 v[208:223], a[156:159], a[56:59], v[208:223]
    ds_read_b64_tr_b16 a[144:145], v15 offset:16384
    ds_read_b64_tr_b16 a[146:147], v15 offset:16896
    v_mul_f32 v32, 0x3b124925, v32
    v_fma_f32 v33, -v12, v12, v32
    v_mfma_f32_32x32x16_bf16 v[224:239], a[56:59], a[160:163], v[224:239]
    ds_read_b64_tr_b16 a[148:149], v11 offset:16384
    ds_read_b64_tr_b16 a[150:151], v11 offset:16896
    v_max_f32 v33, 0, v33
    s_waitcnt vmcnt(10) lgkmcnt(6)
    v_mfma_f32_32x32x16_bf16 v[176:191], a[128:131], a[60:63], v[176:191]
    ds_read_b64_tr_b16 a[152:153], v14 offset:17408
    ds_read_b64_tr_b16 a[154:155], v14 offset:17920
    buffer_load_dwordx4 a[104:107], v7, s[4:7], s57 offen offset:2048 sc1
    v_add_f32 v33, 0x3727c5ac, v33
    v_rsq_f32 v46, v33
    v_mfma_f32_32x32x16_bf16 v[208:223], a[132:135], a[60:63], v[208:223]
    ds_read_b64_tr_b16 a[156:157], v15 offset:17408
    ds_read_b64_tr_b16 a[158:159], v15 offset:17920
    v_sub_f32 v47, 0, v12
    v_cmp_gt_u32 vcc, 32, v0
    v_mfma_f32_32x32x16_bf16 v[224:239], a[60:63], a[136:139], v[224:239]
    ds_read_b64_tr_b16 a[160:161], v11 offset:17408
    ds_read_b64_tr_b16 a[162:163], v11 offset:17920
    v_mul_f32 v48, 0x3e8b97f6, v46
    s_waitcnt vmcnt(10) lgkmcnt(6)
    v_mfma_f32_32x32x16_bf16 v[176:191], a[140:143], a[64:67], v[176:191]
    ds_read_b64_tr_b16 a[128:129], v14 offset:18432
    ds_read_b64_tr_b16 a[130:131], v14 offset:18944
    buffer_load_dwordx4 a[108:111], v7, s[4:7], s57 offen offset:3072 sc1
    v_mul_f32 v49, v47, v46
    v_cndmask_b32 v49, v49, v46, vcc
    v_mfma_f32_32x32x16_bf16 v[208:223], a[144:147], a[64:67], v[208:223]
    ds_read_b64_tr_b16 a[132:133], v15 offset:18432
    ds_read_b64_tr_b16 a[134:135], v15 offset:18944
    ds_write_b32 v9, v49
    v_mfma_f32_32x32x16_bf16 v[224:239], a[64:67], a[148:151], v[224:239]
    ds_read_b64_tr_b16 a[136:137], v11 offset:18432
    ds_read_b64_tr_b16 a[138:139], v11 offset:18944
    s_waitcnt vmcnt(10) lgkmcnt(7)
    v_mfma_f32_32x32x16_bf16 v[176:191], a[152:155], a[68:71], v[176:191]
    ds_read_b64_tr_b16 a[140:141], v14 offset:19456
    ds_read_b64_tr_b16 a[142:143], v14 offset:19968
    v_mfma_f32_32x32x16_bf16 v[208:223], a[156:159], a[68:71], v[208:223]
    ds_read_b64_tr_b16 a[144:145], v15 offset:19456
    ds_read_b64_tr_b16 a[146:147], v15 offset:19968
    v_mfma_f32_32x32x16_bf16 v[224:239], a[68:71], a[160:163], v[224:239]
    ds_read_b64_tr_b16 a[148:149], v11 offset:19456
    ds_read_b64_tr_b16 a[150:151], v11 offset:19968
    s_waitcnt vmcnt(9) lgkmcnt(6)
    v_mfma_f32_32x32x16_bf16 v[176:191], a[128:131], a[72:75], v[176:191]
    ds_read_b64_tr_b16 a[152:153], v14 offset:20480
    ds_read_b64_tr_b16 a[154:155], v14 offset:20992
    ds_read_b128 v[96:99], v10 offset:0
    v_mfma_f32_32x32x16_bf16 v[208:223], a[132:135], a[72:75], v[208:223]
    ds_read_b64_tr_b16 a[156:157], v15 offset:20480
    ds_read_b64_tr_b16 a[158:159], v15 offset:20992
    v_mfma_f32_32x32x16_bf16 v[224:239], a[72:75], a[136:139], v[224:239]
    ds_read_b64_tr_b16 a[160:161], v11 offset:20480
    ds_read_b64_tr_b16 a[162:163], v11 offset:20992
    s_waitcnt vmcnt(8) lgkmcnt(7)
    v_mfma_f32_32x32x16_bf16 v[176:191], a[140:143], a[76:79], v[176:191]
    ds_read_b64_tr_b16 a[128:129], v14 offset:21504
    ds_read_b64_tr_b16 a[130:131], v14 offset:22016
    ds_read_b128 v[100:103], v10 offset:32
    v_mfma_f32_32x32x16_bf16 v[208:223], a[144:147], a[76:79], v[208:223]
    ds_read_b64_tr_b16 a[132:133], v15 offset:21504
    ds_read_b64_tr_b16 a[134:135], v15 offset:22016
    v_mfma_f32_32x32x16_bf16 v[224:239], a[76:79], a[148:151], v[224:239]
    ds_read_b64_tr_b16 a[136:137], v11 offset:21504
    ds_read_b64_tr_b16 a[138:139], v11 offset:22016
    s_waitcnt vmcnt(7) lgkmcnt(7)
    v_mfma_f32_32x32x16_bf16 v[176:191], a[152:155], a[80:83], v[176:191]
    ds_read_b64_tr_b16 a[140:141], v14 offset:22528
    ds_read_b64_tr_b16 a[142:143], v14 offset:23040
    ds_read_b128 v[104:107], v10 offset:64
    v_mfma_f32_32x32x16_bf16 v[208:223], a[156:159], a[80:83], v[208:223]
    ds_read_b64_tr_b16 a[144:145], v15 offset:22528
    ds_read_b64_tr_b16 a[146:147], v15 offset:23040
    v_mfma_f32_32x32x16_bf16 v[224:239], a[80:83], a[160:163], v[224:239]
    ds_read_b64_tr_b16 a[148:149], v11 offset:22528
    ds_read_b64_tr_b16 a[150:151], v11 offset:23040
    s_waitcnt vmcnt(6) lgkmcnt(7)
    v_mfma_f32_32x32x16_bf16 v[176:191], a[128:131], a[84:87], v[176:191]
    ds_read_b64_tr_b16 a[152:153], v14 offset:23552
    ds_read_b64_tr_b16 a[154:155], v14 offset:24064
    ds_read_b128 v[108:111], v10 offset:96
    v_mfma_f32_32x32x16_bf16 v[208:223], a[132:135], a[84:87], v[208:223]
    ds_read_b64_tr_b16 a[156:157], v15 offset:23552
    ds_read_b64_tr_b16 a[158:159], v15 offset:24064
    v_mfma_f32_32x32x16_bf16 v[224:239], a[84:87], a[136:139], v[224:239]
    ds_read_b64_tr_b16 a[160:161], v11 offset:23552
    ds_read_b64_tr_b16 a[162:163], v11 offset:24064
    s_waitcnt vmcnt(5) lgkmcnt(7)
    v_mfma_f32_32x32x16_bf16 v[176:191], a[140:143], a[88:91], v[176:191]
    ds_read_b64_tr_b16 a[128:129], v14 offset:24576
    ds_read_b64_tr_b16 a[130:131], v14 offset:25088
    ds_read_b128 v[112:115], v10 offset:128
    v_mfma_f32_32x32x16_bf16 v[208:223], a[144:147], a[88:91], v[208:223]
    ds_read_b64_tr_b16 a[132:133], v15 offset:24576
    ds_read_b64_tr_b16 a[134:135], v15 offset:25088
    v_mfma_f32_32x32x16_bf16 v[224:239], a[88:91], a[148:151], v[224:239]
    ds_read_b64_tr_b16 a[136:137], v11 offset:24576
    ds_read_b64_tr_b16 a[138:139], v11 offset:25088
    s_waitcnt vmcnt(4) lgkmcnt(7)
    v_mfma_f32_32x32x16_bf16 v[176:191], a[152:155], a[92:95], v[176:191]
    ds_read_b64_tr_b16 a[140:141], v14 offset:25600
    ds_read_b64_tr_b16 a[142:143], v14 offset:26112
    ds_read_b128 v[116:119], v10 offset:160
    v_mfma_f32_32x32x16_bf16 v[208:223], a[156:159], a[92:95], v[208:223]
    ds_read_b64_tr_b16 a[144:145], v15 offset:25600
    ds_read_b64_tr_b16 a[146:147], v15 offset:26112
    v_mfma_f32_32x32x16_bf16 v[224:239], a[92:95], a[160:163], v[224:239]
    ds_read_b64_tr_b16 a[148:149], v11 offset:25600
    ds_read_b64_tr_b16 a[150:151], v11 offset:26112
    s_waitcnt vmcnt(3) lgkmcnt(7)
    v_mfma_f32_32x32x16_bf16 v[176:191], a[128:131], a[96:99], v[176:191]
    ds_read_b64_tr_b16 a[152:153], v14 offset:26624
    ds_read_b64_tr_b16 a[154:155], v14 offset:27136
    ds_read_b128 v[120:123], v10 offset:192
    v_mfma_f32_32x32x16_bf16 v[208:223], a[132:135], a[96:99], v[208:223]
    ds_read_b64_tr_b16 a[156:157], v15 offset:26624
    ds_read_b64_tr_b16 a[158:159], v15 offset:27136
    v_mfma_f32_32x32x16_bf16 v[224:239], a[96:99], a[136:139], v[224:239]
    ds_read_b64_tr_b16 a[160:161], v11 offset:26624
    ds_read_b64_tr_b16 a[162:163], v11 offset:27136
    s_waitcnt vmcnt(2) lgkmcnt(7)
    v_mfma_f32_32x32x16_bf16 v[176:191], a[140:143], a[100:103], v[176:191]
    ds_read_b64_tr_b16 a[128:129], v14 offset:27648
    ds_read_b64_tr_b16 a[130:131], v14 offset:28160
    ds_read_b128 v[124:127], v10 offset:224
    v_mfma_f32_32x32x16_bf16 v[208:223], a[144:147], a[100:103], v[208:223]
    ds_read_b64_tr_b16 a[132:133], v15 offset:27648
    ds_read_b64_tr_b16 a[134:135], v15 offset:28160
    v_mfma_f32_32x32x16_bf16 v[224:239], a[100:103], a[148:151], v[224:239]
    ds_read_b64_tr_b16 a[136:137], v11 offset:27648
    ds_read_b64_tr_b16 a[138:139], v11 offset:28160
    s_waitcnt vmcnt(1) lgkmcnt(7)
    v_mfma_f32_32x32x16_bf16 v[176:191], a[152:155], a[104:107], v[176:191]
    v_mfma_f32_32x32x16_bf16 v[208:223], a[156:159], a[104:107], v[208:223]
    v_mfma_f32_32x32x16_bf16 v[224:239], a[104:107], a[160:163], v[224:239]
    s_waitcnt vmcnt(0) lgkmcnt(0)
    v_mfma_f32_32x32x16_bf16 v[176:191], a[128:131], a[108:111], v[176:191]
    v_mfma_f32_32x32x16_bf16 v[208:223], a[132:135], a[108:111], v[208:223]
    v_mfma_f32_32x32x16_bf16 v[224:239], a[108:111], a[136:139], v[224:239]
    s_mov_b32 s38, 1
    s_add_u32 s3, s3, 8
    v_bfrev_b32 v196, 1
    s_nop 5
    s_waitcnt lgkmcnt(0)
    s_branch L_kv
L_end:
L_done:
    s_endpgm
L_attn_retry:
    v_mov_b32 v160, 0
    v_mov_b32 v161, 0
    v_mov_b32 v162, 0
    v_mov_b32 v163, 0
    v_mov_b32 v164, 0
    v_mov_b32 v165, 0
    v_mov_b32 v166, 0
    v_mov_b32 v167, 0
    v_mov_b32 v168, 0
    v_mov_b32 v169, 0
    v_mov_b32 v170, 0
    v_mov_b32 v171, 0
    v_mov_b32 v172, 0
    v_mov_b32 v173, 0
    v_mov_b32 v174, 0
    v_mov_b32 v175, 0
    v_accvgpr_write_b32 a16, 0
    v_accvgpr_write_b32 a17, 0
    v_accvgpr_write_b32 a18, 0
    v_accvgpr_write_b32 a19, 0
    v_accvgpr_write_b32 a20, 0
    v_accvgpr_write_b32 a21, 0
    v_accvgpr_write_b32 a22, 0
    v_accvgpr_write_b32 a23, 0
    v_accvgpr_write_b32 a24, 0
    v_accvgpr_write_b32 a25, 0
    v_accvgpr_write_b32 a26, 0
    v_accvgpr_write_b32 a27, 0
    v_accvgpr_write_b32 a28, 0
    v_accvgpr_write_b32 a29, 0
    v_accvgpr_write_b32 a30, 0
    v_accvgpr_write_b32 a31, 0
    v_accvgpr_write_b32 a32, 0
    v_accvgpr_write_b32 a33, 0
    v_accvgpr_write_b32 a34, 0
    v_accvgpr_write_b32 a35, 0
    v_accvgpr_write_b32 a36, 0
    v_accvgpr_write_b32 a37, 0
    v_accvgpr_write_b32 a38, 0
    v_accvgpr_write_b32 a39, 0
    v_accvgpr_write_b32 a40, 0
    v_accvgpr_write_b32 a41, 0
    v_accvgpr_write_b32 a42, 0
    v_accvgpr_write_b32 a43, 0
    v_accvgpr_write_b32 a44, 0
    v_accvgpr_write_b32 a45, 0
    v_accvgpr_write_b32 a46, 0
    v_accvgpr_write_b32 a47, 0
    v_accvgpr_write_b32 a48, 0
    v_accvgpr_write_b32 a49, 0
    v_accvgpr_write_b32 a50, 0
    v_accvgpr_write_b32 a51, 0
    v_accvgpr_write_b32 a52, 0
    v_accvgpr_write_b32 a53, 0
    v_accvgpr_write_b32 a54, 0
    v_accvgpr_write_b32 a55, 0
    v_accvgpr_write_b32 a56, 0
    v_accvgpr_write_b32 a57, 0
    v_accvgpr_write_b32 a58, 0
    v_accvgpr_write_b32 a59, 0
    v_accvgpr_write_b32 a60, 0
    v_accvgpr_write_b32 a61, 0
    v_accvgpr_write_b32 a62, 0
    v_accvgpr_write_b32 a63, 0
    v_accvgpr_write_b32 a124, 0
    v_accvgpr_write_b32 a125, 0
    v_accvgpr_write_b32 a126, 0
    v_accvgpr_write_b32 a127, 0
    v_mov_b32 v88, 0
    v_mov_b32 v89, 0
    v_mov_b32 v90, 0
    v_mov_b32 v91, 0
    v_mov_b32 v92, 0
    v_mov_b32 v93, 0
    v_mov_b32 v94, 0
    v_mov_b32 v95, 0
    v_mov_b32 v80, 0
    v_mov_b32 v81, 0
    v_mov_b32 v82, 0
    v_mov_b32 v83, 0
    v_mov_b32 v84, 0
    v_mov_b32 v85, 0
    v_mov_b32 v86, 0
    v_mov_b32 v87, 0
    v_mov_b32 v96, 0xff800000
    v_mov_b32 v97, 0xff800000
    v_mov_b32 v98, 0xff800000
    v_mov_b32 v99, 0xff800000
    s_mov_b32 s76, 0
    s_lshl_b32 s60, s42, 14
    s_add_u32 s66, s60, s78
    buffer_load_dwordx4 a[64:67], v1, s[4:7], s66 offen offset:0 sc1
    buffer_load_dwordx4 a[68:71], v1, s[4:7], s66 offen offset:1024 sc1
    buffer_load_dwordx4 a[72:75], v1, s[4:7], s66 offen offset:2048 sc1
    buffer_load_dwordx4 a[76:79], v1, s[4:7], s66 offen offset:3072 sc1
L_attn_next:
    s_lshl_b32 s60, s76, 14
    s_add_u32 s60, s60, s78
    buffer_load_dwordx4 v[136:139], v1, s[4:7], s60 offen offset:0 sc1
    buffer_load_dwordx4 v[140:143], v1, s[4:7], s60 offen offset:1024 sc1
    s_waitcnt vmcnt(0)
    s_branch L_attn_pp
L_attn_loop0:
    v_mfma_f32_32x32x16_bf16 v[64:79], a[64:67], v[24:27], 0
    buffer_load_dwordx4 a[112:115], v1, s[4:7], s66 offen offset:0 sc1
    v_cvt_pk_bf16_f32 v94, v84, v85
    v_cvt_pk_bf16_f32 v95, v86, v87
    v_exp_f32 v80, v48
    v_exp_f32 v81, v49
    v_exp_f32 v82, v50
    v_exp_f32 v83, v51
    v_mfma_f32_32x32x16_bf16 v[64:79], a[68:71], v[28:31], v[64:79]
    buffer_load_dwordx4 a[116:119], v1, s[4:7], s66 offen offset:1024 sc1
    v_cvt_pk_bf16_f32 v88, v80, v81
    v_cvt_pk_bf16_f32 v89, v82, v83
    v_exp_f32 v84, v52
    v_exp_f32 v85, v53
    v_exp_f32 v86, v54
    v_exp_f32 v87, v55
    v_mfma_f32_32x32x16_bf16 a[48:63], a[124:127], v[92:95], a[48:63]
    buffer_load_dwordx4 a[120:123], v1, s[4:7], s66 offen offset:2048 sc1
    v_cvt_pk_bf16_f32 v90, v84, v85
    v_cvt_pk_bf16_f32 v91, v86, v87
    v_exp_f32 v80, v56
    v_exp_f32 v81, v57
    v_exp_f32 v82, v58
    v_exp_f32 v83, v59
    v_mfma_f32_32x32x16_bf16 v[160:175], a[72:75], v[88:91], v[160:175]
    buffer_load_dwordx4 a[124:127], v1, s[4:7], s66 offen offset:3072 sc1
    v_cvt_pk_bf16_f32 v92, v80, v81
    v_cvt_pk_bf16_f32 v93, v82, v83
    v_exp_f32 v84, v60
    v_exp_f32 v85, v61
    v_exp_f32 v86, v62
    v_exp_f32 v87, v63
    v_mfma_f32_32x32x16_bf16 v[48:63], a[64:67], v[32:35], 0
    s_add_u32 s77, s77, 0x4000
    v_cvt_pk_bf16_f32 v94, v84, v85
    v_cvt_pk_bf16_f32 v95, v86, v87
    v_exp_f32 v80, v64
    v_exp_f32 v81, v65
    v_exp_f32 v82, v66
    v_exp_f32 v83, v67
    v_mfma_f32_32x32x16_bf16 v[48:63], a[68:71], v[36:39], v[48:63]
    s_and_b32 s77, s77, 0x3ffff
    v_cvt_pk_bf16_f32 v88, v80, v81
    v_cvt_pk_bf16_f32 v89, v82, v83
    v_exp_f32 v84, v68
    v_exp_f32 v85, v69
    v_exp_f32 v86, v70
    v_exp_f32 v87, v71
    v_mfma_f32_32x32x16_bf16 v[160:175], a[76:79], v[92:95], v[160:175]
    s_add_u32 s66, s77, s78
    v_cvt_pk_bf16_f32 v90, v84, v85
    v_cvt_pk_bf16_f32 v91, v86, v87
    v_exp_f32 v80, v72
    v_exp_f32 v81, v73
    v_exp_f32 v82, v74
    v_exp_f32 v83, v75
    v_mfma_f32_32x32x16_bf16 a[16:31], a[72:75], v[88:91], a[16:31]
    global_load_dword v198, v246, s[20:21]
    v_cvt_pk_bf16_f32 v92, v80, v81
    v_cvt_pk_bf16_f32 v93, v82, v83
    v_exp_f32 v84, v76
    v_exp_f32 v85, v77
    v_exp_f32 v86, v78
    v_exp_f32 v87, v79
    v_mfma_f32_32x32x16_bf16 v[64:79], a[64:67], v[40:43], 0
    buffer_load_dword v198, v196, s[4:7], s71 offen sc1
    v_cvt_pk_bf16_f32 v94, v84, v85
    v_cvt_pk_bf16_f32 v95, v86, v87
    v_exp_f32 v80, v48
    v_exp_f32 v81, v49
    v_exp_f32 v82, v50
    v_exp_f32 v83, v51
    v_mfma_f32_32x32x16_bf16 v[64:79], a[68:71], v[44:47], v[64:79]
    s_add_u32 s71, s71, 384
    v_cvt_pk_bf16_f32 v88, v80, v81
    v_cvt_pk_bf16_f32 v89, v82, v83
    v_exp_f32 v84, v52
    v_exp_f32 v85, v53
    v_exp_f32 v86, v54
    v_exp_f32 v87, v55
    v_mfma_f32_32x32x16_bf16 a[16:31], a[76:79], v[92:95], a[16:31]
    v_cvt_pk_bf16_f32 v90, v84, v85
    v_cvt_pk_bf16_f32 v91, v86, v87
    v_exp_f32 v80, v56
    v_exp_f32 v81, v57
    v_exp_f32 v82, v58
    v_exp_f32 v83, v59
    v_mfma_f32_32x32x16_bf16 a[32:47], a[72:75], v[88:91], a[32:47]
    s_waitcnt vmcnt(11)
    v_cvt_pk_bf16_f32 v92, v80, v81
    v_cvt_pk_bf16_f32 v93, v82, v83
    v_exp_f32 v84, v60
    v_exp_f32 v85, v61
    v_exp_f32 v86, v62
    v_exp_f32 v87, v63
    v_mfma_f32_32x32x16_bf16 v[48:63], a[80:83], v[16:19], 0
    v_cvt_pk_bf16_f32 v94, v84, v85
    v_cvt_pk_bf16_f32 v95, v86, v87
    v_exp_f32 v80, v64
    v_exp_f32 v81, v65
    v_exp_f32 v82, v66
    v_exp_f32 v83, v67
    v_mfma_f32_32x32x16_bf16 v[48:63], a[84:87], v[20:23], v[48:63]
    v_cvt_pk_bf16_f32 v88, v80, v81
    v_cvt_pk_bf16_f32 v89, v82, v83
    v_exp_f32 v84, v68
    v_exp_f32 v85, v69
    v_exp_f32 v86, v70
    v_exp_f32 v87, v71
    v_mfma_f32_32x32x16_bf16 a[32:47], a[76:79], v[92:95], a[32:47]
    v_cvt_pk_bf16_f32 v90, v84, v85
    v_cvt_pk_bf16_f32 v91, v86, v87
    v_exp_f32 v80, v72
    v_exp_f32 v81, v73
    v_exp_f32 v82, v74
    v_exp_f32 v83, v75
    v_mfma_f32_32x32x16_bf16 a[48:63], a[72:75], v[88:91], a[48:63]
    v_cvt_pk_bf16_f32 v92, v80, v81
    v_cvt_pk_bf16_f32 v93, v82, v83
    v_exp_f32 v84, v76
    v_exp_f32 v85, v77
    v_exp_f32 v86, v78
    v_exp_f32 v87, v79
    v_mfma_f32_32x32x16_bf16 v[64:79], a[80:83], v[24:27], 0
    buffer_load_dwordx4 a[64:67], v1, s[4:7], s66 offen offset:0 sc1
    v_cvt_pk_bf16_f32 v94, v84, v85
    v_cvt_pk_bf16_f32 v95, v86, v87
    v_exp_f32 v80, v48
    v_exp_f32 v81, v49
    v_exp_f32 v82, v50
    v_exp_f32 v83, v51
    v_mfma_f32_32x32x16_bf16 v[64:79], a[84:87], v[28:31], v[64:79]
    buffer_load_dwordx4 a[68:71], v1, s[4:7], s66 offen offset:1024 sc1
    v_cvt_pk_bf16_f32 v88, v80, v81
    v_cvt_pk_bf16_f32 v89, v82, v83
    v_exp_f32 v84, v52
    v_exp_f32 v85, v53
    v_exp_f32 v86, v54
    v_exp_f32 v87, v55
    v_mfma_f32_32x32x16_bf16 a[48:63], a[76:79], v[92:95], a[48:63]
    buffer_load_dwordx4 a[72:75], v1, s[4:7], s66 offen offset:2048 sc1
    v_cvt_pk_bf16_f32 v90, v84, v85
    v_cvt_pk_bf16_f32 v91, v86, v87
    v_exp_f32 v80, v56
    v_exp_f32 v81, v57
    v_exp_f32 v82, v58
    v_exp_f32 v83, v59
    v_mfma_f32_32x32x16_bf16 v[160:175], a[88:91], v[88:91], v[160:175]
    buffer_load_dwordx4 a[76:79], v1, s[4:7], s66 offen offset:3072 sc1
    v_cvt_pk_bf16_f32 v92, v80, v81
    v_cvt_pk_bf16_f32 v93, v82, v83
    v_exp_f32 v84, v60
    v_exp_f32 v85, v61
    v_exp_f32 v86, v62
    v_exp_f32 v87, v63
    v_mfma_f32_32x32x16_bf16 v[48:63], a[80:83], v[32:35], 0
    s_add_u32 s77, s77, 0x4000
    v_cvt_pk_bf16_f32 v94, v84, v85
    v_cvt_pk_bf16_f32 v95, v86, v87
    v_exp_f32 v80, v64
    v_exp_f32 v81, v65
    v_exp_f32 v82, v66
    v_exp_f32 v83, v67
    v_mfma_f32_32x32x16_bf16 v[48:63], a[84:87], v[36:39], v[48:63]
    s_and_b32 s77, s77, 0x3ffff
    v_cvt_pk_bf16_f32 v88, v80, v81
    v_cvt_pk_bf16_f32 v89, v82, v83
    v_exp_f32 v84, v68
    v_exp_f32 v85, v69
    v_exp_f32 v86, v70
    v_exp_f32 v87, v71
    v_mfma_f32_32x32x16_bf16 v[160:175], a[92:95], v[92:95], v[160:175]
    s_add_u32 s66, s77, s78
    v_cvt_pk_bf16_f32 v90, v84, v85
    v_cvt_pk_bf16_f32 v91, v86, v87
    v_exp_f32 v80, v72
    v_exp_f32 v81, v73
    v_exp_f32 v82, v74
    v_exp_f32 v83, v75
    v_mfma_f32_32x32x16_bf16 a[16:31], a[88:91], v[88:91], a[16:31]
    global_load_dword v198, v246, s[24:25]
    v_cvt_pk_bf16_f32 v92, v80, v81
    v_cvt_pk_bf16_f32 v93, v82, v83
    v_exp_f32 v84, v76
    v_exp_f32 v85, v77
    v_exp_f32 v86, v78
    v_exp_f32 v87, v79
    v_mfma_f32_32x32x16_bf16 v[64:79], a[80:83], v[40:43], 0
    buffer_load_dword v198, v196, s[4:7], s71 offen sc1
    v_cvt_pk_bf16_f32 v94, v84, v85
    v_cvt_pk_bf16_f32 v95, v86, v87
    v_exp_f32 v80, v48
    v_exp_f32 v81, v49
    v_exp_f32 v82, v50
    v_exp_f32 v83, v51
    v_mfma_f32_32x32x16_bf16 v[64:79], a[84:87], v[44:47], v[64:79]
    s_add_u32 s71, s71, 384
    v_cvt_pk_bf16_f32 v88, v80, v81
    v_cvt_pk_bf16_f32 v89, v82, v83
    v_exp_f32 v84, v52
    v_exp_f32 v85, v53
    v_exp_f32 v86, v54
    v_exp_f32 v87, v55
    v_mfma_f32_32x32x16_bf16 a[16:31], a[92:95], v[92:95], a[16:31]
    global_load_dword v198, v246, s[26:27]
    v_cvt_pk_bf16_f32 v90, v84, v85
    v_cvt_pk_bf16_f32 v91, v86, v87
    v_exp_f32 v80, v56
    v_exp_f32 v81, v57
    v_exp_f32 v82, v58
    v_exp_f32 v83, v59
    v_mfma_f32_32x32x16_bf16 a[32:47], a[88:91], v[88:91], a[32:47]
    s_waitcnt vmcnt(14)
    v_cvt_pk_bf16_f32 v92, v80, v81
    v_cvt_pk_bf16_f32 v93, v82, v83
    v_exp_f32 v84, v60
    v_exp_f32 v85, v61
    v_exp_f32 v86, v62
    v_exp_f32 v87, v63
    v_mfma_f32_32x32x16_bf16 v[48:63], a[96:99], v[16:19], 0
    v_cvt_pk_bf16_f32 v94, v84, v85
    v_cvt_pk_bf16_f32 v95, v86, v87
    v_exp_f32 v80, v64
    v_exp_f32 v81, v65
    v_exp_f32 v82, v66
    v_exp_f32 v83, v67
    v_mfma_f32_32x32x16_bf16 v[48:63], a[100:103], v[20:23], v[48:63]
    v_cvt_pk_bf16_f32 v88, v80, v81
    v_cvt_pk_bf16_f32 v89, v82, v83
    v_exp_f32 v84, v68
    v_exp_f32 v85, v69
    v_exp_f32 v86, v70
    v_exp_f32 v87, v71
    v_mfma_f32_32x32x16_bf16 a[32:47], a[92:95], v[92:95], a[32:47]
    v_cvt_pk_bf16_f32 v90, v84, v85
    v_cvt_pk_bf16_f32 v91, v86, v87
    v_exp_f32 v80, v72
    v_exp_f32 v81, v73
    v_exp_f32 v82, v74
    v_exp_f32 v83, v75
    v_mfma_f32_32x32x16_bf16 a[48:63], a[88:91], v[88:91], a[48:63]
    v_cvt_pk_bf16_f32 v92, v80, v81
    v_cvt_pk_bf16_f32 v93, v82, v83
    v_exp_f32 v84, v76
    v_exp_f32 v85, v77
    v_exp_f32 v86, v78
    v_exp_f32 v87, v79
    v_mfma_f32_32x32x16_bf16 v[64:79], a[96:99], v[24:27], 0
    buffer_load_dwordx4 a[80:83], v1, s[4:7], s66 offen offset:0 sc1
    v_cvt_pk_bf16_f32 v94, v84, v85
    v_cvt_pk_bf16_f32 v95, v86, v87
    v_exp_f32 v80, v48
    v_exp_f32 v81, v49
    v_exp_f32 v82, v50
    v_exp_f32 v83, v51
    v_mfma_f32_32x32x16_bf16 v[64:79], a[100:103], v[28:31], v[64:79]
    buffer_load_dwordx4 a[84:87], v1, s[4:7], s66 offen offset:1024 sc1
    v_cvt_pk_bf16_f32 v88, v80, v81
    v_cvt_pk_bf16_f32 v89, v82, v83
    v_exp_f32 v84, v52
    v_exp_f32 v85, v53
    v_exp_f32 v86, v54
    v_exp_f32 v87, v55
    v_mfma_f32_32x32x16_bf16 a[48:63], a[92:95], v[92:95], a[48:63]
    buffer_load_dwordx4 a[88:91], v1, s[4:7], s66 offen offset:2048 sc1
    v_cvt_pk_bf16_f32 v90, v84, v85
    v_cvt_pk_bf16_f32 v91, v86, v87
    v_exp_f32 v80, v56
    v_exp_f32 v81, v57
    v_exp_f32 v82, v58
    v_exp_f32 v83, v59
    v_mfma_f32_32x32x16_bf16 v[160:175], a[104:107], v[88:91], v[160:175]
    buffer_load_dwordx4 a[92:95], v1, s[4:7], s66 offen offset:3072 sc1
    v_cvt_pk_bf16_f32 v92, v80, v81
    v_cvt_pk_bf16_f32 v93, v82, v83
    v_exp_f32 v84, v60
    v_exp_f32 v85, v61
    v_exp_f32 v86, v62
    v_exp_f32 v87, v63
    v_mfma_f32_32x32x16_bf16 v[48:63], a[96:99], v[32:35], 0
    s_add_u32 s77, s77, 0x4000
    v_cvt_pk_bf16_f32 v94, v84, v85
    v_cvt_pk_bf16_f32 v95, v86, v87
    v_exp_f32 v80, v64
    v_exp_f32 v81, v65
    v_exp_f32 v82, v66
    v_exp_f32 v83, v67
    v_mfma_f32_32x32x16_bf16 v[48:63], a[100:103], v[36:39], v[48:63]
    s_and_b32 s77, s77, 0x3ffff
    v_cvt_pk_bf16_f32 v88, v80, v81
    v_cvt_pk_bf16_f32 v89, v82, v83
    v_exp_f32 v84, v68
    v_exp_f32 v85, v69
    v_exp_f32 v86, v70
    v_exp_f32 v87, v71
    v_mfma_f32_32x32x16_bf16 v[160:175], a[108:111], v[92:95], v[160:175]
    s_add_u32 s66, s77, s78
    v_cvt_pk_bf16_f32 v90, v84, v85
    v_cvt_pk_bf16_f32 v91, v86, v87
    v_exp_f32 v80, v72
    v_exp_f32 v81, v73
    v_exp_f32 v82, v74
    v_exp_f32 v83, v75
    v_mfma_f32_32x32x16_bf16 a[16:31], a[104:107], v[88:91], a[16:31]
    global_load_dword v198, v247, s[28:29]
    v_cvt_pk_bf16_f32 v92, v80, v81
    v_cvt_pk_bf16_f32 v93, v82, v83
    v_exp_f32 v84, v76
    v_exp_f32 v85, v77
    v_exp_f32 v86, v78
    v_exp_f32 v87, v79
    v_mfma_f32_32x32x16_bf16 v[64:79], a[96:99], v[40:43], 0
    buffer_load_dword v198, v196, s[4:7], s71 offen sc1
    v_cvt_pk_bf16_f32 v94, v84, v85
    v_cvt_pk_bf16_f32 v95, v86, v87
    v_exp_f32 v80, v48
    v_exp_f32 v81, v49
    v_exp_f32 v82, v50
    v_exp_f32 v83, v51
    v_mfma_f32_32x32x16_bf16 v[64:79], a[100:103], v[44:47], v[64:79]
    s_add_u32 s71, s71, 384
    v_cvt_pk_bf16_f32 v88, v80, v81
    v_cvt_pk_bf16_f32 v89, v82, v83
    v_exp_f32 v84, v52
    v_exp_f32 v85, v53
    v_exp_f32 v86, v54
    v_exp_f32 v87, v55
    v_mfma_f32_32x32x16_bf16 a[16:31], a[108:111], v[92:95], a[16:31]
    v_cvt_pk_bf16_f32 v90, v84, v85
    v_cvt_pk_bf16_f32 v91, v86, v87
    v_exp_f32 v80, v56
    v_exp_f32 v81, v57
    v_exp_f32 v82, v58
    v_exp_f32 v83, v59
    v_mfma_f32_32x32x16_bf16 a[32:47], a[104:107], v[88:91], a[32:47]
    s_waitcnt vmcnt(15)
    v_cvt_pk_bf16_f32 v92, v80, v81
    v_cvt_pk_bf16_f32 v93, v82, v83
    v_exp_f32 v84, v60
    v_exp_f32 v85, v61
    v_exp_f32 v86, v62
    v_exp_f32 v87, v63
    v_mfma_f32_32x32x16_bf16 v[48:63], a[112:115], v[16:19], 0
    v_cvt_pk_bf16_f32 v94, v84, v85
    v_cvt_pk_bf16_f32 v95, v86, v87
    v_exp_f32 v80, v64
    v_exp_f32 v81, v65
    v_exp_f32 v82, v66
    v_exp_f32 v83, v67
    v_mfma_f32_32x32x16_bf16 v[48:63], a[116:119], v[20:23], v[48:63]
    v_cvt_pk_bf16_f32 v88, v80, v81
    v_cvt_pk_bf16_f32 v89, v82, v83
    v_exp_f32 v84, v68
    v_exp_f32 v85, v69
    v_exp_f32 v86, v70
    v_exp_f32 v87, v71
    v_mfma_f32_32x32x16_bf16 a[32:47], a[108:111], v[92:95], a[32:47]
    v_cvt_pk_bf16_f32 v90, v84, v85
    v_cvt_pk_bf16_f32 v91, v86, v87
    v_exp_f32 v80, v72
    v_exp_f32 v81, v73
    v_exp_f32 v82, v74
    v_exp_f32 v83, v75
    v_mfma_f32_32x32x16_bf16 a[48:63], a[104:107], v[88:91], a[48:63]
    v_cvt_pk_bf16_f32 v92, v80, v81
    v_cvt_pk_bf16_f32 v93, v82, v83
    v_exp_f32 v84, v76
    v_exp_f32 v85, v77
    v_exp_f32 v86, v78
    v_exp_f32 v87, v79
    v_mfma_f32_32x32x16_bf16 v[64:79], a[112:115], v[24:27], 0
    buffer_load_dwordx4 a[96:99], v1, s[4:7], s66 offen offset:0 sc1
    v_cvt_pk_bf16_f32 v94, v84, v85
    v_cvt_pk_bf16_f32 v95, v86, v87
    v_exp_f32 v80, v48
    v_exp_f32 v81, v49
    v_exp_f32 v82, v50
    v_exp_f32 v83, v51
    v_mfma_f32_32x32x16_bf16 v[64:79], a[116:119], v[28:31], v[64:79]
    buffer_load_dwordx4 a[100:103], v1, s[4:7], s66 offen offset:1024 sc1
    v_cvt_pk_bf16_f32 v88, v80, v81
    v_cvt_pk_bf16_f32 v89, v82, v83
    v_exp_f32 v84, v52
    v_exp_f32 v85, v53
    v_exp_f32 v86, v54
    v_exp_f32 v87, v55
    v_mfma_f32_32x32x16_bf16 a[48:63], a[108:111], v[92:95], a[48:63]
    buffer_load_dwordx4 a[104:107], v1, s[4:7], s66 offen offset:2048 sc1
    v_cvt_pk_bf16_f32 v90, v84, v85
    v_cvt_pk_bf16_f32 v91, v86, v87
    v_exp_f32 v80, v56
    v_exp_f32 v81, v57
    v_exp_f32 v82, v58
    v_exp_f32 v83, v59
    v_mfma_f32_32x32x16_bf16 v[160:175], a[120:123], v[88:91], v[160:175]
    buffer_load_dwordx4 a[108:111], v1, s[4:7], s66 offen offset:3072 sc1
    v_cvt_pk_bf16_f32 v92, v80, v81
    v_cvt_pk_bf16_f32 v93, v82, v83
    v_exp_f32 v84, v60
    v_exp_f32 v85, v61
    v_exp_f32 v86, v62
    v_exp_f32 v87, v63
    v_mfma_f32_32x32x16_bf16 v[48:63], a[112:115], v[32:35], 0
    s_add_u32 s77, s77, 0x4000
    v_cvt_pk_bf16_f32 v94, v84, v85
    v_cvt_pk_bf16_f32 v95, v86, v87
    v_exp_f32 v80, v64
    v_exp_f32 v81, v65
    v_exp_f32 v82, v66
    v_exp_f32 v83, v67
    v_mfma_f32_32x32x16_bf16 v[48:63], a[116:119], v[36:39], v[48:63]
    s_and_b32 s77, s77, 0x3ffff
    v_cvt_pk_bf16_f32 v88, v80, v81
    v_cvt_pk_bf16_f32 v89, v82, v83
    v_exp_f32 v84, v68
    v_exp_f32 v85, v69
    v_exp_f32 v86, v70
    v_exp_f32 v87, v71
    v_mfma_f32_32x32x16_bf16 v[160:175], a[124:127], v[92:95], v[160:175]
    s_add_u32 s66, s77, s78
    v_cvt_pk_bf16_f32 v90, v84, v85
    v_cvt_pk_bf16_f32 v91, v86, v87
    v_exp_f32 v80, v72
    v_exp_f32 v81, v73
    v_exp_f32 v82, v74
    v_exp_f32 v83, v75
    v_mfma_f32_32x32x16_bf16 a[16:31], a[120:123], v[88:91], a[16:31]
    global_load_dword v198, v247, s[30:31]
    v_cvt_pk_bf16_f32 v92, v80, v81
    v_cvt_pk_bf16_f32 v93, v82, v83
    v_exp_f32 v84, v76
    v_exp_f32 v85, v77
    v_exp_f32 v86, v78
    v_exp_f32 v87, v79
    v_mfma_f32_32x32x16_bf16 v[64:79], a[112:115], v[40:43], 0
    buffer_load_dword v198, v196, s[4:7], s71 offen sc1
    v_cvt_pk_bf16_f32 v94, v84, v85
    v_cvt_pk_bf16_f32 v95, v86, v87
    v_exp_f32 v80, v48
    v_exp_f32 v81, v49
    v_exp_f32 v82, v50
    v_exp_f32 v83, v51
    v_mfma_f32_32x32x16_bf16 v[64:79], a[116:119], v[44:47], v[64:79]
    s_add_u32 s71, s71, 384
    v_cvt_pk_bf16_f32 v88, v80, v81
    v_cvt_pk_bf16_f32 v89, v82, v83
    v_exp_f32 v84, v52
    v_exp_f32 v85, v53
    v_exp_f32 v86, v54
    v_exp_f32 v87, v55
    v_mfma_f32_32x32x16_bf16 a[16:31], a[124:127], v[92:95], a[16:31]
    v_add_u32 v246, 128, v246
    v_add_u32 v247, 128, v247
    v_cvt_pk_bf16_f32 v90, v84, v85
    v_cvt_pk_bf16_f32 v91, v86, v87
    v_exp_f32 v80, v56
    v_exp_f32 v81, v57
    v_exp_f32 v82, v58
    v_exp_f32 v83, v59
    v_mfma_f32_32x32x16_bf16 a[32:47], a[120:123], v[88:91], a[32:47]
    s_waitcnt vmcnt(15)
    v_cvt_pk_bf16_f32 v92, v80, v81
    v_cvt_pk_bf16_f32 v93, v82, v83
    v_exp_f32 v84, v60
    v_exp_f32 v85, v61
    v_exp_f32 v86, v62
    v_exp_f32 v87, v63
    v_mfma_f32_32x32x16_bf16 v[48:63], a[64:67], v[16:19], 0
    v_cvt_pk_bf16_f32 v94, v84, v85
    v_cvt_pk_bf16_f32 v95, v86, v87
    v_exp_f32 v80, v64
    v_exp_f32 v81, v65
    v_exp_f32 v82, v66
    v_exp_f32 v83, v67
    v_mfma_f32_32x32x16_bf16 v[48:63], a[68:71], v[20:23], v[48:63]
    v_cvt_pk_bf16_f32 v88, v80, v81
    v_cvt_pk_bf16_f32 v89, v82, v83
    v_exp_f32 v84, v68
    v_exp_f32 v85, v69
    v_exp_f32 v86, v70
    v_exp_f32 v87, v71
    v_mfma_f32_32x32x16_bf16 a[32:47], a[124:127], v[92:95], a[32:47]
    s_add_u32 s79, s79, 1
    v_cvt_pk_bf16_f32 v90, v84, v85
    v_cvt_pk_bf16_f32 v91, v86, v87
    v_exp_f32 v80, v72
    v_exp_f32 v81, v73
    v_exp_f32 v82, v74
    v_exp_f32 v83, v75
    v_mfma_f32_32x32x16_bf16 a[48:63], a[120:123], v[88:91], a[48:63]
    s_cmp_lt_u32 s79, 3
    v_cvt_pk_bf16_f32 v92, v80, v81
    v_cvt_pk_bf16_f32 v93, v82, v83
    v_exp_f32 v84, v76
    v_exp_f32 v85, v77
    v_exp_f32 v86, v78
    v_exp_f32 v87, v79
    s_cbranch_scc1 L_attn_loop0
    s_branch L_attn_tail
L_mode_loop:
    s_add_u32 s22, s3, 32
    s_mov_b32 s74, 0
    s_waitcnt vmcnt(31)
L_ml_66:
    v_subrev_u32 v202, s22, v202
    v_cmp_lt_u32 vcc, 7, v202
    s_cmp_eq_u64 vcc, 0
    s_cbranch_scc1 L_ml_67
    buffer_load_dword v202, v10, s[4:7], s89 offen sc1
    s_add_u32 s74, s74, 1
    s_cmp_lt_u32 s74, 200000
    s_waitcnt vmcnt(0)
    s_cbranch_scc1 L_ml_66
L_ml_67:
    v_readfirstlane_b32 s61, v202
    s_nop 1
    v_cmp_ne_u32 vcc, s61, v202
    s_mov_b32 s48, vcc_lo
    s_branch L_mode_ok
L_attn_ovf:
    s_cmp_lg_u32 s75, 1
    s_cbranch_scc1 L_attn_ok
    s_mov_b32 s75, 16
    s_mov_b32 exec_lo, 0
    v_mov_b32 v22, 0
    v_mov_b32 v30, 0
    v_mov_b32 v38, 0
    v_mov_b32 v46, 0
    s_mov_b32 exec_lo, -1
    s_waitcnt vmcnt(0) lgkmcnt(0)
    s_barrier
    s_branch L_attn_retry
L_xr0_13:
    v_permlane32_swap_b32 v248, v250
    v_permlane32_swap_b32 v249, v251
    v_permlane32_swap_b32 v252, v254
    v_permlane32_swap_b32 v253, v255
    v_lshlrev_b32 v16, 16, v248
    v_and_b32 v17, 0xffff0000, v248
    v_lshlrev_b32 v18, 16, v249
    v_and_b32 v19, 0xffff0000, v249
    v_lshlrev_b32 v20, 16, v250
    v_and_b32 v21, 0xffff0000, v250
    v_lshlrev_b32 v22, 16, v251
    v_and_b32 v23, 0xffff0000, v251
    v_lshlrev_b32 v24, 16, v252
    v_and_b32 v25, 0xffff0000, v252
    v_lshlrev_b32 v26, 16, v253
    v_and_b32 v27, 0xffff0000, v253
    v_lshlrev_b32 v28, 16, v254
    v_and_b32 v29, 0xffff0000, v254
    v_lshlrev_b32 v30, 16, v255
    v_and_b32 v31, 0xffff0000, v255
    s_lshl_b32 s60, s51, 9
    s_add_u32 s60, s60, 57344
    v_add_u32 v6, s60, v2
    v_mov_b32 v5, 0x3f803f80
    v_accvgpr_write_b32 a184, v5
    v_accvgpr_write_b32 a185, v5
    v_accvgpr_write_b32 a186, v5
    v_accvgpr_write_b32 a187, v5
    ds_read_b64_tr_b16 a[168:169], v6 offset:0
    ds_read_b64_tr_b16 a[170:171], v6 offset:1024
    buffer_load_dwordx4 v176, s[8:11], s70 offen offset:0 lds
    ds_read_b64_tr_b16 a[172:173], v6 offset:2048
    ds_read_b64_tr_b16 a[174:175], v6 offset:3072
    ds_read_b64_tr_b16 a[176:177], v6 offset:4096
    ds_read_b64_tr_b16 a[178:179], v6 offset:5120
    buffer_load_dwordx4 v177, s[8:11], s70 offen offset:1024 lds
    ds_read_b64_tr_b16 a[180:181], v6 offset:6144
    ds_read_b64_tr_b16 a[182:183], v6 offset:7168
    s_waitcnt lgkmcnt(6)
    v_mfma_f32_32x32x16_bf16 a[216:231], a[168:171], a[184:187], 0
    ds_read_b64_tr_b16 a[168:169], v6 offset:8192
    ds_read_b64_tr_b16 a[170:171], v6 offset:9216
    s_waitcnt lgkmcnt(6)
    v_mfma_f32_32x32x16_bf16 a[216:231], a[172:175], a[184:187], a[216:231]
    buffer_load_dwordx4 v178, s[8:11], s70 offen offset:2048 lds
    ds_read_b64_tr_b16 a[172:173], v6 offset:10240
    ds_read_b64_tr_b16 a[174:175], v6 offset:11264
    s_waitcnt lgkmcnt(6)
    v_mfma_f32_32x32x16_bf16 a[216:231], a[176:179], a[184:187], a[216:231]
    ds_read_b64_tr_b16 a[176:177], v6 offset:12288
    ds_read_b64_tr_b16 a[178:179], v6 offset:13312
    s_waitcnt lgkmcnt(6)
    v_mfma_f32_32x32x16_bf16 a[216:231], a[180:183], a[184:187], a[216:231]
    buffer_load_dwordx4 v179, s[8:11], s70 offen offset:3072 lds
    ds_read_b64_tr_b16 a[180:181], v6 offset:14336
    ds_read_b64_tr_b16 a[182:183], v6 offset:15360
    s_waitcnt lgkmcnt(6)
    v_mfma_f32_32x32x16_bf16 a[216:231], a[168:171], a[184:187], a[216:231]
    ds_read_b64_tr_b16 a[168:169], v6 offset:16384
    ds_read_b64_tr_b16 a[170:171], v6 offset:17408
    s_waitcnt lgkmcnt(6)
    v_mfma_f32_32x32x16_bf16 a[216:231], a[172:175], a[184:187], a[216:231]
    s_add_u32 m0, m0, 4096
    s_add_u32 s70, s70, 28672
    buffer_load_dwordx4 v176, s[8:11], s70 offen offset:0 lds
    ds_read_b64_tr_b16 a[172:173], v6 offset:18432
    ds_read_b64_tr_b16 a[174:175], v6 offset:19456
    s_waitcnt lgkmcnt(6)
    v_mfma_f32_32x32x16_bf16 a[216:231], a[176:179], a[184:187], a[216:231]
    ds_read_b64_tr_b16 a[176:177], v6 offset:20480
    ds_read_b64_tr_b16 a[178:179], v6 offset:21504
    s_waitcnt lgkmcnt(6)
    v_mfma_f32_32x32x16_bf16 a[216:231], a[180:183], a[184:187], a[216:231]
    buffer_load_dwordx4 v177, s[8:11], s70 offen offset:1024 lds
    ds_read_b64_tr_b16 a[180:181], v6 offset:22528
    ds_read_b64_tr_b16 a[182:183], v6 offset:23552
    s_waitcnt lgkmcnt(6)
    v_mfma_f32_32x32x16_bf16 a[216:231], a[168:171], a[184:187], a[216:231]
    ds_read_b64_tr_b16 a[168:169], v6 offset:24576
    ds_read_b64_tr_b16 a[170:171], v6 offset:25600
    s_waitcnt lgkmcnt(6)
    v_mfma_f32_32x32x16_bf16 a[216:231], a[172:175], a[184:187], a[216:231]
    buffer_load_dwordx4 v178, s[8:11], s70 offen offset:2048 lds
    ds_read_b64_tr_b16 a[172:173], v6 offset:26624
    ds_read_b64_tr_b16 a[174:175], v6 offset:27648
    s_waitcnt lgkmcnt(6)
    v_mfma_f32_32x32x16_bf16 a[216:231], a[176:179], a[184:187], a[216:231]
    ds_read_b64_tr_b16 a[176:177], v6 offset:28672
    ds_read_b64_tr_b16 a[178:179], v6 offset:29696
    s_waitcnt lgkmcnt(6)
    v_mfma_f32_32x32x16_bf16 a[216:231], a[180:183], a[184:187], a[216:231]
    buffer_load_dwordx4 v179, s[8:11], s70 offen offset:3072 lds
    ds_read_b64_tr_b16 a[180:181], v6 offset:30720
    ds_read_b64_tr_b16 a[182:183], v6 offset:31744
    s_waitcnt lgkmcnt(6)
    v_mfma_f32_32x32x16_bf16 a[216:231], a[168:171], a[184:187], a[216:231]
    ds_read_b64_tr_b16 a[168:169], v6 offset:32768
    ds_read_b64_tr_b16 a[170:171], v6 offset:33792
    s_waitcnt lgkmcnt(6)
    v_mfma_f32_32x32x16_bf16 a[216:231], a[172:175], a[184:187], a[216:231]
    s_add_u32 m0, m0, 4096
    s_add_u32 s70, s70, 28672
    buffer_load_dwordx4 v176, s[8:11], s70 offen offset:0 lds
    ds_read_b64_tr_b16 a[172:173], v6 offset:34816
    ds_read_b64_tr_b16 a[174:175], v6 offset:35840
    s_waitcnt lgkmcnt(6)
    v_mfma_f32_32x32x16_bf16 a[216:231], a[176:179], a[184:187], a[216:231]
    ds_read_b64_tr_b16 a[176:177], v6 offset:36864
    ds_read_b64_tr_b16 a[178:179], v6 offset:37888
    s_waitcnt lgkmcnt(6)
    v_mfma_f32_32x32x16_bf16 a[216:231], a[180:183], a[184:187], a[216:231]
    buffer_load_dwordx4 v177, s[8:11], s70 offen offset:1024 lds
    ds_read_b64_tr_b16 a[180:181], v6 offset:38912
    ds_read_b64_tr_b16 a[182:183], v6 offset:39936
    s_waitcnt lgkmcnt(6)
    v_mfma_f32_32x32x16_bf16 a[216:231], a[168:171], a[184:187], a[216:231]
    ds_read_b64_tr_b16 a[168:169], v6 offset:40960
    ds_read_b64_tr_b16 a[170:171], v6 offset:41984
    s_waitcnt lgkmcnt(6)
    v_mfma_f32_32x32x16_bf16 a[216:231], a[172:175], a[184:187], a[216:231]
    ds_read_b64_tr_b16 a[172:173], v6 offset:43008
    ds_read_b64_tr_b16 a[174:175], v6 offset:44032
    s_waitcnt lgkmcnt(6)
    v_mfma_f32_32x32x16_bf16 a[216:231], a[176:179], a[184:187], a[216:231]
    ds_read_b64_tr_b16 a[176:177], v6 offset:45056
    ds_read_b64_tr_b16 a[178:179], v6 offset:46080
    s_waitcnt lgkmcnt(6)
    v_mfma_f32_32x32x16_bf16 a[216:231], a[180:183], a[184:187], a[216:231]
    ds_read_b64_tr_b16 a[180:181], v6 offset:47104
    ds_read_b64_tr_b16 a[182:183], v6 offset:48128
    s_waitcnt lgkmcnt(6)
    v_mfma_f32_32x32x16_bf16 a[216:231], a[168:171], a[184:187], a[216:231]
    ds_read_b64_tr_b16 a[168:169], v6 offset:49152
    ds_read_b64_tr_b16 a[170:171], v6 offset:50176
    s_waitcnt lgkmcnt(6)
    v_mfma_f32_32x32x16_bf16 a[216:231], a[172:175], a[184:187], a[216:231]
    ds_read_b64_tr_b16 a[172:173], v6 offset:51200
    ds_read_b64_tr_b16 a[174:175], v6 offset:52224
    s_waitcnt lgkmcnt(6)
    v_mfma_f32_32x32x16_bf16 a[216:231], a[176:179], a[184:187], a[216:231]
    ds_read_b64_tr_b16 a[176:177], v6 offset:53248
    ds_read_b64_tr_b16 a[178:179], v6 offset:54272
    s_waitcnt lgkmcnt(6)
    v_mfma_f32_32x32x16_bf16 a[216:231], a[180:183], a[184:187], a[216:231]
    ds_read_b64_tr_b16 a[180:181], v6 offset:55296
    ds_read_b64_tr_b16 a[182:183], v6 offset:56320
    s_waitcnt lgkmcnt(6)
    v_mfma_f32_32x32x16_bf16 a[216:231], a[168:171], a[184:187], a[216:231]
    s_waitcnt lgkmcnt(4)
    v_mfma_f32_32x32x16_bf16 a[216:231], a[172:175], a[184:187], a[216:231]
    s_waitcnt lgkmcnt(2)
    v_mfma_f32_32x32x16_bf16 a[216:231], a[176:179], a[184:187], a[216:231]
    s_waitcnt lgkmcnt(0)
    v_mfma_f32_32x32x16_bf16 a[216:231], a[180:183], a[184:187], a[216:231]
    s_branch L_xr2_14
L_cs0_39:
    s_and_b32 s61, s41, 1
    s_lshl_b32 s61, s61, 9
    s_mov_b32 s62, 135168
    s_cmp_lt_u32 s41, 2
    s_cselect_b32 s62, 57344, s62
    s_cselect_b32 s63, 86016, 0
    s_add_u32 s62, s62, s61
    s_add_u32 s63, s63, s61
    v_lshrrev_b32 v5, 4, v0
    v_lshlrev_b32 v6, 10, v5
    v_bfe_u32 v5, v0, 2, 2
    v_lshl_add_u32 v6, v5, 6, v6
    v_and_b32 v5, 3, v0
    v_lshl_add_u32 v6, v5, 3, v6
    v_add_u32 v7, s63, v6
    v_add_u32 v6, s62, v6
    v_mov_b32 v5, 0x3f803f80
    v_accvgpr_write_b32 a176, v5
    v_accvgpr_write_b32 a177, v5
    v_accvgpr_write_b32 a178, v5
    v_accvgpr_write_b32 a179, v5
    ds_read_b64_tr_b16 a[128:129], v6 offset:0
    ds_read_b64_tr_b16 a[130:131], v6 offset:256
    ds_read_b64_tr_b16 a[132:133], v6 offset:32
    ds_read_b64_tr_b16 a[134:135], v6 offset:288
    s_add_u32 m0, s92, 28672
    s_add_u32 s70, s91, 0
    buffer_load_dwordx4 v176, s[8:11], s70 offen offset:0 lds
    ds_read_b64_tr_b16 a[136:137], v6 offset:4096
    ds_read_b64_tr_b16 a[138:139], v6 offset:4352
    ds_read_b64_tr_b16 a[140:141], v6 offset:4128
    ds_read_b64_tr_b16 a[142:143], v6 offset:4384
    ds_read_b64_tr_b16 a[144:145], v6 offset:8192
    ds_read_b64_tr_b16 a[146:147], v6 offset:8448
    buffer_load_dwordx4 v177, s[8:11], s70 offen offset:1024 lds
    ds_read_b64_tr_b16 a[148:149], v6 offset:8224
    ds_read_b64_tr_b16 a[150:151], v6 offset:8480
    ds_read_b64_tr_b16 a[152:153], v6 offset:12288
    ds_read_b64_tr_b16 a[154:155], v6 offset:12544
    s_waitcnt lgkmcnt(12)
    v_mfma_f32_16x16x32_bf16 a[180:183], a[128:131], a[176:179], 0
    ds_read_b64_tr_b16 a[156:157], v6 offset:12320
    ds_read_b64_tr_b16 a[158:159], v6 offset:12576
    s_waitcnt lgkmcnt(12)
    v_mfma_f32_16x16x32_bf16 a[184:187], a[132:135], a[176:179], 0
    buffer_load_dwordx4 v178, s[8:11], s70 offen offset:2048 lds
    ds_read_b64_tr_b16 a[128:129], v6 offset:16384
    ds_read_b64_tr_b16 a[130:131], v6 offset:16640
    s_waitcnt lgkmcnt(12)
    v_mfma_f32_16x16x32_bf16 a[180:183], a[136:139], a[176:179], a[180:183]
    ds_read_b64_tr_b16 a[132:133], v6 offset:16416
    ds_read_b64_tr_b16 a[134:135], v6 offset:16672
    s_waitcnt lgkmcnt(12)
    v_mfma_f32_16x16x32_bf16 a[184:187], a[140:143], a[176:179], a[184:187]
    ds_read_b64_tr_b16 a[136:137], v6 offset:20480
    ds_read_b64_tr_b16 a[138:139], v6 offset:20736
    s_waitcnt lgkmcnt(12)
    v_mfma_f32_16x16x32_bf16 a[180:183], a[144:147], a[176:179], a[180:183]
    buffer_load_dwordx4 v179, s[8:11], s70 offen offset:3072 lds
    ds_read_b64_tr_b16 a[140:141], v6 offset:20512
    ds_read_b64_tr_b16 a[142:143], v6 offset:20768
    s_waitcnt lgkmcnt(12)
    v_mfma_f32_16x16x32_bf16 a[184:187], a[148:151], a[176:179], a[184:187]
    ds_read_b64_tr_b16 a[144:145], v6 offset:24576
    ds_read_b64_tr_b16 a[146:147], v6 offset:24832
    s_waitcnt lgkmcnt(12)
    v_mfma_f32_16x16x32_bf16 a[180:183], a[152:155], a[176:179], a[180:183]
    buffer_load_dword v202, v4, s[4:7], 0 offen sc1
    ds_read_b64_tr_b16 a[148:149], v6 offset:24608
    ds_read_b64_tr_b16 a[150:151], v6 offset:24864
    s_waitcnt lgkmcnt(12)
    v_mfma_f32_16x16x32_bf16 a[184:187], a[156:159], a[176:179], a[184:187]
    s_add_u32 m0, m0, 4096
    s_add_u32 s70, s70, 28672
    buffer_load_dwordx4 v176, s[8:11], s70 offen offset:0 lds
    ds_read_b64_tr_b16 a[152:153], v7 offset:0
    ds_read_b64_tr_b16 a[154:155], v7 offset:256
    s_waitcnt lgkmcnt(12)
    v_mfma_f32_16x16x32_bf16 a[180:183], a[128:131], a[176:179], a[180:183]
    ds_read_b64_tr_b16 a[156:157], v7 offset:32
    ds_read_b64_tr_b16 a[158:159], v7 offset:288
    s_waitcnt lgkmcnt(12)
    v_mfma_f32_16x16x32_bf16 a[184:187], a[132:135], a[176:179], a[184:187]
    ds_read_b64_tr_b16 a[128:129], v7 offset:4096
    ds_read_b64_tr_b16 a[130:131], v7 offset:4352
    s_waitcnt lgkmcnt(12)
    v_mfma_f32_16x16x32_bf16 a[180:183], a[136:139], a[176:179], a[180:183]
    buffer_load_dwordx4 v177, s[8:11], s70 offen offset:1024 lds
    ds_read_b64_tr_b16 a[132:133], v7 offset:4128
    ds_read_b64_tr_b16 a[134:135], v7 offset:4384
    s_waitcnt lgkmcnt(12)
    v_mfma_f32_16x16x32_bf16 a[184:187], a[140:143], a[176:179], a[184:187]
    ds_read_b64_tr_b16 a[136:137], v7 offset:8192
    ds_read_b64_tr_b16 a[138:139], v7 offset:8448
    s_waitcnt lgkmcnt(12)
    v_mfma_f32_16x16x32_bf16 a[180:183], a[144:147], a[176:179], a[180:183]
    ds_read_b64_tr_b16 a[140:141], v7 offset:8224
    ds_read_b64_tr_b16 a[142:143], v7 offset:8480
    s_waitcnt lgkmcnt(12)
    v_mfma_f32_16x16x32_bf16 a[184:187], a[148:151], a[176:179], a[184:187]
    buffer_load_dwordx4 v178, s[8:11], s70 offen offset:2048 lds
    ds_read_b64_tr_b16 a[144:145], v7 offset:12288
    ds_read_b64_tr_b16 a[146:147], v7 offset:12544
    s_waitcnt lgkmcnt(12)
    v_mfma_f32_16x16x32_bf16 a[180:183], a[152:155], a[176:179], a[180:183]
    ds_read_b64_tr_b16 a[148:149], v7 offset:12320
    ds_read_b64_tr_b16 a[150:151], v7 offset:12576
    s_waitcnt lgkmcnt(12)
    v_mfma_f32_16x16x32_bf16 a[184:187], a[156:159], a[176:179], a[184:187]
    ds_read_b64_tr_b16 a[152:153], v7 offset:16384
    ds_read_b64_tr_b16 a[154:155], v7 offset:16640
    s_waitcnt lgkmcnt(12)
    v_mfma_f32_16x16x32_bf16 a[180:183], a[128:131], a[176:179], a[180:183]
    ds_read_b64_tr_b16 a[156:157], v7 offset:16416
    ds_read_b64_tr_b16 a[158:159], v7 offset:16672
    s_waitcnt lgkmcnt(12)
    v_mfma_f32_16x16x32_bf16 a[184:187], a[132:135], a[176:179], a[184:187]
    ds_read_b64_tr_b16 a[128:129], v7 offset:20480
    ds_read_b64_tr_b16 a[130:131], v7 offset:20736
    s_waitcnt lgkmcnt(12)
    v_mfma_f32_16x16x32_bf16 a[180:183], a[136:139], a[176:179], a[180:183]
    ds_read_b64_tr_b16 a[132:133], v7 offset:20512
    ds_read_b64_tr_b16 a[134:135], v7 offset:20768
    s_waitcnt lgkmcnt(12)
    v_mfma_f32_16x16x32_bf16 a[184:187], a[140:143], a[176:179], a[184:187]
    ds_read_b64_tr_b16 a[136:137], v7 offset:24576
    ds_read_b64_tr_b16 a[138:139], v7 offset:24832
    s_waitcnt lgkmcnt(12)
    v_mfma_f32_16x16x32_bf16 a[180:183], a[144:147], a[176:179], a[180:183]
    ds_read_b64_tr_b16 a[140:141], v7 offset:24608
    ds_read_b64_tr_b16 a[142:143], v7 offset:24864
    s_waitcnt lgkmcnt(12)
    v_mfma_f32_16x16x32_bf16 a[184:187], a[148:151], a[176:179], a[184:187]
    s_waitcnt lgkmcnt(10)
    v_mfma_f32_16x16x32_bf16 a[180:183], a[152:155], a[176:179], a[180:183]
    s_waitcnt lgkmcnt(8)
    v_mfma_f32_16x16x32_bf16 a[184:187], a[156:159], a[176:179], a[184:187]
    s_waitcnt lgkmcnt(6)
    v_mfma_f32_16x16x32_bf16 a[180:183], a[128:131], a[176:179], a[180:183]
    s_waitcnt lgkmcnt(4)
    v_mfma_f32_16x16x32_bf16 a[184:187], a[132:135], a[176:179], a[184:187]
    s_waitcnt lgkmcnt(2)
    v_mfma_f32_16x16x32_bf16 a[180:183], a[136:139], a[176:179], a[180:183]
    s_waitcnt lgkmcnt(0)
    v_mfma_f32_16x16x32_bf16 a[184:187], a[140:143], a[176:179], a[184:187]
    s_lshl_b32 s60, s41, 7
    s_add_u32 s60, s60, 131072
    v_add_u32 v5, s60, v0
    s_mov_b32 exec_lo, 0x10001
    s_mov_b32 exec_hi, 0x10001
    s_nop 2
    ds_write_b128 v5, a[180:183] offset:0
    ds_write_b128 v5, a[184:187] offset:64
    s_mov_b64 exec, -1
    s_waitcnt lgkmcnt(0)
    s_branch L_cs1_40
L_final:
    s_nop 8
    ds_write_b128 v199, v[48:51] offset:0
    ds_write_b128 v199, v[52:55] offset:1024
    ds_write_b128 v199, v[56:59] offset:2048
    ds_write_b128 v199, v[60:63] offset:3072
    v_pk_add_f32 v[16:17], v[16:17], v[32:33]
    v_pk_add_f32 v[18:19], v[18:19], v[34:35]
    v_pk_add_f32 v[20:21], v[20:21], v[36:37]
    v_pk_add_f32 v[22:23], v[22:23], v[38:39]
    v_pk_add_f32 v[24:25], v[24:25], v[40:41]
    v_pk_add_f32 v[26:27], v[26:27], v[42:43]
    v_pk_add_f32 v[28:29], v[28:29], v[44:45]
    v_pk_add_f32 v[30:31], v[30:31], v[46:47]
    s_waitcnt lgkmcnt(0)
    s_barrier
    ds_read_b128 v[64:67], v200 offset:0
    ds_read_b128 v[68:71], v200 offset:1024
    ds_read_b128 v[72:75], v200 offset:2048
    ds_read_b128 v[76:79], v200 offset:3072
    s_waitcnt lgkmcnt(3)
    v_pk_add_f32 v[16:17], v[16:17], v[64:65]
    v_pk_add_f32 v[18:19], v[18:19], v[66:67]
    s_waitcnt lgkmcnt(2)
    v_pk_add_f32 v[20:21], v[20:21], v[68:69]
    v_pk_add_f32 v[22:23], v[22:23], v[70:71]
    s_waitcnt lgkmcnt(1)
    v_pk_add_f32 v[24:25], v[24:25], v[72:73]
    v_pk_add_f32 v[26:27], v[26:27], v[74:75]
    s_waitcnt lgkmcnt(0)
    v_pk_add_f32 v[28:29], v[28:29], v[76:77]
    v_pk_add_f32 v[30:31], v[30:31], v[78:79]
    v_cvt_pk_bf16_f32 v144, v16, v17
    v_cvt_pk_bf16_f32 v145, v18, v19
    v_cvt_pk_bf16_f32 v146, v20, v21
    v_cvt_pk_bf16_f32 v147, v22, v23
    v_cvt_pk_bf16_f32 v148, v24, v25
    v_cvt_pk_bf16_f32 v149, v26, v27
    v_cvt_pk_bf16_f32 v150, v28, v29
    v_cvt_pk_bf16_f32 v151, v30, v31
    s_nop 0
    v_permlane32_swap_b32 v144, v146
    v_permlane32_swap_b32 v145, v147
    v_permlane32_swap_b32 v148, v150
    v_permlane32_swap_b32 v149, v151
    buffer_store_dwordx4 v[144:147], v90, s[12:15], 0 offen offset:0
    buffer_store_dwordx4 v[148:151], v90, s[12:15], 0 offen offset:32
    s_lshl_b32 s61, s2, 2
    s_add_u32 s61, s61, s41
    s_cmp_lg_u32 s61, 0
    s_cbranch_scc1 L_ep_68
    s_sub_u32 s61, s3, 8
    v_mov_b32 v5, s61
    s_mov_b32 s62, 40960
    s_mov_b64 exec, 1
    buffer_store_dword v5, off, s[4:7], s62 sc1
    s_mov_b64 exec, -1
L_ep_68:
    s_branch L_end
L_slow_9:
    buffer_store_dwordx2 v[112:113], v192, s[4:7], 0 offen sc1
    buffer_store_dwordx2 v[114:115], v193, s[4:7], 0 offen sc1
    buffer_store_dwordx2 v[116:117], v194, s[4:7], 0 offen sc1
    s_mov_b32 exec_hi, 0
    buffer_store_dwordx2 v[118:119], v195, s[4:7], 0 offen sc1
    s_mov_b32 exec_hi, -1
    s_branch L_join_10
L_slow_11:
    buffer_store_dword v5, off, s[4:7], s82 sc1
    s_branch L_join_12
L_slow_17:
    buffer_store_dwordx4 v[144:147], v1, s[4:7], s87 offen offset:0 sc1
    buffer_store_dwordx4 v[148:151], v1, s[4:7], s87 offen offset:1024 sc1
    s_branch L_join_18
L_slow_19:
    buffer_store_dword v112, v1, s[4:7], s88 offen sc1
    s_branch L_join_20
L_slow_21:
    buffer_store_dword v5, off, s[4:7], s82 sc1
    s_branch L_join_22
L_slow_26:
    buffer_store_dwordx4 v[144:147], v1, s[4:7], s87 offen offset:0 sc1
    buffer_store_dwordx4 v[148:151], v1, s[4:7], s87 offen offset:1024 sc1
    s_branch L_join_27
L_slow_29:
    buffer_store_dword v5, off, s[4:7], s82 sc1
    s_branch L_join_30
L_slow_33:
    buffer_store_dwordx4 v[144:147], v1, s[4:7], s87 offen offset:0 sc1
    buffer_store_dwordx4 v[148:151], v1, s[4:7], s87 offen offset:1024 sc1
    s_branch L_join_34
L_slow_35:
    buffer_store_dword v112, v1, s[4:7], s88 offen sc1
    s_branch L_join_36
L_slow_37:
    buffer_store_dword v5, off, s[4:7], s82 sc1
    s_branch L_join_38
L_slow_43:
    buffer_store_dwordx4 v[160:163], v9, s[4:7], 0 offen offset:0 sc1
    buffer_store_dwordx4 v[164:167], v9, s[4:7], 0 offen offset:1024 sc1
    s_branch L_join_44
L_slow_45:
    buffer_store_dwordx4 v[168:171], v9, s[4:7], 0 offen offset:2048 sc1
    buffer_store_dwordx4 v[172:175], v9, s[4:7], 0 offen offset:3072 sc1
    s_branch L_join_46
L_slow_47:
    buffer_store_dwordx4 v[160:163], v9, s[4:7], s52 offen offset:0 sc1
    buffer_store_dwordx4 v[164:167], v9, s[4:7], s52 offen offset:1024 sc1
    s_branch L_join_48
L_slow_49:
    buffer_store_dwordx4 v[168:171], v9, s[4:7], s52 offen offset:2048 sc1
    buffer_store_dwordx4 v[172:175], v9, s[4:7], s52 offen offset:3072 sc1
    s_branch L_join_50
L_slow_51:
    buffer_store_dword v5, off, s[4:7], s82 sc1
    s_branch L_join_52
L_slow_55:
    buffer_store_dwordx4 v[144:147], v1, s[4:7], s87 offen offset:0 sc1
    buffer_store_dwordx4 v[148:151], v1, s[4:7], s87 offen offset:1024 sc1
    s_branch L_join_56
L_slow_57:
    buffer_store_dword v112, v1, s[4:7], s88 offen sc1
    s_branch L_join_58
L_slow_59:
    buffer_store_dword v5, off, s[4:7], s82 sc1
    s_branch L_join_60
L_code_end:
.section .rodata,"a"
.p2align 6
.amdhsa_kernel interleave_layers__softmax_full_mha__mixer_s_mlp__prompt_kernel
  .amdhsa_next_free_vgpr 512
  .amdhsa_next_free_sgpr 102
  .amdhsa_accum_offset 256
  .amdhsa_group_segment_fixed_size 0
  .amdhsa_kernarg_size 88
  .amdhsa_user_sgpr_count 2
  .amdhsa_user_sgpr_kernarg_segment_ptr 1
  .amdhsa_system_sgpr_workgroup_id_x 1
  .amdhsa_float_denorm_mode_32 3
.end_amdhsa_kernel
```
